```python
import torch

def _softmax(x, axis=-1):
    return torch.softmax(x, dim=axis)
def _gelu(x):
    return torch.nn.functional.gelu(x, approximate="tanh")
def _silu(x):
    return torch.nn.functional.silu(x)
def _sigmoid(x):
    return torch.sigmoid(x)
def _layernorm(x, axis=-1, eps=1e-5):
    m = x.mean(dim=axis, keepdim=True)
    v = x.var(dim=axis, keepdim=True, unbiased=False)
    return (x - m) / torch.sqrt(v + eps)
def _scatter_add(tgt, idx, src, axis=0):
    return tgt.clone().index_add_(axis, idx, src)
def _segment_sum(src, seg, n):
    out = torch.zeros((n,) + src.shape[1:], dtype=src.dtype)
    return out.index_add_(0, seg, src)
def _pad(x, pw):
    flat = tuple(v for pair in reversed(pw) for v in pair)
    return torch.nn.functional.pad(x, flat)

kernel_name = 'parallel_sum__sliding_block__dense_activation_relu__prompt'

def setup_inputs():

    _w = (lambda a: (lambda t: t.to(torch.bfloat16) if t.is_floating_point() else t)(torch.as_tensor(a)))
    def _A_setup():
        B, S, D = 1, 2048, 576
        return {
            "x": _w((lambda *s: torch.randn(*s, dtype=torch.bfloat16) * 0.05)(B, S, D)),
            "wqkv": _w((lambda *s: torch.randn(*s, dtype=torch.bfloat16) * 0.1)(D, 3 * D)),
            "wo": _w((lambda *s: torch.randn(*s, dtype=torch.bfloat16) * 0.05)(D, D)),
        }
    _A_in = _A_setup()

    def _B_setup():
        B, S, D, Dff = 1, 2048, 576, 4608
        return {
            "x": _w((lambda *s: torch.randn(*s, dtype=torch.bfloat16) * 0.05)(B, S, D)),
            "w1": _w((lambda *s: torch.randn(*s, dtype=torch.bfloat16) * 0.05)(D, Dff)),
            "w2": _w((lambda *s: torch.randn(*s, dtype=torch.bfloat16) * 0.05)(Dff, D)),
        }
    _B_in = _B_setup()

    return {
        "A_x": _A_in["x"],
        "A_wqkv": _A_in["wqkv"],
        "A_wo": _A_in["wo"],
        "B_x": _B_in["x"],
        "B_w1": _B_in["w1"],
        "B_w2": _B_in["w2"],
    }

def reference(A_x, A_wqkv, A_wo, B_x, B_w1, B_w2):
    def _A_ref(x, wqkv, wo):
        B, S, D = x.shape
        H = 32; Dh = D // H; W = 256
        qkv = (lambda x, *d: x.permute(*d))((x @ wqkv).reshape(B, S, 3, H, Dh), 2, 0, 3, 1, 4)
        q, k, v = qkv[0], qkv[1], qkv[2]
        scores = torch.einsum("bhqd,bhkd->bhqk", q, k) * (Dh ** -0.5)
        idx = torch.arange(S)
        mask = (idx[:, None] - idx[None, :] >= 0) & (idx[:, None] - idx[None, :] < W)
        scores = torch.where(mask[None, None], scores, -1e9)
        p = _softmax(scores, axis=-1)
        o = torch.einsum("bhqk,bhkd->bhqd", p, v)
        return (lambda x, *d: x.permute(*d))(o, 0, 2, 1, 3).reshape(B, S, D) @ wo

    def _B_ref(x, w1, w2):
        h = torch.einsum("bsd,df->bsf", x, w1)
        zero = torch.zeros_like(h)
        h = torch.maximum(h, zero)
        return torch.einsum("bsf,fd->bsd", h, w2)

    x = A_x
    xn = _layernorm(x, axis=-1)
    return x + _A_ref(xn, A_wqkv, A_wo) + _B_ref(xn, B_w1, B_w2)
```

```asm
; @launch grid=(256,1,1) block=(256,1,1) lds=163840
.amdgcn_target "amdgcn-amd-amdhsa--gfx950"
.text
.globl parallel_sum__sliding_block__dense_activation_relu__prompt_kernel
.p2align 8
.type parallel_sum__sliding_block__dense_activation_relu__prompt_kernel,@function
parallel_sum__sliding_block__dense_activation_relu__prompt_kernel:
  s_cmp_ge_u32 s2, 256
  s_cbranch_scc1 L_end
  s_load_dwordx16 s[40:55], s[0:1], 0
  s_load_dwordx2 s[56:57], s[0:1], 64
  v_lshrrev_b32 v3, 6, v0
  v_and_b32 v1, 63, v0
  v_readfirstlane_b32 s60, v3
  s_getpc_b64 s[36:37]
L_pc:
  s_mov_b32 s38, L_code_end-L_pc
  s_mov_b32 s39, 0x00020000
  v_lshlrev_b32 v2, 7, v1
  v_cmp_lt_u32 vcc, 3, v1
  v_mov_b32 v4, 0x80000000
  s_lshr_b32 s101, s2, 3
  v_cndmask_b32 v97, v2, v4, vcc
  v_cmp_gt_u32 vcc, 40, v0
  s_lshl_b32 s101, s101, 2
  s_add_u32 s101, s101, s60
  v_cndmask_b32 v2, v4, v2, vcc
  s_lshl_b32 s101, s101, 9
  buffer_load_dword v104, v2, s[36:39], 0 offen
  buffer_load_dword v96, v97, s[36:39], s101 offen
  v_accvgpr_write_b32 a246, v97
  v_lshrrev_b32 v2, 3, v1
  v_lshrrev_b32 v3, 4, v1
  v_and_b32 v4, 7, v1
  v_xor_b32 v4, v4, v3
  v_lshlrev_b32 v4, 4, v4
  v_mul_u32_u24 v2, 1152, v2
  v_add_u32 v28, v2, v4
  v_xor_b32 v29, 64, v28
  v_add_u32 v30, 16384, v28
  v_add_u32 v31, 24576, v29
  v_add_u32 v29, 8192, v29
  s_bfe_u32 s100, s2, 0x10002
  s_lshl_b32 s100, s100, 3
  s_lshr_b32 s61, s2, 5
  s_add_u32 s58, s100, s61
  s_bfe_u32 s101, s2, 0x20003
  s_lshl_b32 s101, s101, 1
  s_add_u32 s101, s101, s61
  s_sub_u32 s100, s101, 9
  s_cmp_ge_u32 s101, 9
  s_cselect_b32 s101, s100, s101
  s_lshl_b32 s62, s101, 7
  s_lshl_b32 s100, s58, 2
  s_add_u32 s100, s100, s60
  s_mul_i32 s80, s100, 36864
  s_mul_i32 s94, s60, 20480
  s_add_u32 s94, s94, 81920
  s_mov_b32 s6, 2359296
  s_mov_b32 s7, 0x00020000
  s_waitcnt lgkmcnt(0)
  s_mov_b32 s4, s40
  s_mov_b32 s5, s41
  s_add_u32 m0, s94, 0
  s_add_u32 s100, s80, s62
  buffer_load_dwordx4 v28, s[4:7], s100 offen offset:0 lds
  buffer_load_dwordx4 v29, s[4:7], s100 offen offset:1024 lds
  s_mov_b32 s28, s56
  s_mov_b32 s29, s57
  s_mov_b32 s30, 50331648
  s_mov_b32 s31, 0x00020000
  v_mov_b32 v26, 131072
  s_or_b32 s101, s2, s60
  s_cmp_lg_u32 s101, 0
  s_cbranch_scc1 L_noep1
  buffer_load_dword v27, v26, s[28:31], 0 offen sc1
L_noep1:
  s_mov_b32 s8, s42
  s_mov_b32 s9, s43
  s_mov_b32 s10, 1990656
  s_mov_b32 s11, 0x00020000
  s_mov_b32 s20, s44
  s_mov_b32 s21, s45
  s_mov_b32 s22, 663552
  s_mov_b32 s23, 0x00020000
  s_mov_b32 s12, s48
  s_mov_b32 s13, s49
  s_mov_b32 s14, 5308416
  s_mov_b32 s15, 0x00020000
  s_mov_b32 s16, s50
  s_mov_b32 s17, s51
  s_mov_b32 s18, 5308416
  s_mov_b32 s19, 0x00020000
  s_mov_b32 s24, s52
  s_mov_b32 s25, s53
  s_mov_b32 s26, 2359296
  s_mov_b32 s27, 0x00020000
  s_mov_b32 s32, s54
  s_mov_b32 s33, s55
  s_mov_b32 s34, 256
  s_mov_b32 s35, 0x00020000
  s_and_b32 s75, s2, 3
  s_lshl_b32 s75, s75, 2
  s_bfe_u32 s76, s2, 0x20003
  buffer_load_dwordx4 v30, s[4:7], s100 offen offset:2048 lds
  s_add_u32 s59, s75, s76
  v_and_b32 v2, 31, v1
  v_lshrrev_b32 v3, 5, v1
  v_bfe_u32 v4, v1, 1, 3
  v_xor_b32 v4, v4, v3
  v_lshlrev_b32 v4, 4, v4
  v_lshl_add_u32 v4, v2, 7, v4
  v_xor_b32 v32, 0, v4
  v_add_u32 v32, s94, v32
  v_xor_b32 v33, 32, v4
  v_add_u32 v33, s94, v33
  v_xor_b32 v34, 64, v4
  v_add_u32 v34, s94, v34
  v_xor_b32 v35, 96, v4
  v_add_u32 v35, s94, v35
  v_mov_b32 v36, 0
  v_mov_b32 v37, 0
  v_mov_b32 v38, 0
  v_mov_b32 v39, 0
  v_mov_b32 v40, 0
  v_mov_b32 v41, 0
  v_mov_b32 v42, 0
  v_mov_b32 v43, 0
  v_lshlrev_b32 v21, 4, v1
  s_mov_b32 s95, 0xffff0000
  s_mov_b32 s3, 0x3f803f80
  s_mov_b32 s96, -1
  s_mov_b32 s97, 0
  v_lshlrev_b32 v4, 31, v3
  v_add_u32 v23, 1024, v21
  v_add_u32 v23, v23, v4
  v_bfe_u32 v2, v1, 2, 2
  v_bfe_u32 v4, v1, 4, 1
  buffer_load_dwordx4 v31, s[4:7], s100 offen offset:3072 lds
  v_and_b32 v5, 3, v1
  v_lshl_add_u32 v5, v4, 2, v5
  v_mul_u32_u24 v6, 1088, v2
  v_lshl_add_u32 v6, v3, 9, v6
  v_mul_u32_u24 v7, 40, v5
  v_and_b32 v8, 1, v5
  v_lshl_or_b32 v8, v8, 3, v5
  v_mov_b32 v9, 168
  v_cmp_lt_u32 vcc, 4, v8
  s_nop 1
  v_cndmask_b32 v7, v7, v9, vcc
  v_add3_u32 v7, v7, v6, 36
  v_add_u32 v7, 36, v7
  v_lshl_add_u32 v6, v5, 3, v6
  v_lshl_add_u32 v8, v3, 3, v2
  v_lshlrev_b32 v8, 6, v8
  v_lshl_add_u32 v8, v5, 3, v8
  v_lshl_add_u32 v9, v3, 2, v2
  v_lshlrev_b32 v9, 7, v9
  v_lshl_add_u32 v9, v5, 3, v9
  v_lshrrev_b32 v4, 1, v2
  v_lshl_add_u32 v9, v4, 6, v9
  v_xor_b32 v10, 64, v9
  v_lshrrev_b32 v2, 4, v1
  v_and_b32 v3, 15, v1
  v_mul_u32_u24 v4, 36864, v2
  v_lshl_add_u32 v16, v3, 4, v4
  v_add_u32 v17, 8128, v16
  v_add_u32 v18, 16256, v16
  v_add_u32 v19, 24384, v16
  v_min_u32 v3, 14, v3
  v_mul_u32_u24 v4, 13, v3
  v_lshrrev_b32 v4, 6, v4
  v_mul_u32_u24 v5, 5, v4
  v_sub_u32 v3, v3, v5
  s_add_u32 s63, s62, 128
  s_cmp_eq_u32 s63, 1152
  s_cselect_b32 s63, 0, s63
  s_add_u32 m0, s94, 4096
  s_add_u32 s100, s80, s63
  buffer_load_dwordx4 v28, s[4:7], s100 offen offset:0 lds
  v_lshlrev_b32 v3, 4, v3
  v_min_u32 v3, 56, v3
  v_mul_u32_u24 v5, 1152, v4
  v_add_u32 v3, v3, v5
  s_mul_i32 s75, s59, 72
  s_xor_b32 s76, s59, 1
  s_mul_i32 s77, s76, 72
  v_mov_b32 v5, s77
  v_mov_b32 v20, s75
  v_cmp_eq_u32 vcc, 0, v4
  v_mul_u32_u24 v4, 13824, v2
  v_add_u32 v3, v3, v4
  v_cndmask_b32 v5, v5, v20, vcc
  v_add_u32 v12, v3, v5
  v_and_b32 v3, 15, v1
  v_add_u32 v3, 1, v3
  v_lshlrev_b32 v3, 27, v3
  v_and_b32 v3, 0x80000000, v3
  v_or_b32 v12, v12, v3
  v_add_u32 v13, 2368, v12
  v_add_u32 v14, 4736, v12
  v_add_u32 v15, 7104, v12
  v_lshrrev_b32 v2, 2, v1
  v_mul_u32_u24 v2, 9216, v2
  v_and_b32 v3, 3, v1
  v_lshl_add_u32 v20, v3, 4, v2
  s_mul_i32 s81, s60, 55296
  s_and_b32 s75, s59, 1
  s_mul_i32 s77, s59, 288
  s_lshl_b32 s78, s75, 5
  s_add_u32 s78, s78, s77
  s_xor_b32 s75, s75, 1
  s_lshl_b32 s75, s75, 8
  buffer_load_dwordx4 v29, s[4:7], s100 offen offset:1024 lds
  s_add_u32 s77, s77, s75
  s_mul_i32 s75, s60, 147456
  s_lshl_b32 s82, s78, 1
  s_add_u32 s82, s82, s75
  s_add_u32 s83, s82, 256
  s_lshl_b32 s84, s77, 1
  s_add_u32 s84, s84, s75
  s_mul_i32 s46, s60, 8576
  s_mul_i32 s47, s60, 5312
  s_mul_i32 s48, s60, 5120
  s_lshl_b32 s49, s60, 12
  s_lshl_b32 s50, s60, 10
  s_add_i32 s75, s58, -2
  s_cmp_lt_i32 s75, 0
  s_cselect_b32 s75, s58, s75
  s_lshl_b32 s76, s59, 4
  s_add_u32 s75, s75, s76
  s_lshl_b32 s75, s75, 2
  s_add_u32 s75, s75, s60
  s_mul_i32 s75, s75, 5120
  s_add_u32 s71, s75, 262144
  s_add_i32 s75, s58, -1
  s_cmp_lt_i32 s75, 0
  s_cselect_b32 s75, s58, s75
  s_lshl_b32 s76, s59, 4
  s_add_u32 s75, s75, s76
  s_lshl_b32 s75, s75, 2
  s_add_u32 s75, s75, s60
  s_mul_i32 s75, s75, 5120
  s_add_u32 s72, s75, 262144
  s_add_i32 s75, s58, 0
  s_cmp_lt_i32 s75, 0
  s_cselect_b32 s75, s58, s75
  s_lshl_b32 s76, s59, 4
  s_add_u32 s75, s75, s76
  s_lshl_b32 s75, s75, 2
  buffer_load_dwordx4 v30, s[4:7], s100 offen offset:2048 lds
  s_add_u32 s75, s75, s60
  s_mul_i32 s75, s75, 5120
  s_add_u32 s73, s75, 262144
  s_xor_b32 s75, s59, 1
  s_lshl_b32 s75, s75, 4
  s_add_u32 s75, s75, s58
  s_lshl_b32 s75, s75, 2
  s_add_u32 s75, s75, s60
  s_mul_i32 s75, s75, 5120
  s_add_u32 s89, s75, 262144
  s_lshl_b32 s75, s58, 2
  s_add_u32 s75, s75, s60
  s_lshl_b32 s75, s75, 4
  s_add_u32 s75, s75, s59
  s_mul_i32 s90, s75, 21632
  s_add_u32 s90, s90, 6312960
  s_and_b32 s76, s59, 1
  s_lshl_b32 s77, s58, 1
  s_add_u32 s77, s77, s76
  s_mul_i32 s91, s77, 655360
  s_add_u32 s91, s91, 29360128
  s_mul_i32 s56, s75, 21632
  s_add_u32 s56, s56, 6291456
  s_xor_b32 s75, s75, 1
  s_mul_i32 s57, s75, 21632
  s_add_u32 s57, s57, 6291456
  v_and_b32 v2, 15, v1
  v_and_b32 v3, 1, v1
  v_lshlrev_b32 v3, 4, v3
  v_mov_b32 v4, 0x3f80
  v_lshlrev_b32 v4, v3, v4
  v_lshrrev_b32 v2, 1, v2
  v_cmp_eq_u32 vcc, 0, v2
  s_nop 1
  v_cndmask_b32 v3, 0, v4, vcc
  buffer_load_dwordx4 v31, s[4:7], s100 offen offset:3072 lds
  v_accvgpr_write_b32 a252, v3
  v_cmp_eq_u32 vcc, 4, v2
  s_nop 1
  v_cndmask_b32 v3, 0, v4, vcc
  v_accvgpr_write_b32 a248, v3
  v_cmp_eq_u32 vcc, 1, v2
  s_nop 1
  v_cndmask_b32 v3, 0, v4, vcc
  v_accvgpr_write_b32 a253, v3
  v_cmp_eq_u32 vcc, 5, v2
  s_nop 1
  v_cndmask_b32 v3, 0, v4, vcc
  v_accvgpr_write_b32 a249, v3
  v_cmp_eq_u32 vcc, 2, v2
  s_nop 1
  v_cndmask_b32 v3, 0, v4, vcc
  v_accvgpr_write_b32 a254, v3
  v_cmp_eq_u32 vcc, 6, v2
  s_nop 1
  v_cndmask_b32 v3, 0, v4, vcc
  v_accvgpr_write_b32 a250, v3
  v_cmp_eq_u32 vcc, 3, v2
  s_nop 1
  v_cndmask_b32 v3, 0, v4, vcc
  v_accvgpr_write_b32 a255, v3
  v_cmp_eq_u32 vcc, 7, v2
  s_nop 1
  v_cndmask_b32 v3, 0, v4, vcc
  v_accvgpr_write_b32 a251, v3
  v_bfe_u32 v100, v1, 2, 3
  v_lshlrev_b32 v100, 12, v100
  v_and_b32 v101, 3, v1
  v_lshl_add_u32 v100, v101, 5, v100
  v_lshrrev_b32 v101, 5, v1
  v_lshl_add_u32 v100, v101, 4, v100
  s_lshl_b32 s75, s60, 15
  s_lshr_b32 s77, s59, 1
  s_lshl_b32 s76, s77, 9
  s_add_u32 s75, s75, s76
  v_add_u32 v100, s75, v100
  v_accvgpr_write_b32 a240, v100
  v_lshrrev_b32 v100, 4, v1
  v_lshlrev_b32 v100, 9, v100
  v_and_b32 v101, 15, v1
  v_lshl_add_u32 v100, v101, 4, v100
  s_lshl_b32 s75, s77, 14
  s_lshl_b32 s76, s60, 12
  s_add_u32 s64, s63, 128
  s_cmp_eq_u32 s64, 1152
  s_cselect_b32 s64, 0, s64
  s_add_u32 m0, s94, 8192
  s_add_u32 s100, s80, s64
  buffer_load_dwordx4 v28, s[4:7], s100 offen offset:0 lds
  s_add_u32 s75, s75, s76
  v_add_u32 v100, s75, v100
  v_accvgpr_write_b32 a241, v100
  s_lshl_b32 s75, s58, 7
  s_lshl_b32 s78, s77, 4
  s_add_u32 s75, s75, s78
  s_lshl_b32 s76, s60, 2
  s_add_u32 s75, s75, s76
  s_mul_i32 s75, s75, 1152
  v_bfe_u32 v100, v1, 1, 2
  v_mul_u32_u24 v100, 1152, v100
  v_bfe_u32 v101, v1, 3, 1
  v_lshl_add_u32 v100, v101, 5, v100
  v_bfe_u32 v101, v1, 4, 1
  v_lshl_add_u32 v100, v101, 4, v100
  v_and_b32 v101, 1, v1
  v_lshl_add_u32 v100, v101, 3, v100
  v_lshrrev_b32 v101, 5, v1
  v_lshl_add_u32 v100, v101, 6, v100
  v_add_u32 v100, s75, v100
  v_accvgpr_write_b32 a242, v100
  v_lshrrev_b32 v100, 3, v1
  v_bfe_u32 v101, v1, 4, 1
  v_lshlrev_b32 v101, 2, v101
  v_and_b32 v102, 7, v1
  v_xor_b32 v102, v102, v101
  v_mul_u32_u24 v100, 1152, v100
  v_lshl_add_u32 v100, v102, 4, v100
  v_accvgpr_write_b32 a243, v100
  v_lshrrev_b32 v100, 2, v1
  v_mul_u32_u24 v100, 1152, v100
  v_and_b32 v101, 3, v1
  v_lshl_add_u32 v100, v101, 4, v100
  buffer_load_dwordx4 v29, s[4:7], s100 offen offset:1024 lds
  v_accvgpr_write_b32 a244, v100
  v_lshrrev_b32 v100, 5, v1
  v_lshlrev_b32 v100, 8, v100
  v_sub_u32 v100, v8, v100
  v_accvgpr_write_b32 a245, v100
  v_bfe_u32 v2, v1, 2, 2
  v_min_u32 v2, 2, v2
  s_sub_u32 s75, s58, 2
  v_add_u32 v2, s75, v2
  v_mov_b32 v3, s58
  v_cmp_gt_i32 vcc, 0, v2
  s_xor_b32 s75, s59, 1
  s_nop 0
  v_cndmask_b32 v2, v2, v3, vcc
  v_lshlrev_b32 v2, 6, v2
  v_and_b32 v3, 3, v1
  v_lshl_add_u32 v2, v3, 4, v2
  v_add_u32 v5, s75, v2
  v_mul_u32_u24 v5, 21632, v5
  v_add_u32 v5, 6312960, v5
  v_mov_b32 v3, 0x80000000
  v_cmp_lt_u32 vcc, 11, v1
  s_nop 1
  v_cndmask_b32 v5, v5, v3, vcc
  v_cmp_eq_u32 vcc, 0, v1
  v_mov_b32 v4, 0x80000000
  s_nop 0
  v_cndmask_b32_e64 v4, v4, 0, vcc
  s_lshl_b32 s75, s58, 6
  s_lshr_b32 s78, s59, 2
  s_lshl_b32 s78, s78, 4
  s_add_u32 s75, s75, s78
  s_and_b32 s78, s59, 1
  s_add_u32 s75, s75, s78
  v_and_b32 v3, 7, v1
  buffer_load_dwordx4 v30, s[4:7], s100 offen offset:2048 lds
  v_lshlrev_b32 v3, 1, v3
  v_add_u32 v0, s75, v3
  v_mul_u32_u24 v0, 21632, v0
  v_add_u32 v0, 6312960, v0
  v_mov_b32 v3, 0x80000000
  v_cmp_lt_u32 vcc, 7, v1
  s_nop 1
  v_cndmask_b32 v0, v0, v3, vcc
  v_bfe_u32 v76, v1, 4, 1
  v_and_b32 v77, 3, v1
  v_lshl_add_u32 v76, v76, 2, v77
  v_or_b32 v76, 0x0c0c0c00, v76
  s_mov_b32 s75, 0xffff8080
  v_mov_b32 v77, 0x41014000
  v_perm_b32 v2, s75, v77, v76
  v_mov_b32 v77, 0xfec181c0
  v_perm_b32 v3, s75, v77, v76
  v_bfe_u32 v76, v1, 2, 2
  v_lshrrev_b32 v77, 5, v1
  v_lshl_add_u32 v76, v77, 2, v76
  v_lshlrev_b32 v76, 4, v76
  s_add_u32 s74, s48, 102400
  v_add_u32 v76, s74, v76
  v_add_u32 v76, 2560, v76
  v_add_u32 v77, 2, v2
  v_cmp_lt_u32 vcc, 0xfd, v2
  v_add_u32 v78, 2, v3
  s_nop 0
  v_cndmask_b32 v2, v2, v77, vcc
  v_cmp_lt_u32 vcc, 0xfd, v3
  v_lshl_add_u32 v2, v2, 3, v76
  v_mov_b32 v94, 0
  v_cndmask_b32 v3, v3, v78, vcc
  v_lshl_add_u32 v3, v3, 3, v76
  v_mov_b32 v95, 0
  buffer_load_dwordx4 v31, s[4:7], s100 offen offset:3072 lds
  s_mov_b64 exec, 0
  s_cmp_eq_u32 s60, 0
  s_cbranch_scc1 L_pg0
  s_cmp_eq_u32 s60, 1
  s_cbranch_scc1 L_pg1
  s_cmp_eq_u32 s60, 2
  s_cbranch_scc1 L_pg2
  s_branch L_pg3
L_walked:
  s_mov_b64 exec, -1
  s_waitcnt vmcnt(8)
  ds_read_b128 v[112:115], v32 offset:0
  ds_read_b128 v[116:119], v33 offset:0
  ds_read_b128 v[120:123], v34 offset:0
  ds_read_b128 v[124:127], v35 offset:0
  s_add_u32 s65, s64, 128
  s_cmp_eq_u32 s65, 1152
  s_cselect_b32 s65, 0, s65
  s_add_u32 m0, s94, 12288
  s_add_u32 s100, s80, s65
  buffer_load_dwordx4 v28, s[4:7], s100 offen offset:0 lds
  buffer_load_dwordx4 v29, s[4:7], s100 offen offset:1024 lds
  buffer_load_dwordx4 v30, s[4:7], s100 offen offset:2048 lds
  buffer_load_dwordx4 v31, s[4:7], s100 offen offset:3072 lds
  s_waitcnt vmcnt(8)
  ds_read_b128 v[128:131], v32 offset:4096
  ds_read_b128 v[132:135], v33 offset:4096
  ds_read_b128 v[136:139], v34 offset:4096
  ds_read_b128 v[140:143], v35 offset:4096
  s_waitcnt lgkmcnt(7)
  v_dot2c_f32_bf16 v36, s3, v112
  v_dot2c_f32_bf16 v38, v112, v112
  v_dot2c_f32_bf16 v37, s3, v113
  v_dot2c_f32_bf16 v39, v113, v113
  v_dot2c_f32_bf16 v40, s3, v114
  v_dot2c_f32_bf16 v42, v114, v114
  v_dot2c_f32_bf16 v41, s3, v115
  v_dot2c_f32_bf16 v43, v115, v115
  s_add_u32 s66, s65, 128
  s_cmp_eq_u32 s66, 1152
  s_cselect_b32 s66, 0, s66
  s_add_u32 m0, s94, 16384
  s_add_u32 s100, s80, s66
  buffer_load_dwordx4 v28, s[4:7], s100 offen offset:0 lds
  s_waitcnt lgkmcnt(6)
  v_dot2c_f32_bf16 v36, s3, v116
  v_dot2c_f32_bf16 v38, v116, v116
  v_dot2c_f32_bf16 v37, s3, v117
  v_dot2c_f32_bf16 v39, v117, v117
  v_dot2c_f32_bf16 v40, s3, v118
  v_dot2c_f32_bf16 v42, v118, v118
  v_dot2c_f32_bf16 v41, s3, v119
  v_dot2c_f32_bf16 v43, v119, v119
  buffer_load_dwordx4 v29, s[4:7], s100 offen offset:1024 lds
  s_waitcnt lgkmcnt(5)
  v_dot2c_f32_bf16 v36, s3, v120
  v_dot2c_f32_bf16 v38, v120, v120
  v_dot2c_f32_bf16 v37, s3, v121
  v_dot2c_f32_bf16 v39, v121, v121
  v_dot2c_f32_bf16 v40, s3, v122
  v_dot2c_f32_bf16 v42, v122, v122
  v_dot2c_f32_bf16 v41, s3, v123
  v_dot2c_f32_bf16 v43, v123, v123
  buffer_load_dwordx4 v30, s[4:7], s100 offen offset:2048 lds
  s_waitcnt lgkmcnt(4)
  v_dot2c_f32_bf16 v36, s3, v124
  v_dot2c_f32_bf16 v38, v124, v124
  v_dot2c_f32_bf16 v37, s3, v125
  v_dot2c_f32_bf16 v39, v125, v125
  v_dot2c_f32_bf16 v40, s3, v126
  v_dot2c_f32_bf16 v42, v126, v126
  v_dot2c_f32_bf16 v41, s3, v127
  v_dot2c_f32_bf16 v43, v127, v127
  buffer_load_dwordx4 v31, s[4:7], s100 offen offset:3072 lds
  s_or_b32 s101, s2, s60
  s_cmp_lg_u32 s101, 0
  s_cbranch_scc1 L_noep2
  v_and_b32 v27, -16, v27
  v_add_u32 v27, 16, v27
  buffer_store_dword v27, v26, s[28:31], 0 offen sc1
  v_mov_b32 v98, 0
  v_or_b32 v99, 1, v27
  buffer_store_dword v99, v98, s[32:35], 0 offen sc1
  s_nop 1
L_noep2:
  s_waitcnt vmcnt(8)
  ds_read_b128 v[144:147], v32 offset:8192
  ds_read_b128 v[148:151], v33 offset:8192
  ds_read_b128 v[152:155], v34 offset:8192
  ds_read_b128 v[156:159], v35 offset:8192
  s_waitcnt lgkmcnt(7)
  v_dot2c_f32_bf16 v36, s3, v128
  v_dot2c_f32_bf16 v38, v128, v128
  v_dot2c_f32_bf16 v37, s3, v129
  v_dot2c_f32_bf16 v39, v129, v129
  v_dot2c_f32_bf16 v40, s3, v130
  v_dot2c_f32_bf16 v42, v130, v130
  v_dot2c_f32_bf16 v41, s3, v131
  v_dot2c_f32_bf16 v43, v131, v131
  s_add_u32 s67, s66, 128
  s_cmp_eq_u32 s67, 1152
  s_cselect_b32 s67, 0, s67
  s_add_u32 m0, s94, 0
  s_add_u32 s100, s80, s67
  buffer_load_dwordx4 v28, s[4:7], s100 offen offset:0 lds
  s_waitcnt lgkmcnt(6)
  v_dot2c_f32_bf16 v36, s3, v132
  v_dot2c_f32_bf16 v38, v132, v132
  v_dot2c_f32_bf16 v37, s3, v133
  v_dot2c_f32_bf16 v39, v133, v133
  v_dot2c_f32_bf16 v40, s3, v134
  v_dot2c_f32_bf16 v42, v134, v134
  v_dot2c_f32_bf16 v41, s3, v135
  v_dot2c_f32_bf16 v43, v135, v135
  buffer_load_dwordx4 v29, s[4:7], s100 offen offset:1024 lds
  s_waitcnt lgkmcnt(5)
  v_dot2c_f32_bf16 v36, s3, v136
  v_dot2c_f32_bf16 v38, v136, v136
  v_dot2c_f32_bf16 v37, s3, v137
  v_dot2c_f32_bf16 v39, v137, v137
  v_dot2c_f32_bf16 v40, s3, v138
  v_dot2c_f32_bf16 v42, v138, v138
  v_dot2c_f32_bf16 v41, s3, v139
  v_dot2c_f32_bf16 v43, v139, v139
  buffer_load_dwordx4 v30, s[4:7], s100 offen offset:2048 lds
  s_waitcnt lgkmcnt(4)
  v_dot2c_f32_bf16 v36, s3, v140
  v_dot2c_f32_bf16 v38, v140, v140
  v_dot2c_f32_bf16 v37, s3, v141
  v_dot2c_f32_bf16 v39, v141, v141
  v_dot2c_f32_bf16 v40, s3, v142
  v_dot2c_f32_bf16 v42, v142, v142
  v_dot2c_f32_bf16 v41, s3, v143
  v_dot2c_f32_bf16 v43, v143, v143
  buffer_load_dwordx4 v31, s[4:7], s100 offen offset:3072 lds
  s_waitcnt vmcnt(8)
  ds_read_b128 v[160:163], v32 offset:12288
  ds_read_b128 v[164:167], v33 offset:12288
  ds_read_b128 v[168:171], v34 offset:12288
  ds_read_b128 v[172:175], v35 offset:12288
  s_waitcnt lgkmcnt(7)
  v_dot2c_f32_bf16 v36, s3, v144
  v_dot2c_f32_bf16 v38, v144, v144
  v_dot2c_f32_bf16 v37, s3, v145
  v_dot2c_f32_bf16 v39, v145, v145
  v_dot2c_f32_bf16 v40, s3, v146
  v_dot2c_f32_bf16 v42, v146, v146
  v_dot2c_f32_bf16 v41, s3, v147
  v_dot2c_f32_bf16 v43, v147, v147
  s_add_u32 s68, s67, 128
  s_cmp_eq_u32 s68, 1152
  s_cselect_b32 s68, 0, s68
  s_add_u32 m0, s94, 4096
  s_add_u32 s100, s80, s68
  buffer_load_dwordx4 v28, s[4:7], s100 offen offset:0 lds
  s_waitcnt lgkmcnt(6)
  v_dot2c_f32_bf16 v36, s3, v148
  v_dot2c_f32_bf16 v38, v148, v148
  v_dot2c_f32_bf16 v37, s3, v149
  v_dot2c_f32_bf16 v39, v149, v149
  v_dot2c_f32_bf16 v40, s3, v150
  v_dot2c_f32_bf16 v42, v150, v150
  v_dot2c_f32_bf16 v41, s3, v151
  v_dot2c_f32_bf16 v43, v151, v151
  buffer_load_dwordx4 v29, s[4:7], s100 offen offset:1024 lds
  s_waitcnt lgkmcnt(5)
  v_dot2c_f32_bf16 v36, s3, v152
  v_dot2c_f32_bf16 v38, v152, v152
  v_dot2c_f32_bf16 v37, s3, v153
  v_dot2c_f32_bf16 v39, v153, v153
  v_dot2c_f32_bf16 v40, s3, v154
  v_dot2c_f32_bf16 v42, v154, v154
  v_dot2c_f32_bf16 v41, s3, v155
  v_dot2c_f32_bf16 v43, v155, v155
  buffer_load_dwordx4 v30, s[4:7], s100 offen offset:2048 lds
  s_waitcnt lgkmcnt(4)
  v_dot2c_f32_bf16 v36, s3, v156
  v_dot2c_f32_bf16 v38, v156, v156
  v_dot2c_f32_bf16 v37, s3, v157
  v_dot2c_f32_bf16 v39, v157, v157
  v_dot2c_f32_bf16 v40, s3, v158
  v_dot2c_f32_bf16 v42, v158, v158
  v_dot2c_f32_bf16 v41, s3, v159
  v_dot2c_f32_bf16 v43, v159, v159
  buffer_load_dwordx4 v31, s[4:7], s100 offen offset:3072 lds
  s_waitcnt vmcnt(8)
  ds_read_b128 v[176:179], v32 offset:16384
  ds_read_b128 v[180:183], v33 offset:16384
  ds_read_b128 v[184:187], v34 offset:16384
  ds_read_b128 v[188:191], v35 offset:16384
  s_waitcnt lgkmcnt(7)
  v_dot2c_f32_bf16 v36, s3, v160
  v_dot2c_f32_bf16 v38, v160, v160
  v_dot2c_f32_bf16 v37, s3, v161
  v_dot2c_f32_bf16 v39, v161, v161
  v_dot2c_f32_bf16 v40, s3, v162
  v_dot2c_f32_bf16 v42, v162, v162
  v_dot2c_f32_bf16 v41, s3, v163
  v_dot2c_f32_bf16 v43, v163, v163
  s_add_u32 s69, s68, 128
  s_cmp_eq_u32 s69, 1152
  s_cselect_b32 s69, 0, s69
  s_add_u32 m0, s94, 8192
  s_add_u32 s100, s80, s69
  buffer_load_dwordx4 v28, s[4:7], s100 offen offset:0 lds
  s_waitcnt lgkmcnt(6)
  v_dot2c_f32_bf16 v36, s3, v164
  v_dot2c_f32_bf16 v38, v164, v164
  v_dot2c_f32_bf16 v37, s3, v165
  v_dot2c_f32_bf16 v39, v165, v165
  v_dot2c_f32_bf16 v40, s3, v166
  v_dot2c_f32_bf16 v42, v166, v166
  v_dot2c_f32_bf16 v41, s3, v167
  v_dot2c_f32_bf16 v43, v167, v167
  buffer_load_dwordx4 v29, s[4:7], s100 offen offset:1024 lds
  s_waitcnt lgkmcnt(5)
  v_dot2c_f32_bf16 v36, s3, v168
  v_dot2c_f32_bf16 v38, v168, v168
  v_dot2c_f32_bf16 v37, s3, v169
  v_dot2c_f32_bf16 v39, v169, v169
  v_dot2c_f32_bf16 v40, s3, v170
  v_dot2c_f32_bf16 v42, v170, v170
  v_dot2c_f32_bf16 v41, s3, v171
  v_dot2c_f32_bf16 v43, v171, v171
  buffer_load_dwordx4 v30, s[4:7], s100 offen offset:2048 lds
  s_waitcnt lgkmcnt(4)
  v_dot2c_f32_bf16 v36, s3, v172
  v_dot2c_f32_bf16 v38, v172, v172
  v_dot2c_f32_bf16 v37, s3, v173
  v_dot2c_f32_bf16 v39, v173, v173
  v_dot2c_f32_bf16 v40, s3, v174
  v_dot2c_f32_bf16 v42, v174, v174
  v_dot2c_f32_bf16 v41, s3, v175
  v_dot2c_f32_bf16 v43, v175, v175
  buffer_load_dwordx4 v31, s[4:7], s100 offen offset:3072 lds
  s_waitcnt vmcnt(8)
  ds_read_b128 v[192:195], v32 offset:0
  ds_read_b128 v[196:199], v33 offset:0
  ds_read_b128 v[200:203], v34 offset:0
  ds_read_b128 v[204:207], v35 offset:0
  s_waitcnt lgkmcnt(7)
  v_dot2c_f32_bf16 v36, s3, v176
  v_dot2c_f32_bf16 v38, v176, v176
  v_dot2c_f32_bf16 v37, s3, v177
  v_dot2c_f32_bf16 v39, v177, v177
  v_dot2c_f32_bf16 v40, s3, v178
  v_dot2c_f32_bf16 v42, v178, v178
  v_dot2c_f32_bf16 v41, s3, v179
  v_dot2c_f32_bf16 v43, v179, v179
  s_add_u32 s70, s69, 128
  s_cmp_eq_u32 s70, 1152
  s_cselect_b32 s70, 0, s70
  s_add_u32 m0, s94, 12288
  s_add_u32 s100, s80, s70
  buffer_load_dwordx4 v28, s[4:7], s100 offen offset:0 lds
  s_waitcnt lgkmcnt(6)
  v_dot2c_f32_bf16 v36, s3, v180
  v_dot2c_f32_bf16 v38, v180, v180
  v_dot2c_f32_bf16 v37, s3, v181
  v_dot2c_f32_bf16 v39, v181, v181
  v_dot2c_f32_bf16 v40, s3, v182
  v_dot2c_f32_bf16 v42, v182, v182
  v_dot2c_f32_bf16 v41, s3, v183
  v_dot2c_f32_bf16 v43, v183, v183
  buffer_load_dwordx4 v29, s[4:7], s100 offen offset:1024 lds
  s_waitcnt lgkmcnt(5)
  v_dot2c_f32_bf16 v36, s3, v184
  v_dot2c_f32_bf16 v38, v184, v184
  v_dot2c_f32_bf16 v37, s3, v185
  v_dot2c_f32_bf16 v39, v185, v185
  v_dot2c_f32_bf16 v40, s3, v186
  v_dot2c_f32_bf16 v42, v186, v186
  v_dot2c_f32_bf16 v41, s3, v187
  v_dot2c_f32_bf16 v43, v187, v187
  buffer_load_dwordx4 v30, s[4:7], s100 offen offset:2048 lds
  s_waitcnt lgkmcnt(4)
  v_dot2c_f32_bf16 v36, s3, v188
  v_dot2c_f32_bf16 v38, v188, v188
  v_dot2c_f32_bf16 v37, s3, v189
  v_dot2c_f32_bf16 v39, v189, v189
  v_dot2c_f32_bf16 v40, s3, v190
  v_dot2c_f32_bf16 v42, v190, v190
  v_dot2c_f32_bf16 v41, s3, v191
  v_dot2c_f32_bf16 v43, v191, v191
  buffer_load_dwordx4 v31, s[4:7], s100 offen offset:3072 lds
  s_waitcnt vmcnt(8)
  ds_read_b128 v[208:211], v32 offset:4096
  ds_read_b128 v[212:215], v33 offset:4096
  ds_read_b128 v[216:219], v34 offset:4096
  ds_read_b128 v[220:223], v35 offset:4096
  s_waitcnt lgkmcnt(7)
  v_dot2c_f32_bf16 v36, s3, v192
  v_dot2c_f32_bf16 v38, v192, v192
  v_dot2c_f32_bf16 v37, s3, v193
  v_dot2c_f32_bf16 v39, v193, v193
  v_dot2c_f32_bf16 v40, s3, v194
  v_dot2c_f32_bf16 v42, v194, v194
  v_dot2c_f32_bf16 v41, s3, v195
  v_dot2c_f32_bf16 v43, v195, v195
  s_add_u32 m0, s46, 4288
  s_mul_i32 s44, s62, 4608
  s_add_u32 s44, s44, s82
  buffer_load_dwordx4 v16, s[12:15], s44 offen offset:0 lds
  s_waitcnt lgkmcnt(6)
  v_dot2c_f32_bf16 v36, s3, v196
  v_dot2c_f32_bf16 v38, v196, v196
  v_dot2c_f32_bf16 v37, s3, v197
  v_dot2c_f32_bf16 v39, v197, v197
  v_dot2c_f32_bf16 v40, s3, v198
  v_dot2c_f32_bf16 v42, v198, v198
  v_dot2c_f32_bf16 v41, s3, v199
  v_dot2c_f32_bf16 v43, v199, v199
  buffer_load_dwordx4 v17, s[12:15], s44 offen offset:1088 lds
  s_waitcnt lgkmcnt(5)
  v_dot2c_f32_bf16 v36, s3, v200
  v_dot2c_f32_bf16 v38, v200, v200
  v_dot2c_f32_bf16 v37, s3, v201
  v_dot2c_f32_bf16 v39, v201, v201
  v_dot2c_f32_bf16 v40, s3, v202
  v_dot2c_f32_bf16 v42, v202, v202
  v_dot2c_f32_bf16 v41, s3, v203
  v_dot2c_f32_bf16 v43, v203, v203
  buffer_load_dwordx4 v18, s[12:15], s44 offen offset:2176 lds
  s_waitcnt lgkmcnt(4)
  v_dot2c_f32_bf16 v36, s3, v204
  v_dot2c_f32_bf16 v38, v204, v204
  v_dot2c_f32_bf16 v37, s3, v205
  v_dot2c_f32_bf16 v39, v205, v205
  v_dot2c_f32_bf16 v40, s3, v206
  v_dot2c_f32_bf16 v42, v206, v206
  v_dot2c_f32_bf16 v41, s3, v207
  v_dot2c_f32_bf16 v43, v207, v207
  buffer_load_dwordx4 v19, s[12:15], s44 offen offset:3264 lds
  s_waitcnt vmcnt(8)
  ds_read_b128 v[224:227], v32 offset:8192
  ds_read_b128 v[228:231], v33 offset:8192
  ds_read_b128 v[232:235], v34 offset:8192
  ds_read_b128 v[236:239], v35 offset:8192
  s_waitcnt lgkmcnt(7)
  v_dot2c_f32_bf16 v36, s3, v208
  v_dot2c_f32_bf16 v38, v208, v208
  v_dot2c_f32_bf16 v37, s3, v209
  v_dot2c_f32_bf16 v39, v209, v209
  v_dot2c_f32_bf16 v40, s3, v210
  v_dot2c_f32_bf16 v42, v210, v210
  v_dot2c_f32_bf16 v41, s3, v211
  v_dot2c_f32_bf16 v43, v211, v211
  s_add_u32 m0, s46, 38592
  s_mul_i32 s44, s63, 4608
  s_add_u32 s44, s44, s82
  buffer_load_dwordx4 v16, s[12:15], s44 offen offset:0 lds
  s_waitcnt lgkmcnt(6)
  v_dot2c_f32_bf16 v36, s3, v212
  v_dot2c_f32_bf16 v38, v212, v212
  v_dot2c_f32_bf16 v37, s3, v213
  v_dot2c_f32_bf16 v39, v213, v213
  v_dot2c_f32_bf16 v40, s3, v214
  v_dot2c_f32_bf16 v42, v214, v214
  v_dot2c_f32_bf16 v41, s3, v215
  v_dot2c_f32_bf16 v43, v215, v215
  buffer_load_dwordx4 v17, s[12:15], s44 offen offset:1088 lds
  s_waitcnt lgkmcnt(5)
  v_dot2c_f32_bf16 v36, s3, v216
  v_dot2c_f32_bf16 v38, v216, v216
  v_dot2c_f32_bf16 v37, s3, v217
  v_dot2c_f32_bf16 v39, v217, v217
  v_dot2c_f32_bf16 v40, s3, v218
  v_dot2c_f32_bf16 v42, v218, v218
  v_dot2c_f32_bf16 v41, s3, v219
  v_dot2c_f32_bf16 v43, v219, v219
  buffer_load_dwordx4 v18, s[12:15], s44 offen offset:2176 lds
  s_waitcnt lgkmcnt(4)
  v_dot2c_f32_bf16 v36, s3, v220
  v_dot2c_f32_bf16 v38, v220, v220
  v_dot2c_f32_bf16 v37, s3, v221
  v_dot2c_f32_bf16 v39, v221, v221
  v_dot2c_f32_bf16 v40, s3, v222
  v_dot2c_f32_bf16 v42, v222, v222
  v_dot2c_f32_bf16 v41, s3, v223
  v_dot2c_f32_bf16 v43, v223, v223
  buffer_load_dwordx4 v19, s[12:15], s44 offen offset:3264 lds
  s_waitcnt vmcnt(8)
  ds_read_b128 v[240:243], v32 offset:12288
  ds_read_b128 v[244:247], v33 offset:12288
  ds_read_b128 v[248:251], v34 offset:12288
  ds_read_b128 v[252:255], v35 offset:12288
  s_waitcnt lgkmcnt(7)
  v_dot2c_f32_bf16 v36, s3, v224
  v_dot2c_f32_bf16 v38, v224, v224
  v_dot2c_f32_bf16 v37, s3, v225
  v_dot2c_f32_bf16 v39, v225, v225
  v_dot2c_f32_bf16 v40, s3, v226
  v_dot2c_f32_bf16 v42, v226, v226
  v_dot2c_f32_bf16 v41, s3, v227
  v_dot2c_f32_bf16 v43, v227, v227
  s_add_u32 m0, s46, 0
  s_mul_i32 s44, s62, 1728
  s_add_u32 s44, s44, s81
  buffer_load_dwordx4 v12, s[8:11], s44 offen offset:0 lds
  s_waitcnt lgkmcnt(6)
  v_dot2c_f32_bf16 v36, s3, v228
  v_dot2c_f32_bf16 v38, v228, v228
  v_dot2c_f32_bf16 v37, s3, v229
  v_dot2c_f32_bf16 v39, v229, v229
  v_dot2c_f32_bf16 v40, s3, v230
  v_dot2c_f32_bf16 v42, v230, v230
  v_dot2c_f32_bf16 v41, s3, v231
  v_dot2c_f32_bf16 v43, v231, v231
  buffer_load_dwordx4 v13, s[8:11], s44 offen offset:1088 lds
  s_waitcnt lgkmcnt(5)
  v_dot2c_f32_bf16 v36, s3, v232
  v_dot2c_f32_bf16 v38, v232, v232
  v_dot2c_f32_bf16 v37, s3, v233
  v_dot2c_f32_bf16 v39, v233, v233
  v_dot2c_f32_bf16 v40, s3, v234
  v_dot2c_f32_bf16 v42, v234, v234
  v_dot2c_f32_bf16 v41, s3, v235
  v_dot2c_f32_bf16 v43, v235, v235
  buffer_load_dwordx4 v14, s[8:11], s44 offen offset:2176 lds
  s_waitcnt lgkmcnt(4)
  v_dot2c_f32_bf16 v36, s3, v236
  v_dot2c_f32_bf16 v38, v236, v236
  v_dot2c_f32_bf16 v37, s3, v237
  v_dot2c_f32_bf16 v39, v237, v237
  v_dot2c_f32_bf16 v40, s3, v238
  v_dot2c_f32_bf16 v42, v238, v238
  v_dot2c_f32_bf16 v41, s3, v239
  v_dot2c_f32_bf16 v43, v239, v239
  buffer_load_dwordx4 v15, s[8:11], s44 offen offset:3264 lds
  s_waitcnt lgkmcnt(0)
  v_dot2c_f32_bf16 v36, s3, v240
  v_dot2c_f32_bf16 v38, v240, v240
  v_dot2c_f32_bf16 v37, s3, v241
  v_dot2c_f32_bf16 v39, v241, v241
  v_dot2c_f32_bf16 v40, s3, v242
  v_dot2c_f32_bf16 v42, v242, v242
  v_dot2c_f32_bf16 v41, s3, v243
  v_dot2c_f32_bf16 v43, v243, v243
  v_dot2c_f32_bf16 v36, s3, v244
  v_dot2c_f32_bf16 v38, v244, v244
  v_dot2c_f32_bf16 v37, s3, v245
  v_dot2c_f32_bf16 v39, v245, v245
  v_dot2c_f32_bf16 v40, s3, v246
  v_dot2c_f32_bf16 v42, v246, v246
  v_dot2c_f32_bf16 v41, s3, v247
  v_dot2c_f32_bf16 v43, v247, v247
  v_dot2c_f32_bf16 v36, s3, v248
  v_dot2c_f32_bf16 v38, v248, v248
  v_dot2c_f32_bf16 v37, s3, v249
  v_dot2c_f32_bf16 v39, v249, v249
  v_dot2c_f32_bf16 v40, s3, v250
  v_dot2c_f32_bf16 v42, v250, v250
  v_dot2c_f32_bf16 v41, s3, v251
  v_dot2c_f32_bf16 v43, v251, v251
  v_dot2c_f32_bf16 v36, s3, v252
  v_dot2c_f32_bf16 v38, v252, v252
  v_dot2c_f32_bf16 v37, s3, v253
  v_dot2c_f32_bf16 v39, v253, v253
  v_dot2c_f32_bf16 v40, s3, v254
  v_dot2c_f32_bf16 v42, v254, v254
  v_dot2c_f32_bf16 v41, s3, v255
  v_dot2c_f32_bf16 v43, v255, v255
  v_add_f32 v36, v36, v40
  s_nop 0
  v_add_f32 v37, v37, v41
  v_add_f32 v38, v38, v42
  v_add_f32 v39, v39, v43
  v_add_f32 v36, v36, v37
  v_add_f32 v38, v38, v39
  v_mov_b32 v37, v36
  v_mov_b32 v39, v38
  s_nop 0
  v_permlane32_swap_b32 v36, v37
  v_permlane32_swap_b32 v38, v39
  v_add_f32 v36, v36, v37
  v_add_f32 v38, v38, v39
  v_mul_f32 v36, 0x3ae38e39, v36
  v_mul_f32 v38, 0x3ae38e39, v38
  v_fma_f32 v38, -v36, v36, v38
  v_max_f32 v38, 0, v38
  v_add_f32 v38, 0x3727c5ac, v38
  v_rsq_f32 v24, v38
  s_nop 0
  v_mul_f32_e64 v25, -v36, v24
  v_lshlrev_b32 v96, 16, v116
  v_and_b32 v97, s95, v116
  v_lshlrev_b32 v98, 16, v117
  v_and_b32 v99, s95, v117
  v_lshlrev_b32 v100, 16, v118
  v_and_b32 v101, s95, v118
  v_lshlrev_b32 v102, 16, v119
  v_and_b32 v103, s95, v119
  v_fma_f32 v96, v96, v24, v25
  v_fma_f32 v97, v97, v24, v25
  v_fma_f32 v98, v98, v24, v25
  v_fma_f32 v99, v99, v24, v25
  v_fma_f32 v100, v100, v24, v25
  v_fma_f32 v101, v101, v24, v25
  v_fma_f32 v102, v102, v24, v25
  v_fma_f32 v103, v103, v24, v25
  v_cvt_pk_bf16_f32 v116, v96, v97
  v_cvt_pk_bf16_f32 v117, v98, v99
  v_cvt_pk_bf16_f32 v118, v100, v101
  v_cvt_pk_bf16_f32 v119, v102, v103
  v_lshlrev_b32 v96, 16, v120
  v_and_b32 v97, s95, v120
  v_lshlrev_b32 v98, 16, v121
  v_and_b32 v99, s95, v121
  v_lshlrev_b32 v100, 16, v122
  v_and_b32 v101, s95, v122
  v_lshlrev_b32 v102, 16, v123
  v_and_b32 v103, s95, v123
  v_fma_f32 v96, v96, v24, v25
  v_fma_f32 v97, v97, v24, v25
  v_fma_f32 v98, v98, v24, v25
  v_fma_f32 v99, v99, v24, v25
  v_fma_f32 v100, v100, v24, v25
  v_fma_f32 v101, v101, v24, v25
  v_fma_f32 v102, v102, v24, v25
  v_fma_f32 v103, v103, v24, v25
  v_cvt_pk_bf16_f32 v120, v96, v97
  v_cvt_pk_bf16_f32 v121, v98, v99
  v_cvt_pk_bf16_f32 v122, v100, v101
  v_cvt_pk_bf16_f32 v123, v102, v103
  v_lshlrev_b32 v96, 16, v124
  v_and_b32 v97, s95, v124
  v_lshlrev_b32 v98, 16, v125
  v_and_b32 v99, s95, v125
  v_lshlrev_b32 v100, 16, v126
  v_and_b32 v101, s95, v126
  v_lshlrev_b32 v102, 16, v127
  v_and_b32 v103, s95, v127
  v_fma_f32 v96, v96, v24, v25
  v_fma_f32 v97, v97, v24, v25
  v_fma_f32 v98, v98, v24, v25
  v_fma_f32 v99, v99, v24, v25
  v_fma_f32 v100, v100, v24, v25
  v_fma_f32 v101, v101, v24, v25
  v_fma_f32 v102, v102, v24, v25
  v_fma_f32 v103, v103, v24, v25
  v_cvt_pk_bf16_f32 v124, v96, v97
  v_cvt_pk_bf16_f32 v125, v98, v99
  v_cvt_pk_bf16_f32 v126, v100, v101
  v_cvt_pk_bf16_f32 v127, v102, v103
  v_lshlrev_b32 v96, 16, v128
  v_and_b32 v97, s95, v128
  v_lshlrev_b32 v98, 16, v129
  v_and_b32 v99, s95, v129
  v_lshlrev_b32 v100, 16, v130
  v_and_b32 v101, s95, v130
  v_lshlrev_b32 v102, 16, v131
  v_and_b32 v103, s95, v131
  v_fma_f32 v96, v96, v24, v25
  v_fma_f32 v97, v97, v24, v25
  v_fma_f32 v98, v98, v24, v25
  v_fma_f32 v99, v99, v24, v25
  v_fma_f32 v100, v100, v24, v25
  v_fma_f32 v101, v101, v24, v25
  v_fma_f32 v102, v102, v24, v25
  v_fma_f32 v103, v103, v24, v25
  v_cvt_pk_bf16_f32 v128, v96, v97
  v_cvt_pk_bf16_f32 v129, v98, v99
  v_cvt_pk_bf16_f32 v130, v100, v101
  v_cvt_pk_bf16_f32 v131, v102, v103
  v_lshlrev_b32 v96, 16, v132
  v_and_b32 v97, s95, v132
  v_lshlrev_b32 v98, 16, v133
  v_and_b32 v99, s95, v133
  v_lshlrev_b32 v100, 16, v134
  v_and_b32 v101, s95, v134
  v_lshlrev_b32 v102, 16, v135
  v_and_b32 v103, s95, v135
  v_fma_f32 v96, v96, v24, v25
  v_fma_f32 v97, v97, v24, v25
  v_fma_f32 v98, v98, v24, v25
  v_fma_f32 v99, v99, v24, v25
  v_fma_f32 v100, v100, v24, v25
  v_fma_f32 v101, v101, v24, v25
  v_fma_f32 v102, v102, v24, v25
  v_fma_f32 v103, v103, v24, v25
  v_cvt_pk_bf16_f32 v132, v96, v97
  v_cvt_pk_bf16_f32 v133, v98, v99
  v_cvt_pk_bf16_f32 v134, v100, v101
  v_cvt_pk_bf16_f32 v135, v102, v103
  v_lshlrev_b32 v96, 16, v112
  v_and_b32 v97, s95, v112
  v_lshlrev_b32 v98, 16, v113
  v_and_b32 v99, s95, v113
  v_lshlrev_b32 v100, 16, v114
  v_and_b32 v101, s95, v114
  v_lshlrev_b32 v102, 16, v115
  v_and_b32 v103, s95, v115
  s_waitcnt vmcnt(8)
  s_barrier
  ds_read_b64_tr_b16 a[208:209], v6 offset:4288
  ds_read_b64_tr_b16 a[210:211], v6 offset:4544
  ds_read_b64_tr_b16 a[212:213], v6 offset:4352
  ds_read_b64_tr_b16 a[214:215], v6 offset:4608
  ds_read_b64_tr_b16 a[216:217], v6 offset:4416
  ds_read_b64_tr_b16 a[218:219], v6 offset:4672
  ds_read_b64_tr_b16 a[220:221], v6 offset:4480
  ds_read_b64_tr_b16 a[222:223], v6 offset:4736
  ds_read_b64_tr_b16 a[224:225], v6 offset:12864
  ds_read_b64_tr_b16 a[226:227], v6 offset:13120
  ds_read_b64_tr_b16 a[228:229], v6 offset:12928
  ds_read_b64_tr_b16 a[230:231], v6 offset:13184
  ds_read_b64_tr_b16 a[232:233], v6 offset:12992
  ds_read_b64_tr_b16 a[234:235], v6 offset:13248
  v_fma_f32 v96, v96, v24, v25
  v_fma_f32 v97, v97, v24, v25
  v_fma_f32 v98, v98, v24, v25
  v_fma_f32 v99, v99, v24, v25
  v_fma_f32 v100, v100, v24, v25
  v_fma_f32 v101, v101, v24, v25
  v_fma_f32 v102, v102, v24, v25
  v_fma_f32 v103, v103, v24, v25
  v_cvt_pk_bf16_f32 v112, v96, v97
  v_cvt_pk_bf16_f32 v113, v98, v99
  v_cvt_pk_bf16_f32 v114, v100, v101
  v_cvt_pk_bf16_f32 v115, v102, v103
  s_branch L_al
.p2align 12
L_al:
L_pg0:
  s_cbranch_execz L_pg4
  s_waitcnt lgkmcnt(6)
  s_nop 0
  v_mfma_f32_32x32x16_bf16 a[64:79], a[208:211], v[112:115], 0
  ds_read_b64_tr_b16 a[236:237], v6 offset:13056
  ds_read_b64_tr_b16 a[238:239], v6 offset:13312
  s_add_u32 m0, s46, 72896
  s_mul_i32 s44, s64, 4608
  s_add_u32 s44, s44, s82
  v_lshlrev_b32 v96, 16, v136
  v_and_b32 v97, s95, v136
  v_mfma_f32_32x32x16_bf16 a[80:95], a[212:215], v[112:115], 0
  buffer_load_dwordx4 v16, s[12:15], s44 offen offset:0 lds
  ds_read_b64_tr_b16 a[208:209], v6 offset:21440
  ds_read_b64_tr_b16 a[210:211], v6 offset:21696
  v_lshlrev_b32 v98, 16, v137
  v_and_b32 v99, s95, v137
  v_lshlrev_b32 v100, 16, v138
  v_and_b32 v101, s95, v138
  v_mfma_f32_32x32x16_bf16 a[96:111], a[216:219], v[112:115], 0
  ds_read_b64_tr_b16 a[212:213], v6 offset:21504
  ds_read_b64_tr_b16 a[214:215], v6 offset:21760
  v_lshlrev_b32 v102, 16, v139
  v_and_b32 v103, s95, v139
  v_fma_f32 v96, v96, v24, v25
  v_fma_f32 v97, v97, v24, v25
  v_fma_f32 v98, v98, v24, v25
  v_mfma_f32_32x32x16_bf16 a[112:127], a[220:223], v[112:115], 0
  buffer_load_dwordx4 v17, s[12:15], s44 offen offset:1088 lds
  ds_read_b64_tr_b16 a[216:217], v6 offset:21568
  ds_read_b64_tr_b16 a[218:219], v6 offset:21824
  v_fma_f32 v99, v99, v24, v25
  v_fma_f32 v100, v100, v24, v25
  v_fma_f32 v101, v101, v24, v25
  v_fma_f32 v102, v102, v24, v25
  s_waitcnt lgkmcnt(6)
  v_mfma_f32_32x32x16_bf16 a[64:79], a[224:227], v[116:119], a[64:79]
  buffer_load_dwordx4 v18, s[12:15], s44 offen offset:2176 lds
  ds_read_b64_tr_b16 a[220:221], v6 offset:21632
  ds_read_b64_tr_b16 a[222:223], v6 offset:21888
  v_fma_f32 v103, v103, v24, v25
  v_cvt_pk_bf16_f32 v136, v96, v97
  v_cvt_pk_bf16_f32 v137, v98, v99
  v_cvt_pk_bf16_f32 v138, v100, v101
  v_mfma_f32_32x32x16_bf16 a[80:95], a[228:231], v[116:119], a[80:95]
  ds_read_b64_tr_b16 a[224:225], v6 offset:30016
  ds_read_b64_tr_b16 a[226:227], v6 offset:30272
  v_cvt_pk_bf16_f32 v139, v102, v103
  v_lshlrev_b32 v96, 16, v140
  v_and_b32 v97, s95, v140
  v_lshlrev_b32 v98, 16, v141
  v_and_b32 v99, s95, v141
  v_mfma_f32_32x32x16_bf16 a[96:111], a[232:235], v[116:119], a[96:111]
  buffer_load_dwordx4 v19, s[12:15], s44 offen offset:3264 lds
  ds_read_b64_tr_b16 a[228:229], v6 offset:30080
  ds_read_b64_tr_b16 a[230:231], v6 offset:30336
  v_lshlrev_b32 v100, 16, v142
  v_and_b32 v101, s95, v142
  v_lshlrev_b32 v102, 16, v143
  v_and_b32 v103, s95, v143
  v_mfma_f32_32x32x16_bf16 a[112:127], a[236:239], v[116:119], a[112:127]
  ds_read_b64_tr_b16 a[232:233], v6 offset:30144
  ds_read_b64_tr_b16 a[234:235], v6 offset:30400
  s_add_u32 m0, s46, 34304
  s_mul_i32 s44, s63, 1728
  s_add_u32 s44, s44, s81
  v_fma_f32 v96, v96, v24, v25
  v_fma_f32 v97, v97, v24, v25
  s_waitcnt lgkmcnt(6)
  v_mfma_f32_32x32x16_bf16 a[64:79], a[208:211], v[120:123], a[64:79]
  buffer_load_dwordx4 v12, s[8:11], s44 offen offset:0 lds
  ds_read_b64_tr_b16 a[236:237], v6 offset:30208
  ds_read_b64_tr_b16 a[238:239], v6 offset:30464
  v_fma_f32 v98, v98, v24, v25
  v_fma_f32 v99, v99, v24, v25
  v_fma_f32 v100, v100, v24, v25
  v_fma_f32 v101, v101, v24, v25
  s_waitcnt vmcnt(9)
  s_barrier
  v_mfma_f32_32x32x16_bf16 a[80:95], a[212:215], v[120:123], a[80:95]
  ds_read_b64_tr_b16 a[208:209], v6 offset:38592
  ds_read_b64_tr_b16 a[210:211], v6 offset:38848
  v_fma_f32 v102, v102, v24, v25
  v_fma_f32 v103, v103, v24, v25
  v_cvt_pk_bf16_f32 v140, v96, v97
  v_cvt_pk_bf16_f32 v141, v98, v99
  v_cvt_pk_bf16_f32 v142, v100, v101
  v_mfma_f32_32x32x16_bf16 a[96:111], a[216:219], v[120:123], a[96:111]
  ds_read_b64_tr_b16 a[212:213], v6 offset:38656
  ds_read_b64_tr_b16 a[214:215], v6 offset:38912
  v_cvt_pk_bf16_f32 v143, v102, v103
  v_lshlrev_b32 v96, 16, v144
  v_and_b32 v97, s95, v144
  v_lshlrev_b32 v98, 16, v145
  v_and_b32 v99, s95, v145
  v_mfma_f32_32x32x16_bf16 a[112:127], a[220:223], v[120:123], a[112:127]
  ds_read_b64_tr_b16 a[216:217], v6 offset:38720
  ds_read_b64_tr_b16 a[218:219], v6 offset:38976
  v_lshlrev_b32 v100, 16, v146
  v_and_b32 v101, s95, v146
  v_lshlrev_b32 v102, 16, v147
  v_and_b32 v103, s95, v147
  v_fma_f32 v96, v96, v24, v25
  s_waitcnt lgkmcnt(6)
  v_mfma_f32_32x32x16_bf16 a[64:79], a[224:227], v[124:127], a[64:79]
  buffer_load_dwordx4 v13, s[8:11], s44 offen offset:1088 lds
  ds_read_b64_tr_b16 a[220:221], v6 offset:38784
  ds_read_b64_tr_b16 a[222:223], v6 offset:39040
  v_fma_f32 v97, v97, v24, v25
  v_fma_f32 v98, v98, v24, v25
  v_fma_f32 v99, v99, v24, v25
  v_fma_f32 v100, v100, v24, v25
  v_mfma_f32_32x32x16_bf16 a[80:95], a[228:231], v[124:127], a[80:95]
  ds_read_b64_tr_b16 a[224:225], v6 offset:47168
  ds_read_b64_tr_b16 a[226:227], v6 offset:47424
  v_fma_f32 v101, v101, v24, v25
  v_fma_f32 v102, v102, v24, v25
  v_fma_f32 v103, v103, v24, v25
  v_cvt_pk_bf16_f32 v144, v96, v97
  v_cvt_pk_bf16_f32 v145, v98, v99
  v_mfma_f32_32x32x16_bf16 a[96:111], a[232:235], v[124:127], a[96:111]
  ds_read_b64_tr_b16 a[228:229], v6 offset:47232
  ds_read_b64_tr_b16 a[230:231], v6 offset:47488
  v_cvt_pk_bf16_f32 v146, v100, v101
  v_cvt_pk_bf16_f32 v147, v102, v103
  v_lshlrev_b32 v96, 16, v148
  v_and_b32 v97, s95, v148
  v_lshlrev_b32 v98, 16, v149
  v_mfma_f32_32x32x16_bf16 a[112:127], a[236:239], v[124:127], a[112:127]
  ds_read_b64_tr_b16 a[232:233], v6 offset:47296
  ds_read_b64_tr_b16 a[234:235], v6 offset:47552
  v_and_b32 v99, s95, v149
  v_lshlrev_b32 v100, 16, v150
  v_and_b32 v101, s95, v150
  v_lshlrev_b32 v102, 16, v151
  v_and_b32 v103, s95, v151
  s_waitcnt lgkmcnt(6)
  v_mfma_f32_32x32x16_bf16 a[64:79], a[208:211], v[128:131], a[64:79]
  buffer_load_dwordx4 v14, s[8:11], s44 offen offset:2176 lds
  ds_read_b64_tr_b16 a[236:237], v6 offset:47360
  ds_read_b64_tr_b16 a[238:239], v6 offset:47616
  v_fma_f32 v96, v96, v24, v25
  v_fma_f32 v97, v97, v24, v25
  v_fma_f32 v98, v98, v24, v25
  v_fma_f32 v99, v99, v24, v25
  v_mfma_f32_32x32x16_bf16 a[80:95], a[212:215], v[128:131], a[80:95]
  ds_read_b64_tr_b16 a[208:209], v6 offset:55744
  ds_read_b64_tr_b16 a[210:211], v6 offset:56000
  v_fma_f32 v100, v100, v24, v25
  v_fma_f32 v101, v101, v24, v25
  v_fma_f32 v102, v102, v24, v25
  v_fma_f32 v103, v103, v24, v25
  v_cvt_pk_bf16_f32 v148, v96, v97
  v_mfma_f32_32x32x16_bf16 a[96:111], a[216:219], v[128:131], a[96:111]
  ds_read_b64_tr_b16 a[212:213], v6 offset:55808
  ds_read_b64_tr_b16 a[214:215], v6 offset:56064
  v_cvt_pk_bf16_f32 v149, v98, v99
  v_cvt_pk_bf16_f32 v150, v100, v101
  v_cvt_pk_bf16_f32 v151, v102, v103
  v_lshlrev_b32 v96, 16, v152
  v_and_b32 v97, s95, v152
  v_mfma_f32_32x32x16_bf16 a[112:127], a[220:223], v[128:131], a[112:127]
  ds_read_b64_tr_b16 a[216:217], v6 offset:55872
  ds_read_b64_tr_b16 a[218:219], v6 offset:56128
  v_lshlrev_b32 v98, 16, v153
  v_and_b32 v99, s95, v153
  v_lshlrev_b32 v100, 16, v154
  v_and_b32 v101, s95, v154
  v_lshlrev_b32 v102, 16, v155
  s_waitcnt lgkmcnt(6)
  v_mfma_f32_32x32x16_bf16 a[64:79], a[224:227], v[132:135], a[64:79]
  ds_read_b64_tr_b16 a[220:221], v6 offset:55936
  ds_read_b64_tr_b16 a[222:223], v6 offset:56192
  v_and_b32 v103, s95, v155
  v_fma_f32 v96, v96, v24, v25
  v_fma_f32 v97, v97, v24, v25
  v_fma_f32 v98, v98, v24, v25
  v_fma_f32 v99, v99, v24, v25
  v_mfma_f32_32x32x16_bf16 a[80:95], a[228:231], v[132:135], a[80:95]
  buffer_load_dwordx4 v15, s[8:11], s44 offen offset:3264 lds
  ds_read_b64_tr_b16 a[224:225], v6 offset:64320
  ds_read_b64_tr_b16 a[226:227], v6 offset:64576
  v_fma_f32 v100, v100, v24, v25
  v_fma_f32 v101, v101, v24, v25
  v_fma_f32 v102, v102, v24, v25
  v_fma_f32 v103, v103, v24, v25
  v_mfma_f32_32x32x16_bf16 a[96:111], a[232:235], v[132:135], a[96:111]
  ds_read_b64_tr_b16 a[228:229], v6 offset:64384
  ds_read_b64_tr_b16 a[230:231], v6 offset:64640
  s_add_u32 m0, s46, 68608
  s_mul_i32 s44, s64, 1728
  s_add_u32 s44, s44, s81
  v_cvt_pk_bf16_f32 v152, v96, v97
  v_cvt_pk_bf16_f32 v153, v98, v99
  v_mfma_f32_32x32x16_bf16 a[112:127], a[236:239], v[132:135], a[112:127]
  ds_read_b64_tr_b16 a[232:233], v6 offset:64448
  ds_read_b64_tr_b16 a[234:235], v6 offset:64704
  v_cvt_pk_bf16_f32 v154, v100, v101
  v_cvt_pk_bf16_f32 v155, v102, v103
  v_lshlrev_b32 v96, 16, v156
  v_and_b32 v97, s95, v156
  v_lshlrev_b32 v98, 16, v157
  s_waitcnt lgkmcnt(6)
  v_mfma_f32_32x32x16_bf16 a[64:79], a[208:211], v[136:139], a[64:79]
  ds_read_b64_tr_b16 a[236:237], v6 offset:64512
  ds_read_b64_tr_b16 a[238:239], v6 offset:64768
  v_and_b32 v99, s95, v157
  v_lshlrev_b32 v100, 16, v158
  v_and_b32 v101, s95, v158
  v_lshlrev_b32 v102, 16, v159
  v_and_b32 v103, s95, v159
  s_waitcnt vmcnt(4)
  s_barrier
  v_mfma_f32_32x32x16_bf16 a[80:95], a[212:215], v[136:139], a[80:95]
  buffer_load_dwordx4 v12, s[8:11], s44 offen offset:0 lds
  v_add_u32 v6, 0x11800, v6
  ds_read_b64_tr_b16 a[208:209], v6 offset:1216
  ds_read_b64_tr_b16 a[210:211], v6 offset:1472
  v_fma_f32 v96, v96, v24, v25
  v_fma_f32 v97, v97, v24, v25
  v_fma_f32 v98, v98, v24, v25
  v_mfma_f32_32x32x16_bf16 a[96:111], a[216:219], v[136:139], a[96:111]
  ds_read_b64_tr_b16 a[212:213], v6 offset:1280
  ds_read_b64_tr_b16 a[214:215], v6 offset:1536
  v_fma_f32 v99, v99, v24, v25
  v_fma_f32 v100, v100, v24, v25
  v_fma_f32 v101, v101, v24, v25
  v_fma_f32 v102, v102, v24, v25
  v_fma_f32 v103, v103, v24, v25
  v_mfma_f32_32x32x16_bf16 a[112:127], a[220:223], v[136:139], a[112:127]
  ds_read_b64_tr_b16 a[216:217], v6 offset:1344
  ds_read_b64_tr_b16 a[218:219], v6 offset:1600
  v_cvt_pk_bf16_f32 v156, v96, v97
  v_cvt_pk_bf16_f32 v157, v98, v99
  v_cvt_pk_bf16_f32 v158, v100, v101
  v_cvt_pk_bf16_f32 v159, v102, v103
  s_waitcnt lgkmcnt(6)
  v_mfma_f32_32x32x16_bf16 a[64:79], a[224:227], v[140:143], a[64:79]
  ds_read_b64_tr_b16 a[220:221], v6 offset:1408
  ds_read_b64_tr_b16 a[222:223], v6 offset:1664
  v_mfma_f32_32x32x16_bf16 a[80:95], a[228:231], v[140:143], a[80:95]
  ds_read_b64_tr_b16 a[224:225], v6 offset:9792
  ds_read_b64_tr_b16 a[226:227], v6 offset:10048
  v_mfma_f32_32x32x16_bf16 a[96:111], a[232:235], v[140:143], a[96:111]
  buffer_load_dwordx4 v13, s[8:11], s44 offen offset:1088 lds
  ds_read_b64_tr_b16 a[228:229], v6 offset:9856
  ds_read_b64_tr_b16 a[230:231], v6 offset:10112
  v_mfma_f32_32x32x16_bf16 a[112:127], a[236:239], v[140:143], a[112:127]
  ds_read_b64_tr_b16 a[232:233], v6 offset:9920
  ds_read_b64_tr_b16 a[234:235], v6 offset:10176
  s_waitcnt lgkmcnt(6)
  v_mfma_f32_32x32x16_bf16 a[64:79], a[208:211], v[144:147], a[64:79]
  ds_read_b64_tr_b16 a[236:237], v6 offset:9984
  ds_read_b64_tr_b16 a[238:239], v6 offset:10240
  v_mfma_f32_32x32x16_bf16 a[80:95], a[212:215], v[144:147], a[80:95]
  ds_read_b64_tr_b16 a[208:209], v6 offset:18368
  ds_read_b64_tr_b16 a[210:211], v6 offset:18624
  v_mfma_f32_32x32x16_bf16 a[96:111], a[216:219], v[144:147], a[96:111]
  ds_read_b64_tr_b16 a[212:213], v6 offset:18432
  ds_read_b64_tr_b16 a[214:215], v6 offset:18688
  v_mfma_f32_32x32x16_bf16 a[112:127], a[220:223], v[144:147], a[112:127]
  buffer_load_dwordx4 v14, s[8:11], s44 offen offset:2176 lds
  ds_read_b64_tr_b16 a[216:217], v6 offset:18496
  ds_read_b64_tr_b16 a[218:219], v6 offset:18752
  s_waitcnt lgkmcnt(6)
  v_mfma_f32_32x32x16_bf16 a[64:79], a[224:227], v[148:151], a[64:79]
  ds_read_b64_tr_b16 a[220:221], v6 offset:18560
  ds_read_b64_tr_b16 a[222:223], v6 offset:18816
  v_mfma_f32_32x32x16_bf16 a[80:95], a[228:231], v[148:151], a[80:95]
  ds_read_b64_tr_b16 a[224:225], v6 offset:26944
  ds_read_b64_tr_b16 a[226:227], v6 offset:27200
  v_mfma_f32_32x32x16_bf16 a[96:111], a[232:235], v[148:151], a[96:111]
  ds_read_b64_tr_b16 a[228:229], v6 offset:27008
  ds_read_b64_tr_b16 a[230:231], v6 offset:27264
  v_mfma_f32_32x32x16_bf16 a[112:127], a[236:239], v[148:151], a[112:127]
  ds_read_b64_tr_b16 a[232:233], v6 offset:27072
  ds_read_b64_tr_b16 a[234:235], v6 offset:27328
  s_waitcnt lgkmcnt(6)
  v_mfma_f32_32x32x16_bf16 a[64:79], a[208:211], v[152:155], a[64:79]
  buffer_load_dwordx4 v15, s[8:11], s44 offen offset:3264 lds
  ds_read_b64_tr_b16 a[236:237], v6 offset:27136
  ds_read_b64_tr_b16 a[238:239], v6 offset:27392
  s_barrier
  v_mfma_f32_32x32x16_bf16 a[80:95], a[212:215], v[152:155], a[80:95]
  v_add_u32 v6, 0xfffee800, v6
  ds_read_b64_tr_b16 a[208:209], v6 offset:0
  ds_read_b64_tr_b16 a[210:211], v6 offset:256
  s_add_u32 m0, s46, 102912
  s_mul_i32 s44, s65, 1728
  s_add_u32 s44, s44, s81
  v_mfma_f32_32x32x16_bf16 a[96:111], a[216:219], v[152:155], a[96:111]
  ds_read_b64_tr_b16 a[212:213], v6 offset:80
  ds_read_b64_tr_b16 a[214:215], v6 offset:336
  v_mfma_f32_32x32x16_bf16 a[112:127], a[220:223], v[152:155], a[112:127]
  ds_read_b64_tr_b16 a[216:217], v6 offset:160
  ds_read_b64_tr_b16 a[218:219], v6 offset:416
  s_waitcnt lgkmcnt(6)
  v_mfma_f32_32x32x16_bf16 a[64:79], a[224:227], v[156:159], a[64:79]
  ds_read_b64_tr_b16 a[220:221], v7 offset:0
  ds_read_b64_tr_b16 a[222:223], v7 offset:256
  v_mfma_f32_32x32x16_bf16 a[80:95], a[228:231], v[156:159], a[80:95]
  ds_read_b64_tr_b16 a[224:225], v6 offset:8576
  ds_read_b64_tr_b16 a[226:227], v6 offset:8832
  v_mfma_f32_32x32x16_bf16 a[96:111], a[232:235], v[156:159], a[96:111]
  buffer_load_dwordx4 v12, s[8:11], s44 offen offset:0 lds
  ds_read_b64_tr_b16 a[228:229], v6 offset:8656
  ds_read_b64_tr_b16 a[230:231], v6 offset:8912
  v_mfma_f32_32x32x16_bf16 a[112:127], a[236:239], v[156:159], a[112:127]
  ds_read_b64_tr_b16 a[232:233], v6 offset:8736
  ds_read_b64_tr_b16 a[234:235], v6 offset:8992
  s_waitcnt lgkmcnt(6)
  v_mfma_f32_32x32x16_bf16 a[0:15], a[208:211], v[112:115], 0
  ds_read_b64_tr_b16 a[236:237], v7 offset:8576
  ds_read_b64_tr_b16 a[238:239], v7 offset:8832
  v_mfma_f32_32x32x16_bf16 a[16:31], a[212:215], v[112:115], 0
  ds_read_b64_tr_b16 a[208:209], v6 offset:17152
  ds_read_b64_tr_b16 a[210:211], v6 offset:17408
  v_mfma_f32_32x32x16_bf16 a[32:47], a[216:219], v[112:115], 0
  ds_read_b64_tr_b16 a[212:213], v6 offset:17232
  ds_read_b64_tr_b16 a[214:215], v6 offset:17488
  v_mfma_f32_32x32x16_bf16 a[48:63], a[220:223], v[112:115], 0
  buffer_load_dwordx4 v13, s[8:11], s44 offen offset:1088 lds
  ds_read_b64_tr_b16 a[216:217], v6 offset:17312
  ds_read_b64_tr_b16 a[218:219], v6 offset:17568
  s_waitcnt lgkmcnt(6)
  v_mfma_f32_32x32x16_bf16 a[0:15], a[224:227], v[116:119], a[0:15]
  ds_read_b64_tr_b16 a[220:221], v7 offset:17152
  ds_read_b64_tr_b16 a[222:223], v7 offset:17408
  v_mfma_f32_32x32x16_bf16 a[16:31], a[228:231], v[116:119], a[16:31]
  ds_read_b64_tr_b16 a[224:225], v6 offset:25728
  ds_read_b64_tr_b16 a[226:227], v6 offset:25984
  v_mfma_f32_32x32x16_bf16 a[32:47], a[232:235], v[116:119], a[32:47]
  ds_read_b64_tr_b16 a[228:229], v6 offset:25808
  ds_read_b64_tr_b16 a[230:231], v6 offset:26064
  v_mfma_f32_32x32x16_bf16 a[48:63], a[236:239], v[116:119], a[48:63]
  ds_read_b64_tr_b16 a[232:233], v6 offset:25888
  ds_read_b64_tr_b16 a[234:235], v6 offset:26144
  s_waitcnt lgkmcnt(6)
  v_mfma_f32_32x32x16_bf16 a[0:15], a[208:211], v[120:123], a[0:15]
  buffer_load_dwordx4 v14, s[8:11], s44 offen offset:2176 lds
  ds_read_b64_tr_b16 a[236:237], v7 offset:25728
  ds_read_b64_tr_b16 a[238:239], v7 offset:25984
  v_lshlrev_b32 v96, 16, v160
  v_and_b32 v97, s95, v160
  s_waitcnt vmcnt(7)
  s_barrier
  v_mfma_f32_32x32x16_bf16 a[16:31], a[212:215], v[120:123], a[16:31]
  ds_read_b64_tr_b16 a[208:209], v6 offset:34304
  ds_read_b64_tr_b16 a[210:211], v6 offset:34560
  v_lshlrev_b32 v98, 16, v161
  v_and_b32 v99, s95, v161
  v_lshlrev_b32 v100, 16, v162
  v_mfma_f32_32x32x16_bf16 a[32:47], a[216:219], v[120:123], a[32:47]
  ds_read_b64_tr_b16 a[212:213], v6 offset:34384
  ds_read_b64_tr_b16 a[214:215], v6 offset:34640
  v_and_b32 v101, s95, v162
  v_lshlrev_b32 v102, 16, v163
  v_and_b32 v103, s95, v163
  v_mfma_f32_32x32x16_bf16 a[48:63], a[220:223], v[120:123], a[48:63]
  ds_read_b64_tr_b16 a[216:217], v6 offset:34464
  ds_read_b64_tr_b16 a[218:219], v6 offset:34720
  v_fma_f32 v96, v96, v24, v25
  v_fma_f32 v97, v97, v24, v25
  v_fma_f32 v98, v98, v24, v25
  s_waitcnt lgkmcnt(6)
  v_mfma_f32_32x32x16_bf16 a[0:15], a[224:227], v[124:127], a[0:15]
  ds_read_b64_tr_b16 a[220:221], v7 offset:34304
  ds_read_b64_tr_b16 a[222:223], v7 offset:34560
  v_fma_f32 v99, v99, v24, v25
  v_fma_f32 v100, v100, v24, v25
  v_fma_f32 v101, v101, v24, v25
  v_mfma_f32_32x32x16_bf16 a[16:31], a[228:231], v[124:127], a[16:31]
  ds_read_b64_tr_b16 a[224:225], v6 offset:42880
  ds_read_b64_tr_b16 a[226:227], v6 offset:43136
  v_fma_f32 v102, v102, v24, v25
  v_fma_f32 v103, v103, v24, v25
  v_cvt_pk_bf16_f32 v160, v96, v97
  v_mfma_f32_32x32x16_bf16 a[32:47], a[232:235], v[124:127], a[32:47]
  buffer_load_dwordx4 v15, s[8:11], s44 offen offset:3264 lds
  ds_read_b64_tr_b16 a[228:229], v6 offset:42960
  ds_read_b64_tr_b16 a[230:231], v6 offset:43216
  v_cvt_pk_bf16_f32 v161, v98, v99
  v_cvt_pk_bf16_f32 v162, v100, v101
  v_mfma_f32_32x32x16_bf16 a[48:63], a[236:239], v[124:127], a[48:63]
  ds_read_b64_tr_b16 a[232:233], v6 offset:43040
  ds_read_b64_tr_b16 a[234:235], v6 offset:43296
  s_add_u32 m0, s46, 107200
  s_mul_i32 s44, s65, 4608
  s_add_u32 s44, s44, s82
  s_waitcnt lgkmcnt(6)
  v_mfma_f32_32x32x16_bf16 a[0:15], a[208:211], v[128:131], a[0:15]
  ds_read_b64_tr_b16 a[236:237], v7 offset:42880
  ds_read_b64_tr_b16 a[238:239], v7 offset:43136
  v_cvt_pk_bf16_f32 v163, v102, v103
  v_lshlrev_b32 v96, 16, v164
  v_and_b32 v97, s95, v164
  v_mfma_f32_32x32x16_bf16 a[16:31], a[212:215], v[128:131], a[16:31]
  ds_read_b64_tr_b16 a[208:209], v6 offset:51456
  ds_read_b64_tr_b16 a[210:211], v6 offset:51712
  v_lshlrev_b32 v98, 16, v165
  v_and_b32 v99, s95, v165
  v_lshlrev_b32 v100, 16, v166
  v_mfma_f32_32x32x16_bf16 a[32:47], a[216:219], v[128:131], a[32:47]
  ds_read_b64_tr_b16 a[212:213], v6 offset:51536
  ds_read_b64_tr_b16 a[214:215], v6 offset:51792
  v_and_b32 v101, s95, v166
  v_lshlrev_b32 v102, 16, v167
  v_and_b32 v103, s95, v167
  v_mfma_f32_32x32x16_bf16 a[48:63], a[220:223], v[128:131], a[48:63]
  buffer_load_dwordx4 v16, s[12:15], s44 offen offset:0 lds
  ds_read_b64_tr_b16 a[216:217], v6 offset:51616
  ds_read_b64_tr_b16 a[218:219], v6 offset:51872
  v_fma_f32 v96, v96, v24, v25
  v_fma_f32 v97, v97, v24, v25
  s_waitcnt lgkmcnt(6)
  v_mfma_f32_32x32x16_bf16 a[0:15], a[224:227], v[132:135], a[0:15]
  ds_read_b64_tr_b16 a[220:221], v7 offset:51456
  ds_read_b64_tr_b16 a[222:223], v7 offset:51712
  v_fma_f32 v98, v98, v24, v25
  v_fma_f32 v99, v99, v24, v25
  v_fma_f32 v100, v100, v24, v25
  v_mfma_f32_32x32x16_bf16 a[16:31], a[228:231], v[132:135], a[16:31]
  buffer_load_dwordx4 v17, s[12:15], s44 offen offset:1088 lds
  ds_read_b64_tr_b16 a[224:225], v6 offset:60032
  ds_read_b64_tr_b16 a[226:227], v6 offset:60288
  v_fma_f32 v101, v101, v24, v25
  v_fma_f32 v102, v102, v24, v25
  v_mfma_f32_32x32x16_bf16 a[32:47], a[232:235], v[132:135], a[32:47]
  ds_read_b64_tr_b16 a[228:229], v6 offset:60112
  ds_read_b64_tr_b16 a[230:231], v6 offset:60368
  v_fma_f32 v103, v103, v24, v25
  v_cvt_pk_bf16_f32 v164, v96, v97
  v_cvt_pk_bf16_f32 v165, v98, v99
  v_mfma_f32_32x32x16_bf16 a[48:63], a[236:239], v[132:135], a[48:63]
  buffer_load_dwordx4 v18, s[12:15], s44 offen offset:2176 lds
  ds_read_b64_tr_b16 a[232:233], v6 offset:60192
  ds_read_b64_tr_b16 a[234:235], v6 offset:60448
  v_cvt_pk_bf16_f32 v166, v100, v101
  v_cvt_pk_bf16_f32 v167, v102, v103
  s_waitcnt lgkmcnt(6)
  v_mfma_f32_32x32x16_bf16 a[0:15], a[208:211], v[136:139], a[0:15]
  ds_read_b64_tr_b16 a[236:237], v7 offset:60032
  ds_read_b64_tr_b16 a[238:239], v7 offset:60288
  v_lshlrev_b32 v96, 16, v168
  v_and_b32 v97, s95, v168
  v_lshlrev_b32 v98, 16, v169
  s_waitcnt vmcnt(7)
  s_barrier
  v_mfma_f32_32x32x16_bf16 a[16:31], a[212:215], v[136:139], a[16:31]
  buffer_load_dwordx4 v19, s[12:15], s44 offen offset:3264 lds
  v_add_u32 v6, 0x10800, v6
  ds_read_b64_tr_b16 a[208:209], v6 offset:1024
  ds_read_b64_tr_b16 a[210:211], v6 offset:1280
  v_and_b32 v99, s95, v169
  v_mfma_f32_32x32x16_bf16 a[32:47], a[216:219], v[136:139], a[32:47]
  ds_read_b64_tr_b16 a[212:213], v6 offset:1104
  ds_read_b64_tr_b16 a[214:215], v6 offset:1360
  s_add_u32 m0, s46, 0
  s_mul_i32 s44, s66, 1728
  s_add_u32 s44, s44, s81
  v_mfma_f32_32x32x16_bf16 a[48:63], a[220:223], v[136:139], a[48:63]
  buffer_load_dwordx4 v12, s[8:11], s44 offen offset:0 lds
  ds_read_b64_tr_b16 a[216:217], v6 offset:1184
  ds_read_b64_tr_b16 a[218:219], v6 offset:1440
  v_lshlrev_b32 v100, 16, v170
  v_and_b32 v101, s95, v170
  s_waitcnt lgkmcnt(6)
  v_mfma_f32_32x32x16_bf16 a[0:15], a[224:227], v[140:143], a[0:15]
  v_add_u32 v7, 0x10800, v7
  ds_read_b64_tr_b16 a[220:221], v7 offset:1024
  ds_read_b64_tr_b16 a[222:223], v7 offset:1280
  v_lshlrev_b32 v102, 16, v171
  v_and_b32 v103, s95, v171
  v_mfma_f32_32x32x16_bf16 a[16:31], a[228:231], v[140:143], a[16:31]
  ds_read_b64_tr_b16 a[224:225], v6 offset:9600
  ds_read_b64_tr_b16 a[226:227], v6 offset:9856
  v_fma_f32 v96, v96, v24, v25
  v_fma_f32 v97, v97, v24, v25
  v_fma_f32 v98, v98, v24, v25
  v_mfma_f32_32x32x16_bf16 a[32:47], a[232:235], v[140:143], a[32:47]
  ds_read_b64_tr_b16 a[228:229], v6 offset:9680
  ds_read_b64_tr_b16 a[230:231], v6 offset:9936
  v_fma_f32 v99, v99, v24, v25
  v_fma_f32 v100, v100, v24, v25
  v_fma_f32 v101, v101, v24, v25
  v_mfma_f32_32x32x16_bf16 a[48:63], a[236:239], v[140:143], a[48:63]
  ds_read_b64_tr_b16 a[232:233], v6 offset:9760
  ds_read_b64_tr_b16 a[234:235], v6 offset:10016
  v_fma_f32 v102, v102, v24, v25
  v_fma_f32 v103, v103, v24, v25
  v_cvt_pk_bf16_f32 v168, v96, v97
  s_waitcnt lgkmcnt(6)
  v_mfma_f32_32x32x16_bf16 a[0:15], a[208:211], v[144:147], a[0:15]
  ds_read_b64_tr_b16 a[236:237], v7 offset:9600
  ds_read_b64_tr_b16 a[238:239], v7 offset:9856
  v_cvt_pk_bf16_f32 v169, v98, v99
  v_cvt_pk_bf16_f32 v170, v100, v101
  v_cvt_pk_bf16_f32 v171, v102, v103
  v_mfma_f32_32x32x16_bf16 a[16:31], a[212:215], v[144:147], a[16:31]
  buffer_load_dwordx4 v13, s[8:11], s44 offen offset:1088 lds
  ds_read_b64_tr_b16 a[208:209], v6 offset:18176
  ds_read_b64_tr_b16 a[210:211], v6 offset:18432
  v_lshlrev_b32 v96, 16, v172
  v_and_b32 v97, s95, v172
  v_mfma_f32_32x32x16_bf16 a[32:47], a[216:219], v[144:147], a[32:47]
  ds_read_b64_tr_b16 a[212:213], v6 offset:18256
  ds_read_b64_tr_b16 a[214:215], v6 offset:18512
  v_lshlrev_b32 v98, 16, v173
  v_and_b32 v99, s95, v173
  v_lshlrev_b32 v100, 16, v174
  v_mfma_f32_32x32x16_bf16 a[48:63], a[220:223], v[144:147], a[48:63]
  ds_read_b64_tr_b16 a[216:217], v6 offset:18336
  ds_read_b64_tr_b16 a[218:219], v6 offset:18592
  v_and_b32 v101, s95, v174
  v_lshlrev_b32 v102, 16, v175
  v_and_b32 v103, s95, v175
  s_waitcnt lgkmcnt(6)
  v_mfma_f32_32x32x16_bf16 a[0:15], a[224:227], v[148:151], a[0:15]
  ds_read_b64_tr_b16 a[220:221], v7 offset:18176
  ds_read_b64_tr_b16 a[222:223], v7 offset:18432
  v_fma_f32 v96, v96, v24, v25
  v_fma_f32 v97, v97, v24, v25
  v_fma_f32 v98, v98, v24, v25
  v_mfma_f32_32x32x16_bf16 a[16:31], a[228:231], v[148:151], a[16:31]
  ds_read_b64_tr_b16 a[224:225], v6 offset:26752
  ds_read_b64_tr_b16 a[226:227], v6 offset:27008
  v_fma_f32 v99, v99, v24, v25
  v_fma_f32 v100, v100, v24, v25
  v_fma_f32 v101, v101, v24, v25
  v_mfma_f32_32x32x16_bf16 a[32:47], a[232:235], v[148:151], a[32:47]
  buffer_load_dwordx4 v14, s[8:11], s44 offen offset:2176 lds
  ds_read_b64_tr_b16 a[228:229], v6 offset:26832
  ds_read_b64_tr_b16 a[230:231], v6 offset:27088
  v_fma_f32 v102, v102, v24, v25
  v_fma_f32 v103, v103, v24, v25
  v_mfma_f32_32x32x16_bf16 a[48:63], a[236:239], v[148:151], a[48:63]
  ds_read_b64_tr_b16 a[232:233], v6 offset:26912
  ds_read_b64_tr_b16 a[234:235], v6 offset:27168
  v_cvt_pk_bf16_f32 v172, v96, v97
  v_cvt_pk_bf16_f32 v173, v98, v99
  v_cvt_pk_bf16_f32 v174, v100, v101
  s_waitcnt lgkmcnt(6)
  v_mfma_f32_32x32x16_bf16 a[0:15], a[208:211], v[152:155], a[0:15]
  ds_read_b64_tr_b16 a[236:237], v7 offset:26752
  ds_read_b64_tr_b16 a[238:239], v7 offset:27008
  v_cvt_pk_bf16_f32 v175, v102, v103
  v_lshlrev_b32 v96, 16, v176
  v_and_b32 v97, s95, v176
  s_waitcnt vmcnt(3)
  s_barrier
  v_mfma_f32_32x32x16_bf16 a[16:31], a[212:215], v[152:155], a[16:31]
  ds_read_b64_tr_b16 a[208:209], v6 offset:35328
  ds_read_b64_tr_b16 a[210:211], v6 offset:35584
  v_lshlrev_b32 v98, 16, v177
  v_and_b32 v99, s95, v177
  v_lshlrev_b32 v100, 16, v178
  v_mfma_f32_32x32x16_bf16 a[32:47], a[216:219], v[152:155], a[32:47]
  ds_read_b64_tr_b16 a[212:213], v6 offset:35408
  ds_read_b64_tr_b16 a[214:215], v6 offset:35664
  v_and_b32 v101, s95, v178
  v_lshlrev_b32 v102, 16, v179
  v_and_b32 v103, s95, v179
  v_mfma_f32_32x32x16_bf16 a[48:63], a[220:223], v[152:155], a[48:63]
  buffer_load_dwordx4 v15, s[8:11], s44 offen offset:3264 lds
  ds_read_b64_tr_b16 a[216:217], v6 offset:35488
  ds_read_b64_tr_b16 a[218:219], v6 offset:35744
  v_fma_f32 v96, v96, v24, v25
  v_fma_f32 v97, v97, v24, v25
  s_waitcnt lgkmcnt(6)
  v_mfma_f32_32x32x16_bf16 a[0:15], a[224:227], v[156:159], a[0:15]
  ds_read_b64_tr_b16 a[220:221], v7 offset:35328
  ds_read_b64_tr_b16 a[222:223], v7 offset:35584
  s_add_u32 m0, s46, 4288
  s_mul_i32 s44, s66, 4608
  s_add_u32 s44, s44, s82
  v_mfma_f32_32x32x16_bf16 a[16:31], a[228:231], v[156:159], a[16:31]
  ds_read_b64_tr_b16 a[224:225], v6 offset:39616
  ds_read_b64_tr_b16 a[226:227], v6 offset:39872
  v_fma_f32 v98, v98, v24, v25
L_pg1:
  s_cbranch_execz L_pg5
  v_fma_f32 v99, v99, v24, v25
  v_fma_f32 v100, v100, v24, v25
  v_mfma_f32_32x32x16_bf16 a[32:47], a[232:235], v[156:159], a[32:47]
  ds_read_b64_tr_b16 a[228:229], v6 offset:39680
  ds_read_b64_tr_b16 a[230:231], v6 offset:39936
  v_fma_f32 v101, v101, v24, v25
  v_fma_f32 v102, v102, v24, v25
  v_fma_f32 v103, v103, v24, v25
  v_mfma_f32_32x32x16_bf16 a[48:63], a[236:239], v[156:159], a[48:63]
  ds_read_b64_tr_b16 a[232:233], v6 offset:39744
  ds_read_b64_tr_b16 a[234:235], v6 offset:40000
  v_cvt_pk_bf16_f32 v176, v96, v97
  v_cvt_pk_bf16_f32 v177, v98, v99
  v_cvt_pk_bf16_f32 v178, v100, v101
  s_waitcnt lgkmcnt(6)
  v_mfma_f32_32x32x16_bf16 a[0:15], a[208:211], v[160:163], a[0:15]
  ds_read_b64_tr_b16 a[236:237], v6 offset:39808
  ds_read_b64_tr_b16 a[238:239], v6 offset:40064
  v_cvt_pk_bf16_f32 v179, v102, v103
  v_lshlrev_b32 v96, 16, v180
  v_and_b32 v97, s95, v180
  v_mfma_f32_32x32x16_bf16 a[16:31], a[212:215], v[160:163], a[16:31]
  buffer_load_dwordx4 v16, s[12:15], s44 offen offset:0 lds
  ds_read_b64_tr_b16 a[208:209], v6 offset:43904
  ds_read_b64_tr_b16 a[210:211], v6 offset:44160
  v_lshlrev_b32 v98, 16, v181
  v_and_b32 v99, s95, v181
  v_mfma_f32_32x32x16_bf16 a[32:47], a[216:219], v[160:163], a[32:47]
  ds_read_b64_tr_b16 a[212:213], v6 offset:43984
  ds_read_b64_tr_b16 a[214:215], v6 offset:44240
  v_lshlrev_b32 v100, 16, v182
  v_and_b32 v101, s95, v182
  v_lshlrev_b32 v102, 16, v183
  v_mfma_f32_32x32x16_bf16 a[48:63], a[220:223], v[160:163], a[48:63]
  buffer_load_dwordx4 v17, s[12:15], s44 offen offset:1088 lds
  ds_read_b64_tr_b16 a[216:217], v6 offset:44064
  ds_read_b64_tr_b16 a[218:219], v6 offset:44320
  v_and_b32 v103, s95, v183
  v_fma_f32 v96, v96, v24, v25
  buffer_load_dword v26, v4, s[32:35], 0 offen sc1
  s_waitcnt lgkmcnt(6)
  v_mfma_f32_32x32x16_bf16 a[64:79], a[224:227], v[160:163], a[64:79]
  ds_read_b64_tr_b16 a[220:221], v7 offset:43904
  ds_read_b64_tr_b16 a[222:223], v7 offset:44160
  v_fma_f32 v97, v97, v24, v25
  v_fma_f32 v98, v98, v24, v25
  v_fma_f32 v99, v99, v24, v25
  v_mfma_f32_32x32x16_bf16 a[80:95], a[228:231], v[160:163], a[80:95]
  buffer_load_dwordx4 v18, s[12:15], s44 offen offset:2176 lds
  ds_read_b64_tr_b16 a[224:225], v6 offset:48192
  ds_read_b64_tr_b16 a[226:227], v6 offset:48448
  v_fma_f32 v100, v100, v24, v25
  v_fma_f32 v101, v101, v24, v25
  v_mfma_f32_32x32x16_bf16 a[96:111], a[232:235], v[160:163], a[96:111]
  ds_read_b64_tr_b16 a[228:229], v6 offset:48256
  ds_read_b64_tr_b16 a[230:231], v6 offset:48512
  v_fma_f32 v102, v102, v24, v25
  v_fma_f32 v103, v103, v24, v25
  v_cvt_pk_bf16_f32 v180, v96, v97
  v_mfma_f32_32x32x16_bf16 a[112:127], a[236:239], v[160:163], a[112:127]
  buffer_load_dwordx4 v19, s[12:15], s44 offen offset:3264 lds
  ds_read_b64_tr_b16 a[232:233], v6 offset:48320
  ds_read_b64_tr_b16 a[234:235], v6 offset:48576
  v_cvt_pk_bf16_f32 v181, v98, v99
  v_cvt_pk_bf16_f32 v182, v100, v101
  s_waitcnt lgkmcnt(6)
  v_mfma_f32_32x32x16_bf16 a[0:15], a[208:211], v[164:167], a[0:15]
  ds_read_b64_tr_b16 a[236:237], v6 offset:48384
  ds_read_b64_tr_b16 a[238:239], v6 offset:48640
  s_add_u32 m0, s47, 137216
  s_mul_i32 s45, s62, 4608
  s_add_u32 s44, s45, s83
  v_mfma_f32_32x32x16_bf16 a[16:31], a[212:215], v[164:167], a[16:31]
  ds_read_b64_tr_b16 a[208:209], v6 offset:52480
  ds_read_b64_tr_b16 a[210:211], v6 offset:52736
  v_cvt_pk_bf16_f32 v183, v102, v103
  v_lshlrev_b32 v96, 16, v184
  v_and_b32 v97, s95, v184
  v_mfma_f32_32x32x16_bf16 a[32:47], a[216:219], v[164:167], a[32:47]
  buffer_load_dwordx4 v16, s[12:15], s44 offen offset:0 lds
  ds_read_b64_tr_b16 a[212:213], v6 offset:52560
  ds_read_b64_tr_b16 a[214:215], v6 offset:52816
  v_lshlrev_b32 v98, 16, v185
  v_and_b32 v99, s95, v185
  v_mfma_f32_32x32x16_bf16 a[48:63], a[220:223], v[164:167], a[48:63]
  ds_read_b64_tr_b16 a[216:217], v6 offset:52640
  ds_read_b64_tr_b16 a[218:219], v6 offset:52896
  s_add_u32 m0, s46, 34304
  s_mul_i32 s44, s67, 1728
  s_add_u32 s44, s44, s81
  s_waitcnt lgkmcnt(6)
  v_mfma_f32_32x32x16_bf16 a[64:79], a[224:227], v[164:167], a[64:79]
  buffer_load_dwordx4 v12, s[8:11], s44 offen offset:0 lds
  ds_read_b64_tr_b16 a[220:221], v7 offset:52480
  ds_read_b64_tr_b16 a[222:223], v7 offset:52736
  v_lshlrev_b32 v100, 16, v186
  v_and_b32 v101, s95, v186
  v_mfma_f32_32x32x16_bf16 a[80:95], a[228:231], v[164:167], a[80:95]
  ds_read_b64_tr_b16 a[224:225], v6 offset:56768
  ds_read_b64_tr_b16 a[226:227], v6 offset:57024
  v_lshlrev_b32 v102, 16, v187
  v_and_b32 v103, s95, v187
  v_fma_f32 v96, v96, v24, v25
  v_mfma_f32_32x32x16_bf16 a[96:111], a[232:235], v[164:167], a[96:111]
  ds_read_b64_tr_b16 a[228:229], v6 offset:56832
  ds_read_b64_tr_b16 a[230:231], v6 offset:57088
  v_fma_f32 v97, v97, v24, v25
  v_fma_f32 v98, v98, v24, v25
  v_fma_f32 v99, v99, v24, v25
  v_mfma_f32_32x32x16_bf16 a[112:127], a[236:239], v[164:167], a[112:127]
  ds_read_b64_tr_b16 a[232:233], v6 offset:56896
  ds_read_b64_tr_b16 a[234:235], v6 offset:57152
  v_fma_f32 v100, v100, v24, v25
  v_fma_f32 v101, v101, v24, v25
  v_fma_f32 v102, v102, v24, v25
  s_waitcnt lgkmcnt(6)
  v_mfma_f32_32x32x16_bf16 a[0:15], a[208:211], v[168:171], a[0:15]
  ds_read_b64_tr_b16 a[236:237], v6 offset:56960
  ds_read_b64_tr_b16 a[238:239], v6 offset:57216
  v_fma_f32 v103, v103, v24, v25
  v_cvt_pk_bf16_f32 v184, v96, v97
  v_cvt_pk_bf16_f32 v185, v98, v99
  v_mfma_f32_32x32x16_bf16 a[16:31], a[212:215], v[168:171], a[16:31]
  buffer_load_dwordx4 v13, s[8:11], s44 offen offset:1088 lds
  ds_read_b64_tr_b16 a[208:209], v6 offset:61056
  ds_read_b64_tr_b16 a[210:211], v6 offset:61312
  v_cvt_pk_bf16_f32 v186, v100, v101
  v_cvt_pk_bf16_f32 v187, v102, v103
  v_mfma_f32_32x32x16_bf16 a[32:47], a[216:219], v[168:171], a[32:47]
  ds_read_b64_tr_b16 a[212:213], v6 offset:61136
  ds_read_b64_tr_b16 a[214:215], v6 offset:61392
  v_lshlrev_b32 v96, 16, v188
  v_and_b32 v97, s95, v188
  v_lshlrev_b32 v98, 16, v189
  v_mfma_f32_32x32x16_bf16 a[48:63], a[220:223], v[168:171], a[48:63]
  ds_read_b64_tr_b16 a[216:217], v6 offset:61216
  ds_read_b64_tr_b16 a[218:219], v6 offset:61472
  v_and_b32 v99, s95, v189
  v_lshlrev_b32 v100, 16, v190
  v_and_b32 v101, s95, v190
  s_waitcnt lgkmcnt(6)
  v_mfma_f32_32x32x16_bf16 a[64:79], a[224:227], v[168:171], a[64:79]
  ds_read_b64_tr_b16 a[220:221], v7 offset:61056
  ds_read_b64_tr_b16 a[222:223], v7 offset:61312
  v_lshlrev_b32 v102, 16, v191
  v_and_b32 v103, s95, v191
  v_fma_f32 v96, v96, v24, v25
  v_mfma_f32_32x32x16_bf16 a[80:95], a[228:231], v[168:171], a[80:95]
  v_add_u32 v6, 0xf800, v6
  ds_read_b64_tr_b16 a[224:225], v6 offset:1856
  ds_read_b64_tr_b16 a[226:227], v6 offset:2112
  v_fma_f32 v97, v97, v24, v25
  v_fma_f32 v98, v98, v24, v25
  v_mfma_f32_32x32x16_bf16 a[96:111], a[232:235], v[168:171], a[96:111]
  buffer_load_dwordx4 v14, s[8:11], s44 offen offset:2176 lds
  ds_read_b64_tr_b16 a[228:229], v6 offset:1920
  ds_read_b64_tr_b16 a[230:231], v6 offset:2176
  v_fma_f32 v99, v99, v24, v25
  v_fma_f32 v100, v100, v24, v25
  v_mfma_f32_32x32x16_bf16 a[112:127], a[236:239], v[168:171], a[112:127]
  ds_read_b64_tr_b16 a[232:233], v6 offset:1984
  ds_read_b64_tr_b16 a[234:235], v6 offset:2240
  v_fma_f32 v101, v101, v24, v25
  v_fma_f32 v102, v102, v24, v25
  v_fma_f32 v103, v103, v24, v25
  s_waitcnt lgkmcnt(6)
  v_mfma_f32_32x32x16_bf16 a[0:15], a[208:211], v[172:175], a[0:15]
  ds_read_b64_tr_b16 a[236:237], v6 offset:2048
  ds_read_b64_tr_b16 a[238:239], v6 offset:2304
  v_cvt_pk_bf16_f32 v188, v96, v97
  v_cvt_pk_bf16_f32 v189, v98, v99
  v_cvt_pk_bf16_f32 v190, v100, v101
  s_waitcnt vmcnt(4)
  s_barrier
  v_mfma_f32_32x32x16_bf16 a[16:31], a[212:215], v[172:175], a[16:31]
  v_add_u32 v6, 0xfffe0000, v6
  ds_read_b64_tr_b16 a[208:209], v6 offset:0
  ds_read_b64_tr_b16 a[210:211], v6 offset:256
  v_cvt_pk_bf16_f32 v191, v102, v103
  v_lshlrev_b32 v96, 16, v192
  v_mfma_f32_32x32x16_bf16 a[32:47], a[216:219], v[172:175], a[32:47]
  ds_read_b64_tr_b16 a[212:213], v6 offset:80
  ds_read_b64_tr_b16 a[214:215], v6 offset:336
  v_and_b32 v97, s95, v192
  v_lshlrev_b32 v98, 16, v193
  v_and_b32 v99, s95, v193
  v_mfma_f32_32x32x16_bf16 a[48:63], a[220:223], v[172:175], a[48:63]
  ds_read_b64_tr_b16 a[216:217], v6 offset:160
  ds_read_b64_tr_b16 a[218:219], v6 offset:416
  v_lshlrev_b32 v100, 16, v194
  v_and_b32 v101, s95, v194
  v_lshlrev_b32 v102, 16, v195
  s_waitcnt lgkmcnt(6)
  v_mfma_f32_32x32x16_bf16 a[64:79], a[224:227], v[172:175], a[64:79]
  buffer_load_dwordx4 v15, s[8:11], s44 offen offset:3264 lds
  v_add_u32 v7, 0xfffef800, v7
  ds_read_b64_tr_b16 a[220:221], v7 offset:0
  ds_read_b64_tr_b16 a[222:223], v7 offset:256
  v_and_b32 v103, s95, v195
  v_mfma_f32_32x32x16_bf16 a[80:95], a[228:231], v[172:175], a[80:95]
  ds_read_b64_tr_b16 a[224:225], v6 offset:4288
  ds_read_b64_tr_b16 a[226:227], v6 offset:4544
  s_add_u32 m0, s46, 38592
  s_mul_i32 s44, s67, 4608
  s_add_u32 s44, s44, s82
  v_mfma_f32_32x32x16_bf16 a[96:111], a[232:235], v[172:175], a[96:111]
  ds_read_b64_tr_b16 a[228:229], v6 offset:4352
  ds_read_b64_tr_b16 a[230:231], v6 offset:4608
  v_fma_f32 v96, v96, v24, v25
  v_fma_f32 v97, v97, v24, v25
  v_fma_f32 v98, v98, v24, v25
  v_mfma_f32_32x32x16_bf16 a[112:127], a[236:239], v[172:175], a[112:127]
  ds_read_b64_tr_b16 a[232:233], v6 offset:4416
  ds_read_b64_tr_b16 a[234:235], v6 offset:4672
  v_fma_f32 v99, v99, v24, v25
  v_fma_f32 v100, v100, v24, v25
  v_fma_f32 v101, v101, v24, v25
  s_waitcnt lgkmcnt(6)
  v_mfma_f32_32x32x16_bf16 a[0:15], a[208:211], v[176:179], a[0:15]
  ds_read_b64_tr_b16 a[236:237], v6 offset:4480
  ds_read_b64_tr_b16 a[238:239], v6 offset:4736
  v_fma_f32 v102, v102, v24, v25
  v_fma_f32 v103, v103, v24, v25
  v_cvt_pk_bf16_f32 v192, v96, v97
  v_mfma_f32_32x32x16_bf16 a[16:31], a[212:215], v[176:179], a[16:31]
  buffer_load_dwordx4 v16, s[12:15], s44 offen offset:0 lds
  ds_read_b64_tr_b16 a[208:209], v6 offset:8576
  ds_read_b64_tr_b16 a[210:211], v6 offset:8832
  v_cvt_pk_bf16_f32 v193, v98, v99
  v_cvt_pk_bf16_f32 v194, v100, v101
  v_mfma_f32_32x32x16_bf16 a[32:47], a[216:219], v[176:179], a[32:47]
  ds_read_b64_tr_b16 a[212:213], v6 offset:8656
  ds_read_b64_tr_b16 a[214:215], v6 offset:8912
  v_cvt_pk_bf16_f32 v195, v102, v103
  v_lshlrev_b32 v96, 16, v196
  v_and_b32 v97, s95, v196
  v_mfma_f32_32x32x16_bf16 a[48:63], a[220:223], v[176:179], a[48:63]
  buffer_load_dwordx4 v17, s[12:15], s44 offen offset:1088 lds
  ds_read_b64_tr_b16 a[216:217], v6 offset:8736
  ds_read_b64_tr_b16 a[218:219], v6 offset:8992
  v_lshlrev_b32 v98, 16, v197
  v_and_b32 v99, s95, v197
  s_waitcnt lgkmcnt(6)
  v_mfma_f32_32x32x16_bf16 a[64:79], a[224:227], v[176:179], a[64:79]
  ds_read_b64_tr_b16 a[220:221], v7 offset:8576
  ds_read_b64_tr_b16 a[222:223], v7 offset:8832
  v_lshlrev_b32 v100, 16, v198
  v_and_b32 v101, s95, v198
  v_lshlrev_b32 v102, 16, v199
  v_mfma_f32_32x32x16_bf16 a[80:95], a[228:231], v[176:179], a[80:95]
  buffer_load_dwordx4 v18, s[12:15], s44 offen offset:2176 lds
  ds_read_b64_tr_b16 a[224:225], v6 offset:12864
  ds_read_b64_tr_b16 a[226:227], v6 offset:13120
  v_and_b32 v103, s95, v199
  v_fma_f32 v96, v96, v24, v25
  v_mfma_f32_32x32x16_bf16 a[96:111], a[232:235], v[176:179], a[96:111]
  ds_read_b64_tr_b16 a[228:229], v6 offset:12928
  ds_read_b64_tr_b16 a[230:231], v6 offset:13184
  v_fma_f32 v97, v97, v24, v25
  v_fma_f32 v98, v98, v24, v25
  v_fma_f32 v99, v99, v24, v25
  v_mfma_f32_32x32x16_bf16 a[112:127], a[236:239], v[176:179], a[112:127]
  buffer_load_dwordx4 v19, s[12:15], s44 offen offset:3264 lds
  ds_read_b64_tr_b16 a[232:233], v6 offset:12992
  ds_read_b64_tr_b16 a[234:235], v6 offset:13248
  v_fma_f32 v100, v100, v24, v25
  v_fma_f32 v101, v101, v24, v25
  s_waitcnt lgkmcnt(6)
  v_mfma_f32_32x32x16_bf16 a[0:15], a[208:211], v[180:183], a[0:15]
  ds_read_b64_tr_b16 a[236:237], v6 offset:13056
  ds_read_b64_tr_b16 a[238:239], v6 offset:13312
  s_add_u32 m0, s47, 137216
  s_mul_i32 s45, s62, 4608
  s_add_u32 s44, s45, s83
  v_mfma_f32_32x32x16_bf16 a[16:31], a[212:215], v[180:183], a[16:31]
  ds_read_b64_tr_b16 a[208:209], v6 offset:17152
  ds_read_b64_tr_b16 a[210:211], v6 offset:17408
  v_fma_f32 v102, v102, v24, v25
  v_fma_f32 v103, v103, v24, v25
  v_cvt_pk_bf16_f32 v196, v96, v97
  v_mfma_f32_32x32x16_bf16 a[32:47], a[216:219], v[180:183], a[32:47]
  buffer_load_dwordx4 v17, s[12:15], s44 offen offset:1088 lds
  ds_read_b64_tr_b16 a[212:213], v6 offset:17232
  ds_read_b64_tr_b16 a[214:215], v6 offset:17488
  v_cvt_pk_bf16_f32 v197, v98, v99
  v_cvt_pk_bf16_f32 v198, v100, v101
  v_mfma_f32_32x32x16_bf16 a[48:63], a[220:223], v[180:183], a[48:63]
  ds_read_b64_tr_b16 a[216:217], v6 offset:17312
  ds_read_b64_tr_b16 a[218:219], v6 offset:17568
  s_add_u32 m0, s46, 68608
  s_mul_i32 s44, s68, 1728
  s_add_u32 s44, s44, s81
  s_waitcnt lgkmcnt(6)
  v_mfma_f32_32x32x16_bf16 a[64:79], a[224:227], v[180:183], a[64:79]
  buffer_load_dwordx4 v12, s[8:11], s44 offen offset:0 lds
  ds_read_b64_tr_b16 a[220:221], v7 offset:17152
  ds_read_b64_tr_b16 a[222:223], v7 offset:17408
  v_cvt_pk_bf16_f32 v199, v102, v103
  v_lshlrev_b32 v96, 16, v200
  v_mfma_f32_32x32x16_bf16 a[80:95], a[228:231], v[180:183], a[80:95]
  ds_read_b64_tr_b16 a[224:225], v6 offset:21440
  ds_read_b64_tr_b16 a[226:227], v6 offset:21696
  v_and_b32 v97, s95, v200
  v_lshlrev_b32 v98, 16, v201
  v_and_b32 v99, s95, v201
  v_mfma_f32_32x32x16_bf16 a[96:111], a[232:235], v[180:183], a[96:111]
  ds_read_b64_tr_b16 a[228:229], v6 offset:21504
  ds_read_b64_tr_b16 a[230:231], v6 offset:21760
  v_lshlrev_b32 v100, 16, v202
  v_and_b32 v101, s95, v202
  v_lshlrev_b32 v102, 16, v203
  v_mfma_f32_32x32x16_bf16 a[112:127], a[236:239], v[180:183], a[112:127]
  ds_read_b64_tr_b16 a[232:233], v6 offset:21568
  ds_read_b64_tr_b16 a[234:235], v6 offset:21824
  v_and_b32 v103, s95, v203
  v_fma_f32 v96, v96, v24, v25
  v_fma_f32 v97, v97, v24, v25
  s_waitcnt lgkmcnt(6)
  v_mfma_f32_32x32x16_bf16 a[0:15], a[208:211], v[184:187], a[0:15]
  ds_read_b64_tr_b16 a[236:237], v6 offset:21632
  ds_read_b64_tr_b16 a[238:239], v6 offset:21888
  v_fma_f32 v98, v98, v24, v25
  v_fma_f32 v99, v99, v24, v25
  v_fma_f32 v100, v100, v24, v25
  v_mfma_f32_32x32x16_bf16 a[16:31], a[212:215], v[184:187], a[16:31]
  buffer_load_dwordx4 v13, s[8:11], s44 offen offset:1088 lds
  ds_read_b64_tr_b16 a[208:209], v6 offset:25728
  ds_read_b64_tr_b16 a[210:211], v6 offset:25984
  v_fma_f32 v101, v101, v24, v25
  v_fma_f32 v102, v102, v24, v25
  v_mfma_f32_32x32x16_bf16 a[32:47], a[216:219], v[184:187], a[32:47]
  ds_read_b64_tr_b16 a[212:213], v6 offset:25808
  ds_read_b64_tr_b16 a[214:215], v6 offset:26064
  v_fma_f32 v103, v103, v24, v25
  v_cvt_pk_bf16_f32 v200, v96, v97
  v_cvt_pk_bf16_f32 v201, v98, v99
  v_mfma_f32_32x32x16_bf16 a[48:63], a[220:223], v[184:187], a[48:63]
  ds_read_b64_tr_b16 a[216:217], v6 offset:25888
  ds_read_b64_tr_b16 a[218:219], v6 offset:26144
  v_cvt_pk_bf16_f32 v202, v100, v101
  v_cvt_pk_bf16_f32 v203, v102, v103
  v_lshlrev_b32 v96, 16, v204
  s_waitcnt lgkmcnt(6)
  v_mfma_f32_32x32x16_bf16 a[64:79], a[224:227], v[184:187], a[64:79]
  ds_read_b64_tr_b16 a[220:221], v7 offset:25728
  ds_read_b64_tr_b16 a[222:223], v7 offset:25984
  v_and_b32 v97, s95, v204
  v_lshlrev_b32 v98, 16, v205
  v_and_b32 v99, s95, v205
  v_mfma_f32_32x32x16_bf16 a[80:95], a[228:231], v[184:187], a[80:95]
  ds_read_b64_tr_b16 a[224:225], v6 offset:30016
  ds_read_b64_tr_b16 a[226:227], v6 offset:30272
  v_lshlrev_b32 v100, 16, v206
  v_and_b32 v101, s95, v206
  v_lshlrev_b32 v102, 16, v207
  v_mfma_f32_32x32x16_bf16 a[96:111], a[232:235], v[184:187], a[96:111]
  buffer_load_dwordx4 v14, s[8:11], s44 offen offset:2176 lds
  ds_read_b64_tr_b16 a[228:229], v6 offset:30080
  ds_read_b64_tr_b16 a[230:231], v6 offset:30336
  v_and_b32 v103, s95, v207
  v_fma_f32 v96, v96, v24, v25
  v_mfma_f32_32x32x16_bf16 a[112:127], a[236:239], v[184:187], a[112:127]
  ds_read_b64_tr_b16 a[232:233], v6 offset:30144
  ds_read_b64_tr_b16 a[234:235], v6 offset:30400
  v_fma_f32 v97, v97, v24, v25
  v_fma_f32 v98, v98, v24, v25
  v_fma_f32 v99, v99, v24, v25
  s_waitcnt lgkmcnt(6)
  v_mfma_f32_32x32x16_bf16 a[0:15], a[208:211], v[188:191], a[0:15]
  ds_read_b64_tr_b16 a[236:237], v6 offset:30208
  ds_read_b64_tr_b16 a[238:239], v6 offset:30464
  v_fma_f32 v100, v100, v24, v25
  v_fma_f32 v101, v101, v24, v25
  v_fma_f32 v102, v102, v24, v25
  s_waitcnt vmcnt(4)
  s_barrier
  v_mfma_f32_32x32x16_bf16 a[16:31], a[212:215], v[188:191], a[16:31]
  ds_read_b64_tr_b16 a[208:209], v6 offset:34304
  ds_read_b64_tr_b16 a[210:211], v6 offset:34560
  v_fma_f32 v103, v103, v24, v25
  v_cvt_pk_bf16_f32 v204, v96, v97
  v_cvt_pk_bf16_f32 v205, v98, v99
  v_mfma_f32_32x32x16_bf16 a[32:47], a[216:219], v[188:191], a[32:47]
  ds_read_b64_tr_b16 a[212:213], v6 offset:34384
  ds_read_b64_tr_b16 a[214:215], v6 offset:34640
  v_cvt_pk_bf16_f32 v206, v100, v101
  v_cvt_pk_bf16_f32 v207, v102, v103
  v_lshlrev_b32 v96, 16, v208
  v_mfma_f32_32x32x16_bf16 a[48:63], a[220:223], v[188:191], a[48:63]
  ds_read_b64_tr_b16 a[216:217], v6 offset:34464
  ds_read_b64_tr_b16 a[218:219], v6 offset:34720
  v_and_b32 v97, s95, v208
  v_lshlrev_b32 v98, 16, v209
  v_and_b32 v99, s95, v209
  s_waitcnt lgkmcnt(6)
  v_mfma_f32_32x32x16_bf16 a[64:79], a[224:227], v[188:191], a[64:79]
  buffer_load_dwordx4 v15, s[8:11], s44 offen offset:3264 lds
  ds_read_b64_tr_b16 a[220:221], v7 offset:34304
  ds_read_b64_tr_b16 a[222:223], v7 offset:34560
  v_lshlrev_b32 v100, 16, v210
  v_and_b32 v101, s95, v210
  v_mfma_f32_32x32x16_bf16 a[80:95], a[228:231], v[188:191], a[80:95]
  ds_read_b64_tr_b16 a[224:225], v6 offset:38592
  ds_read_b64_tr_b16 a[226:227], v6 offset:38848
  s_add_u32 m0, s46, 72896
  s_mul_i32 s44, s68, 4608
  s_add_u32 s44, s44, s82
  v_mfma_f32_32x32x16_bf16 a[96:111], a[232:235], v[188:191], a[96:111]
  ds_read_b64_tr_b16 a[228:229], v6 offset:38656
  ds_read_b64_tr_b16 a[230:231], v6 offset:38912
  v_lshlrev_b32 v102, 16, v211
  v_and_b32 v103, s95, v211
  v_fma_f32 v96, v96, v24, v25
  v_mfma_f32_32x32x16_bf16 a[112:127], a[236:239], v[188:191], a[112:127]
  ds_read_b64_tr_b16 a[232:233], v6 offset:38720
  ds_read_b64_tr_b16 a[234:235], v6 offset:38976
  v_fma_f32 v97, v97, v24, v25
  v_fma_f32 v98, v98, v24, v25
  v_fma_f32 v99, v99, v24, v25
  s_waitcnt lgkmcnt(6)
  v_mfma_f32_32x32x16_bf16 a[0:15], a[208:211], v[192:195], a[0:15]
  ds_read_b64_tr_b16 a[236:237], v6 offset:38784
  ds_read_b64_tr_b16 a[238:239], v6 offset:39040
  v_fma_f32 v100, v100, v24, v25
  v_fma_f32 v101, v101, v24, v25
  v_fma_f32 v102, v102, v24, v25
  v_mfma_f32_32x32x16_bf16 a[16:31], a[212:215], v[192:195], a[16:31]
  buffer_load_dwordx4 v16, s[12:15], s44 offen offset:0 lds
  ds_read_b64_tr_b16 a[208:209], v6 offset:42880
  ds_read_b64_tr_b16 a[210:211], v6 offset:43136
  v_fma_f32 v103, v103, v24, v25
  v_cvt_pk_bf16_f32 v208, v96, v97
  v_mfma_f32_32x32x16_bf16 a[32:47], a[216:219], v[192:195], a[32:47]
  ds_read_b64_tr_b16 a[212:213], v6 offset:42960
  ds_read_b64_tr_b16 a[214:215], v6 offset:43216
  v_cvt_pk_bf16_f32 v209, v98, v99
  v_cvt_pk_bf16_f32 v210, v100, v101
  v_cvt_pk_bf16_f32 v211, v102, v103
  v_mfma_f32_32x32x16_bf16 a[48:63], a[220:223], v[192:195], a[48:63]
  buffer_load_dwordx4 v17, s[12:15], s44 offen offset:1088 lds
  ds_read_b64_tr_b16 a[216:217], v6 offset:43040
  ds_read_b64_tr_b16 a[218:219], v6 offset:43296
  v_lshlrev_b32 v96, 16, v212
  v_and_b32 v97, s95, v212
  s_waitcnt lgkmcnt(6)
  v_mfma_f32_32x32x16_bf16 a[64:79], a[224:227], v[192:195], a[64:79]
  ds_read_b64_tr_b16 a[220:221], v7 offset:42880
  ds_read_b64_tr_b16 a[222:223], v7 offset:43136
  v_lshlrev_b32 v98, 16, v213
  v_and_b32 v99, s95, v213
  v_lshlrev_b32 v100, 16, v214
  v_mfma_f32_32x32x16_bf16 a[80:95], a[228:231], v[192:195], a[80:95]
  buffer_load_dwordx4 v18, s[12:15], s44 offen offset:2176 lds
  ds_read_b64_tr_b16 a[224:225], v6 offset:47168
  ds_read_b64_tr_b16 a[226:227], v6 offset:47424
  v_and_b32 v101, s95, v214
  v_lshlrev_b32 v102, 16, v215
  v_mfma_f32_32x32x16_bf16 a[96:111], a[232:235], v[192:195], a[96:111]
  ds_read_b64_tr_b16 a[228:229], v6 offset:47232
  ds_read_b64_tr_b16 a[230:231], v6 offset:47488
  v_and_b32 v103, s95, v215
  v_fma_f32 v96, v96, v24, v25
  v_fma_f32 v97, v97, v24, v25
  v_mfma_f32_32x32x16_bf16 a[112:127], a[236:239], v[192:195], a[112:127]
  buffer_load_dwordx4 v19, s[12:15], s44 offen offset:3264 lds
  ds_read_b64_tr_b16 a[232:233], v6 offset:47296
  ds_read_b64_tr_b16 a[234:235], v6 offset:47552
  v_fma_f32 v98, v98, v24, v25
  v_fma_f32 v99, v99, v24, v25
  s_waitcnt lgkmcnt(6)
  v_mfma_f32_32x32x16_bf16 a[0:15], a[208:211], v[196:199], a[0:15]
  ds_read_b64_tr_b16 a[236:237], v6 offset:47360
  ds_read_b64_tr_b16 a[238:239], v6 offset:47616
  s_add_u32 m0, s47, 137216
  s_mul_i32 s45, s62, 4608
  s_add_u32 s44, s45, s83
  v_mfma_f32_32x32x16_bf16 a[16:31], a[212:215], v[196:199], a[16:31]
  ds_read_b64_tr_b16 a[208:209], v6 offset:51456
  ds_read_b64_tr_b16 a[210:211], v6 offset:51712
  v_fma_f32 v100, v100, v24, v25
  v_fma_f32 v101, v101, v24, v25
  v_fma_f32 v102, v102, v24, v25
  v_mfma_f32_32x32x16_bf16 a[32:47], a[216:219], v[196:199], a[32:47]
  buffer_load_dwordx4 v18, s[12:15], s44 offen offset:2176 lds
  ds_read_b64_tr_b16 a[212:213], v6 offset:51536
  ds_read_b64_tr_b16 a[214:215], v6 offset:51792
  v_fma_f32 v103, v103, v24, v25
  v_cvt_pk_bf16_f32 v212, v96, v97
  v_mfma_f32_32x32x16_bf16 a[48:63], a[220:223], v[196:199], a[48:63]
  ds_read_b64_tr_b16 a[216:217], v6 offset:51616
  ds_read_b64_tr_b16 a[218:219], v6 offset:51872
  s_add_u32 m0, s46, 102912
  s_mul_i32 s44, s69, 1728
  s_add_u32 s44, s44, s81
  s_waitcnt lgkmcnt(6)
  v_mfma_f32_32x32x16_bf16 a[64:79], a[224:227], v[196:199], a[64:79]
  buffer_load_dwordx4 v12, s[8:11], s44 offen offset:0 lds
  ds_read_b64_tr_b16 a[220:221], v7 offset:51456
  ds_read_b64_tr_b16 a[222:223], v7 offset:51712
  v_cvt_pk_bf16_f32 v213, v98, v99
  v_cvt_pk_bf16_f32 v214, v100, v101
  v_mfma_f32_32x32x16_bf16 a[80:95], a[228:231], v[196:199], a[80:95]
  ds_read_b64_tr_b16 a[224:225], v6 offset:55744
  ds_read_b64_tr_b16 a[226:227], v6 offset:56000
  v_cvt_pk_bf16_f32 v215, v102, v103
  v_lshlrev_b32 v96, 16, v216
  v_and_b32 v97, s95, v216
  v_mfma_f32_32x32x16_bf16 a[96:111], a[232:235], v[196:199], a[96:111]
  ds_read_b64_tr_b16 a[228:229], v6 offset:55808
  ds_read_b64_tr_b16 a[230:231], v6 offset:56064
  v_lshlrev_b32 v98, 16, v217
  v_and_b32 v99, s95, v217
  v_lshlrev_b32 v100, 16, v218
  v_mfma_f32_32x32x16_bf16 a[112:127], a[236:239], v[196:199], a[112:127]
  ds_read_b64_tr_b16 a[232:233], v6 offset:55872
  ds_read_b64_tr_b16 a[234:235], v6 offset:56128
  v_and_b32 v101, s95, v218
  v_lshlrev_b32 v102, 16, v219
  v_and_b32 v103, s95, v219
  s_waitcnt lgkmcnt(6)
  v_mfma_f32_32x32x16_bf16 a[0:15], a[208:211], v[200:203], a[0:15]
  ds_read_b64_tr_b16 a[236:237], v6 offset:55936
  ds_read_b64_tr_b16 a[238:239], v6 offset:56192
  v_fma_f32 v96, v96, v24, v25
  v_fma_f32 v97, v97, v24, v25
  v_fma_f32 v98, v98, v24, v25
  v_mfma_f32_32x32x16_bf16 a[16:31], a[212:215], v[200:203], a[16:31]
  buffer_load_dwordx4 v13, s[8:11], s44 offen offset:1088 lds
  ds_read_b64_tr_b16 a[208:209], v6 offset:60032
  ds_read_b64_tr_b16 a[210:211], v6 offset:60288
  v_fma_f32 v99, v99, v24, v25
  v_fma_f32 v100, v100, v24, v25
  v_mfma_f32_32x32x16_bf16 a[32:47], a[216:219], v[200:203], a[32:47]
  ds_read_b64_tr_b16 a[212:213], v6 offset:60112
  ds_read_b64_tr_b16 a[214:215], v6 offset:60368
  v_fma_f32 v101, v101, v24, v25
  v_fma_f32 v102, v102, v24, v25
  v_fma_f32 v103, v103, v24, v25
  v_mfma_f32_32x32x16_bf16 a[48:63], a[220:223], v[200:203], a[48:63]
  ds_read_b64_tr_b16 a[216:217], v6 offset:60192
  ds_read_b64_tr_b16 a[218:219], v6 offset:60448
  v_cvt_pk_bf16_f32 v216, v96, v97
  v_cvt_pk_bf16_f32 v217, v98, v99
  v_cvt_pk_bf16_f32 v218, v100, v101
  s_waitcnt lgkmcnt(6)
  v_mfma_f32_32x32x16_bf16 a[64:79], a[224:227], v[200:203], a[64:79]
  ds_read_b64_tr_b16 a[220:221], v7 offset:60032
  ds_read_b64_tr_b16 a[222:223], v7 offset:60288
  v_cvt_pk_bf16_f32 v219, v102, v103
  v_lshlrev_b32 v96, 16, v220
  v_and_b32 v97, s95, v220
  v_mfma_f32_32x32x16_bf16 a[80:95], a[228:231], v[200:203], a[80:95]
  ds_read_b64_tr_b16 a[224:225], v6 offset:64320
  ds_read_b64_tr_b16 a[226:227], v6 offset:64576
  v_lshlrev_b32 v98, 16, v221
  v_and_b32 v99, s95, v221
  v_lshlrev_b32 v100, 16, v222
  v_mfma_f32_32x32x16_bf16 a[96:111], a[232:235], v[200:203], a[96:111]
  buffer_load_dwordx4 v14, s[8:11], s44 offen offset:2176 lds
  ds_read_b64_tr_b16 a[228:229], v6 offset:64384
  ds_read_b64_tr_b16 a[230:231], v6 offset:64640
  v_and_b32 v101, s95, v222
  v_lshlrev_b32 v102, 16, v223
  v_mfma_f32_32x32x16_bf16 a[112:127], a[236:239], v[200:203], a[112:127]
  ds_read_b64_tr_b16 a[232:233], v6 offset:64448
  ds_read_b64_tr_b16 a[234:235], v6 offset:64704
  v_and_b32 v103, s95, v223
  v_fma_f32 v96, v96, v24, v25
  v_fma_f32 v97, v97, v24, v25
  s_waitcnt lgkmcnt(6)
  v_mfma_f32_32x32x16_bf16 a[0:15], a[208:211], v[204:207], a[0:15]
  ds_read_b64_tr_b16 a[236:237], v6 offset:64512
  ds_read_b64_tr_b16 a[238:239], v6 offset:64768
L_pg2:
  s_cbranch_execz L_pg6
  v_fma_f32 v98, v98, v24, v25
  v_fma_f32 v99, v99, v24, v25
  v_fma_f32 v100, v100, v24, v25
  s_waitcnt vmcnt(4)
  s_barrier
  v_mfma_f32_32x32x16_bf16 a[16:31], a[212:215], v[204:207], a[16:31]
  v_add_u32 v6, 0x10800, v6
  ds_read_b64_tr_b16 a[208:209], v6 offset:1024
  ds_read_b64_tr_b16 a[210:211], v6 offset:1280
  v_fma_f32 v101, v101, v24, v25
  v_fma_f32 v102, v102, v24, v25
  v_mfma_f32_32x32x16_bf16 a[32:47], a[216:219], v[204:207], a[32:47]
  ds_read_b64_tr_b16 a[212:213], v6 offset:1104
  ds_read_b64_tr_b16 a[214:215], v6 offset:1360
  v_fma_f32 v103, v103, v24, v25
  v_cvt_pk_bf16_f32 v220, v96, v97
  v_cvt_pk_bf16_f32 v221, v98, v99
  v_mfma_f32_32x32x16_bf16 a[48:63], a[220:223], v[204:207], a[48:63]
  ds_read_b64_tr_b16 a[216:217], v6 offset:1184
  ds_read_b64_tr_b16 a[218:219], v6 offset:1440
  v_cvt_pk_bf16_f32 v222, v100, v101
  v_cvt_pk_bf16_f32 v223, v102, v103
  v_lshlrev_b32 v96, 16, v224
  s_waitcnt lgkmcnt(6)
  v_mfma_f32_32x32x16_bf16 a[64:79], a[224:227], v[204:207], a[64:79]
  buffer_load_dwordx4 v15, s[8:11], s44 offen offset:3264 lds
  v_add_u32 v7, 0x10800, v7
  ds_read_b64_tr_b16 a[220:221], v7 offset:1024
  ds_read_b64_tr_b16 a[222:223], v7 offset:1280
  v_and_b32 v97, s95, v224
  v_mfma_f32_32x32x16_bf16 a[80:95], a[228:231], v[204:207], a[80:95]
  ds_read_b64_tr_b16 a[224:225], v6 offset:5312
  ds_read_b64_tr_b16 a[226:227], v6 offset:5568
  s_add_u32 m0, s46, 107200
  s_mul_i32 s44, s69, 4608
  s_add_u32 s44, s44, s82
  v_mfma_f32_32x32x16_bf16 a[96:111], a[232:235], v[204:207], a[96:111]
  ds_read_b64_tr_b16 a[228:229], v6 offset:5376
  ds_read_b64_tr_b16 a[230:231], v6 offset:5632
  v_lshlrev_b32 v98, 16, v225
  v_and_b32 v99, s95, v225
  v_lshlrev_b32 v100, 16, v226
  v_mfma_f32_32x32x16_bf16 a[112:127], a[236:239], v[204:207], a[112:127]
  ds_read_b64_tr_b16 a[232:233], v6 offset:5440
  ds_read_b64_tr_b16 a[234:235], v6 offset:5696
  v_and_b32 v101, s95, v226
  v_lshlrev_b32 v102, 16, v227
  v_and_b32 v103, s95, v227
  s_waitcnt lgkmcnt(6)
  v_mfma_f32_32x32x16_bf16 a[0:15], a[208:211], v[208:211], a[0:15]
  ds_read_b64_tr_b16 a[236:237], v6 offset:5504
  ds_read_b64_tr_b16 a[238:239], v6 offset:5760
  v_fma_f32 v96, v96, v24, v25
  v_fma_f32 v97, v97, v24, v25
  v_fma_f32 v98, v98, v24, v25
  v_mfma_f32_32x32x16_bf16 a[16:31], a[212:215], v[208:211], a[16:31]
  buffer_load_dwordx4 v16, s[12:15], s44 offen offset:0 lds
  ds_read_b64_tr_b16 a[208:209], v6 offset:9600
  ds_read_b64_tr_b16 a[210:211], v6 offset:9856
  v_fma_f32 v99, v99, v24, v25
  v_fma_f32 v100, v100, v24, v25
  v_mfma_f32_32x32x16_bf16 a[32:47], a[216:219], v[208:211], a[32:47]
  ds_read_b64_tr_b16 a[212:213], v6 offset:9680
  ds_read_b64_tr_b16 a[214:215], v6 offset:9936
  v_fma_f32 v101, v101, v24, v25
  v_fma_f32 v102, v102, v24, v25
  v_fma_f32 v103, v103, v24, v25
  v_mfma_f32_32x32x16_bf16 a[48:63], a[220:223], v[208:211], a[48:63]
  buffer_load_dwordx4 v17, s[12:15], s44 offen offset:1088 lds
  ds_read_b64_tr_b16 a[216:217], v6 offset:9760
  ds_read_b64_tr_b16 a[218:219], v6 offset:10016
  v_cvt_pk_bf16_f32 v224, v96, v97
  v_cvt_pk_bf16_f32 v225, v98, v99
  s_waitcnt lgkmcnt(6)
  v_mfma_f32_32x32x16_bf16 a[64:79], a[224:227], v[208:211], a[64:79]
  ds_read_b64_tr_b16 a[220:221], v7 offset:9600
  ds_read_b64_tr_b16 a[222:223], v7 offset:9856
  v_cvt_pk_bf16_f32 v226, v100, v101
  v_cvt_pk_bf16_f32 v227, v102, v103
  v_lshlrev_b32 v96, 16, v228
  v_mfma_f32_32x32x16_bf16 a[80:95], a[228:231], v[208:211], a[80:95]
  buffer_load_dwordx4 v18, s[12:15], s44 offen offset:2176 lds
  ds_read_b64_tr_b16 a[224:225], v6 offset:13888
  ds_read_b64_tr_b16 a[226:227], v6 offset:14144
  v_and_b32 v97, s95, v228
  v_lshlrev_b32 v98, 16, v229
  v_mfma_f32_32x32x16_bf16 a[96:111], a[232:235], v[208:211], a[96:111]
  ds_read_b64_tr_b16 a[228:229], v6 offset:13952
  ds_read_b64_tr_b16 a[230:231], v6 offset:14208
  v_and_b32 v99, s95, v229
  v_lshlrev_b32 v100, 16, v230
  v_and_b32 v101, s95, v230
  v_mfma_f32_32x32x16_bf16 a[112:127], a[236:239], v[208:211], a[112:127]
  buffer_load_dwordx4 v19, s[12:15], s44 offen offset:3264 lds
  ds_read_b64_tr_b16 a[232:233], v6 offset:14016
  ds_read_b64_tr_b16 a[234:235], v6 offset:14272
  v_lshlrev_b32 v102, 16, v231
  v_and_b32 v103, s95, v231
  s_waitcnt lgkmcnt(6)
  v_mfma_f32_32x32x16_bf16 a[0:15], a[208:211], v[212:215], a[0:15]
  ds_read_b64_tr_b16 a[236:237], v6 offset:14080
  ds_read_b64_tr_b16 a[238:239], v6 offset:14336
  s_add_u32 m0, s47, 137216
  s_mul_i32 s45, s62, 4608
  s_add_u32 s44, s45, s83
  v_mfma_f32_32x32x16_bf16 a[16:31], a[212:215], v[212:215], a[16:31]
  ds_read_b64_tr_b16 a[208:209], v6 offset:18176
  ds_read_b64_tr_b16 a[210:211], v6 offset:18432
  v_fma_f32 v96, v96, v24, v25
  v_fma_f32 v97, v97, v24, v25
  v_fma_f32 v98, v98, v24, v25
  v_mfma_f32_32x32x16_bf16 a[32:47], a[216:219], v[212:215], a[32:47]
  buffer_load_dwordx4 v19, s[12:15], s44 offen offset:3264 lds
  ds_read_b64_tr_b16 a[212:213], v6 offset:18256
  ds_read_b64_tr_b16 a[214:215], v6 offset:18512
  v_fma_f32 v99, v99, v24, v25
  v_fma_f32 v100, v100, v24, v25
  v_mfma_f32_32x32x16_bf16 a[48:63], a[220:223], v[212:215], a[48:63]
  ds_read_b64_tr_b16 a[216:217], v6 offset:18336
  ds_read_b64_tr_b16 a[218:219], v6 offset:18592
  s_add_u32 m0, s46, 0
  s_mul_i32 s44, s70, 1728
  s_add_u32 s44, s44, s81
  s_waitcnt lgkmcnt(6)
  v_mfma_f32_32x32x16_bf16 a[64:79], a[224:227], v[212:215], a[64:79]
  buffer_load_dwordx4 v12, s[8:11], s44 offen offset:0 lds
  ds_read_b64_tr_b16 a[220:221], v7 offset:18176
  ds_read_b64_tr_b16 a[222:223], v7 offset:18432
  v_fma_f32 v101, v101, v24, v25
  v_fma_f32 v102, v102, v24, v25
  v_mfma_f32_32x32x16_bf16 a[80:95], a[228:231], v[212:215], a[80:95]
  ds_read_b64_tr_b16 a[224:225], v6 offset:22464
  ds_read_b64_tr_b16 a[226:227], v6 offset:22720
  v_fma_f32 v103, v103, v24, v25
  v_cvt_pk_bf16_f32 v228, v96, v97
  v_cvt_pk_bf16_f32 v229, v98, v99
  v_mfma_f32_32x32x16_bf16 a[96:111], a[232:235], v[212:215], a[96:111]
  ds_read_b64_tr_b16 a[228:229], v6 offset:22528
  ds_read_b64_tr_b16 a[230:231], v6 offset:22784
  v_cvt_pk_bf16_f32 v230, v100, v101
  v_cvt_pk_bf16_f32 v231, v102, v103
  v_lshlrev_b32 v96, 16, v232
  v_mfma_f32_32x32x16_bf16 a[112:127], a[236:239], v[212:215], a[112:127]
  ds_read_b64_tr_b16 a[232:233], v6 offset:22592
  ds_read_b64_tr_b16 a[234:235], v6 offset:22848
  v_and_b32 v97, s95, v232
  v_lshlrev_b32 v98, 16, v233
  v_and_b32 v99, s95, v233
  s_waitcnt lgkmcnt(6)
  v_mfma_f32_32x32x16_bf16 a[0:15], a[208:211], v[216:219], a[0:15]
  ds_read_b64_tr_b16 a[236:237], v6 offset:22656
  ds_read_b64_tr_b16 a[238:239], v6 offset:22912
  v_lshlrev_b32 v100, 16, v234
  v_and_b32 v101, s95, v234
  v_lshlrev_b32 v102, 16, v235
  v_mfma_f32_32x32x16_bf16 a[16:31], a[212:215], v[216:219], a[16:31]
  buffer_load_dwordx4 v13, s[8:11], s44 offen offset:1088 lds
  ds_read_b64_tr_b16 a[208:209], v6 offset:26752
  ds_read_b64_tr_b16 a[210:211], v6 offset:27008
  v_and_b32 v103, s95, v235
  v_fma_f32 v96, v96, v24, v25
  v_mfma_f32_32x32x16_bf16 a[32:47], a[216:219], v[216:219], a[32:47]
  ds_read_b64_tr_b16 a[212:213], v6 offset:26832
  ds_read_b64_tr_b16 a[214:215], v6 offset:27088
  v_fma_f32 v97, v97, v24, v25
  v_fma_f32 v98, v98, v24, v25
  v_fma_f32 v99, v99, v24, v25
  v_mfma_f32_32x32x16_bf16 a[48:63], a[220:223], v[216:219], a[48:63]
  ds_read_b64_tr_b16 a[216:217], v6 offset:26912
  ds_read_b64_tr_b16 a[218:219], v6 offset:27168
  v_fma_f32 v100, v100, v24, v25
  v_fma_f32 v101, v101, v24, v25
  v_fma_f32 v102, v102, v24, v25
  s_waitcnt lgkmcnt(6)
  v_mfma_f32_32x32x16_bf16 a[64:79], a[224:227], v[216:219], a[64:79]
  ds_read_b64_tr_b16 a[220:221], v7 offset:26752
  ds_read_b64_tr_b16 a[222:223], v7 offset:27008
  v_fma_f32 v103, v103, v24, v25
  v_cvt_pk_bf16_f32 v232, v96, v97
  v_cvt_pk_bf16_f32 v233, v98, v99
  v_mfma_f32_32x32x16_bf16 a[80:95], a[228:231], v[216:219], a[80:95]
  ds_read_b64_tr_b16 a[224:225], v6 offset:31040
  ds_read_b64_tr_b16 a[226:227], v6 offset:31296
  v_cvt_pk_bf16_f32 v234, v100, v101
  v_cvt_pk_bf16_f32 v235, v102, v103
  v_lshlrev_b32 v96, 16, v236
  v_mfma_f32_32x32x16_bf16 a[96:111], a[232:235], v[216:219], a[96:111]
  buffer_load_dwordx4 v14, s[8:11], s44 offen offset:2176 lds
  ds_read_b64_tr_b16 a[228:229], v6 offset:31104
  ds_read_b64_tr_b16 a[230:231], v6 offset:31360
  v_and_b32 v97, s95, v236
  v_lshlrev_b32 v98, 16, v237
  v_mfma_f32_32x32x16_bf16 a[112:127], a[236:239], v[216:219], a[112:127]
  ds_read_b64_tr_b16 a[232:233], v6 offset:31168
  ds_read_b64_tr_b16 a[234:235], v6 offset:31424
  v_and_b32 v99, s95, v237
  v_lshlrev_b32 v100, 16, v238
  v_and_b32 v101, s95, v238
  s_waitcnt lgkmcnt(6)
  v_mfma_f32_32x32x16_bf16 a[0:15], a[208:211], v[220:223], a[0:15]
  ds_read_b64_tr_b16 a[236:237], v6 offset:31232
  ds_read_b64_tr_b16 a[238:239], v6 offset:31488
  v_lshlrev_b32 v102, 16, v239
  v_and_b32 v103, s95, v239
  v_fma_f32 v96, v96, v24, v25
  s_waitcnt vmcnt(4)
  s_barrier
  v_mfma_f32_32x32x16_bf16 a[16:31], a[212:215], v[220:223], a[16:31]
  ds_read_b64_tr_b16 a[208:209], v6 offset:35328
  ds_read_b64_tr_b16 a[210:211], v6 offset:35584
  v_fma_f32 v97, v97, v24, v25
  v_fma_f32 v98, v98, v24, v25
  v_fma_f32 v99, v99, v24, v25
  v_mfma_f32_32x32x16_bf16 a[32:47], a[216:219], v[220:223], a[32:47]
  ds_read_b64_tr_b16 a[212:213], v6 offset:35408
  ds_read_b64_tr_b16 a[214:215], v6 offset:35664
  v_fma_f32 v100, v100, v24, v25
  v_fma_f32 v101, v101, v24, v25
  v_fma_f32 v102, v102, v24, v25
  v_mfma_f32_32x32x16_bf16 a[48:63], a[220:223], v[220:223], a[48:63]
  ds_read_b64_tr_b16 a[216:217], v6 offset:35488
  ds_read_b64_tr_b16 a[218:219], v6 offset:35744
  v_fma_f32 v103, v103, v24, v25
  v_cvt_pk_bf16_f32 v236, v96, v97
  v_cvt_pk_bf16_f32 v237, v98, v99
  s_waitcnt lgkmcnt(6)
  v_mfma_f32_32x32x16_bf16 a[64:79], a[224:227], v[220:223], a[64:79]
  buffer_load_dwordx4 v15, s[8:11], s44 offen offset:3264 lds
  ds_read_b64_tr_b16 a[220:221], v7 offset:35328
  ds_read_b64_tr_b16 a[222:223], v7 offset:35584
  v_cvt_pk_bf16_f32 v238, v100, v101
  v_cvt_pk_bf16_f32 v239, v102, v103
  v_mfma_f32_32x32x16_bf16 a[80:95], a[228:231], v[220:223], a[80:95]
  ds_read_b64_tr_b16 a[224:225], v6 offset:39616
  ds_read_b64_tr_b16 a[226:227], v6 offset:39872
  s_add_u32 m0, s46, 4288
  s_mul_i32 s44, s70, 4608
  s_add_u32 s44, s44, s82
  v_mfma_f32_32x32x16_bf16 a[96:111], a[232:235], v[220:223], a[96:111]
  ds_read_b64_tr_b16 a[228:229], v6 offset:39680
  ds_read_b64_tr_b16 a[230:231], v6 offset:39936
  v_lshlrev_b32 v96, 16, v240
  v_and_b32 v97, s95, v240
  v_lshlrev_b32 v98, 16, v241
  v_mfma_f32_32x32x16_bf16 a[112:127], a[236:239], v[220:223], a[112:127]
  ds_read_b64_tr_b16 a[232:233], v6 offset:39744
  ds_read_b64_tr_b16 a[234:235], v6 offset:40000
  v_and_b32 v99, s95, v241
  v_lshlrev_b32 v100, 16, v242
  v_and_b32 v101, s95, v242
  s_waitcnt lgkmcnt(6)
  v_mfma_f32_32x32x16_bf16 a[0:15], a[208:211], v[224:227], a[0:15]
  ds_read_b64_tr_b16 a[236:237], v6 offset:39808
  ds_read_b64_tr_b16 a[238:239], v6 offset:40064
  v_lshlrev_b32 v102, 16, v243
  v_and_b32 v103, s95, v243
  v_fma_f32 v96, v96, v24, v25
  v_mfma_f32_32x32x16_bf16 a[16:31], a[212:215], v[224:227], a[16:31]
  buffer_load_dwordx4 v16, s[12:15], s44 offen offset:0 lds
  ds_read_b64_tr_b16 a[208:209], v6 offset:43904
  ds_read_b64_tr_b16 a[210:211], v6 offset:44160
  v_fma_f32 v97, v97, v24, v25
  v_fma_f32 v98, v98, v24, v25
  v_mfma_f32_32x32x16_bf16 a[32:47], a[216:219], v[224:227], a[32:47]
  ds_read_b64_tr_b16 a[212:213], v6 offset:43984
  ds_read_b64_tr_b16 a[214:215], v6 offset:44240
  v_fma_f32 v99, v99, v24, v25
  v_fma_f32 v100, v100, v24, v25
  v_fma_f32 v101, v101, v24, v25
  v_mfma_f32_32x32x16_bf16 a[48:63], a[220:223], v[224:227], a[48:63]
  buffer_load_dwordx4 v17, s[12:15], s44 offen offset:1088 lds
  ds_read_b64_tr_b16 a[216:217], v6 offset:44064
  ds_read_b64_tr_b16 a[218:219], v6 offset:44320
  v_fma_f32 v102, v102, v24, v25
  v_fma_f32 v103, v103, v24, v25
  s_waitcnt lgkmcnt(6)
  v_mfma_f32_32x32x16_bf16 a[64:79], a[224:227], v[224:227], a[64:79]
  ds_read_b64_tr_b16 a[220:221], v7 offset:43904
  ds_read_b64_tr_b16 a[222:223], v7 offset:44160
  v_cvt_pk_bf16_f32 v240, v96, v97
  v_cvt_pk_bf16_f32 v241, v98, v99
  v_cvt_pk_bf16_f32 v242, v100, v101
  v_mfma_f32_32x32x16_bf16 a[80:95], a[228:231], v[224:227], a[80:95]
  buffer_load_dwordx4 v18, s[12:15], s44 offen offset:2176 lds
  ds_read_b64_tr_b16 a[224:225], v6 offset:48192
  ds_read_b64_tr_b16 a[226:227], v6 offset:48448
  v_cvt_pk_bf16_f32 v243, v102, v103
  v_lshlrev_b32 v96, 16, v244
  v_mfma_f32_32x32x16_bf16 a[96:111], a[232:235], v[224:227], a[96:111]
  ds_read_b64_tr_b16 a[228:229], v6 offset:48256
  ds_read_b64_tr_b16 a[230:231], v6 offset:48512
  v_and_b32 v97, s95, v244
  v_lshlrev_b32 v98, 16, v245
  v_and_b32 v99, s95, v245
  v_mfma_f32_32x32x16_bf16 a[112:127], a[236:239], v[224:227], a[112:127]
  buffer_load_dwordx4 v19, s[12:15], s44 offen offset:3264 lds
  ds_read_b64_tr_b16 a[232:233], v6 offset:48320
  ds_read_b64_tr_b16 a[234:235], v6 offset:48576
  v_lshlrev_b32 v100, 16, v246
  v_and_b32 v101, s95, v246
  s_waitcnt lgkmcnt(6)
  v_mfma_f32_32x32x16_bf16 a[0:15], a[208:211], v[228:231], a[0:15]
  ds_read_b64_tr_b16 a[236:237], v6 offset:48384
  ds_read_b64_tr_b16 a[238:239], v6 offset:48640
  s_add_u32 m0, s47, 141504
  s_add_u32 s44, s45, s84
  v_lshlrev_b32 v102, 16, v247
  v_mfma_f32_32x32x16_bf16 a[16:31], a[212:215], v[228:231], a[16:31]
  ds_read_b64_tr_b16 a[208:209], v6 offset:52480
  ds_read_b64_tr_b16 a[210:211], v6 offset:52736
  v_and_b32 v103, s95, v247
  v_fma_f32 v96, v96, v24, v25
  v_fma_f32 v97, v97, v24, v25
  v_mfma_f32_32x32x16_bf16 a[32:47], a[216:219], v[228:231], a[32:47]
  buffer_load_dwordx4 v20, s[12:15], s44 offen offset:0 lds
  ds_read_b64_tr_b16 a[212:213], v6 offset:52560
  ds_read_b64_tr_b16 a[214:215], v6 offset:52816
  v_fma_f32 v98, v98, v24, v25
  v_fma_f32 v99, v99, v24, v25
  v_mfma_f32_32x32x16_bf16 a[48:63], a[220:223], v[228:231], a[48:63]
  ds_read_b64_tr_b16 a[216:217], v6 offset:52640
  ds_read_b64_tr_b16 a[218:219], v6 offset:52896
  s_add_u32 m0, s47, 34304
  s_mul_i32 s45, s63, 4608
  s_add_u32 s44, s45, s83
  s_waitcnt lgkmcnt(6)
  v_mfma_f32_32x32x16_bf16 a[64:79], a[224:227], v[228:231], a[64:79]
  ds_read_b64_tr_b16 a[220:221], v7 offset:52480
  ds_read_b64_tr_b16 a[222:223], v7 offset:52736
  v_fma_f32 v100, v100, v24, v25
  v_fma_f32 v101, v101, v24, v25
  v_fma_f32 v102, v102, v24, v25
  v_mfma_f32_32x32x16_bf16 a[80:95], a[228:231], v[228:231], a[80:95]
  ds_read_b64_tr_b16 a[224:225], v6 offset:56768
  ds_read_b64_tr_b16 a[226:227], v6 offset:57024
  v_fma_f32 v103, v103, v24, v25
  v_cvt_pk_bf16_f32 v244, v96, v97
  v_cvt_pk_bf16_f32 v245, v98, v99
  v_mfma_f32_32x32x16_bf16 a[96:111], a[232:235], v[228:231], a[96:111]
  buffer_load_dwordx4 v16, s[12:15], s44 offen offset:0 lds
  ds_read_b64_tr_b16 a[228:229], v6 offset:56832
  ds_read_b64_tr_b16 a[230:231], v6 offset:57088
  v_cvt_pk_bf16_f32 v246, v100, v101
  v_cvt_pk_bf16_f32 v247, v102, v103
  v_mfma_f32_32x32x16_bf16 a[112:127], a[236:239], v[228:231], a[112:127]
  ds_read_b64_tr_b16 a[232:233], v6 offset:56896
  ds_read_b64_tr_b16 a[234:235], v6 offset:57152
  v_lshlrev_b32 v96, 16, v248
  v_and_b32 v97, s95, v248
  v_lshlrev_b32 v98, 16, v249
  s_waitcnt lgkmcnt(6)
  v_mfma_f32_32x32x16_bf16 a[0:15], a[208:211], v[232:235], a[0:15]
  buffer_load_dwordx4 v17, s[12:15], s44 offen offset:1088 lds
  ds_read_b64_tr_b16 a[236:237], v6 offset:56960
  ds_read_b64_tr_b16 a[238:239], v6 offset:57216
  v_and_b32 v99, s95, v249
  v_lshlrev_b32 v100, 16, v250
  v_mfma_f32_32x32x16_bf16 a[16:31], a[212:215], v[232:235], a[16:31]
  ds_read_b64_tr_b16 a[208:209], v6 offset:61056
  ds_read_b64_tr_b16 a[210:211], v6 offset:61312
  v_and_b32 v101, s95, v250
  v_lshlrev_b32 v102, 16, v251
  v_and_b32 v103, s95, v251
  v_mfma_f32_32x32x16_bf16 a[32:47], a[216:219], v[232:235], a[32:47]
  buffer_load_dwordx4 v18, s[12:15], s44 offen offset:2176 lds
  ds_read_b64_tr_b16 a[212:213], v6 offset:61136
  ds_read_b64_tr_b16 a[214:215], v6 offset:61392
  v_fma_f32 v96, v96, v24, v25
  v_fma_f32 v97, v97, v24, v25
  v_mfma_f32_32x32x16_bf16 a[48:63], a[220:223], v[232:235], a[48:63]
  ds_read_b64_tr_b16 a[216:217], v6 offset:61216
  ds_read_b64_tr_b16 a[218:219], v6 offset:61472
  v_fma_f32 v98, v98, v24, v25
  v_fma_f32 v99, v99, v24, v25
  v_fma_f32 v100, v100, v24, v25
  s_waitcnt lgkmcnt(6)
  v_mfma_f32_32x32x16_bf16 a[64:79], a[224:227], v[232:235], a[64:79]
  buffer_load_dwordx4 v19, s[12:15], s44 offen offset:3264 lds
  ds_read_b64_tr_b16 a[220:221], v7 offset:61056
  ds_read_b64_tr_b16 a[222:223], v7 offset:61312
  v_fma_f32 v101, v101, v24, v25
  v_fma_f32 v102, v102, v24, v25
  v_mfma_f32_32x32x16_bf16 a[80:95], a[228:231], v[232:235], a[80:95]
  v_add_u32 v6, 0xf800, v6
  ds_read_b64_tr_b16 a[224:225], v6 offset:1856
  ds_read_b64_tr_b16 a[226:227], v6 offset:2112
  s_add_u32 m0, s47, 38592
  s_add_u32 s44, s45, s84
  v_mfma_f32_32x32x16_bf16 a[96:111], a[232:235], v[232:235], a[96:111]
  buffer_load_dwordx4 v20, s[12:15], s44 offen offset:0 lds
  ds_read_b64_tr_b16 a[228:229], v6 offset:1920
  ds_read_b64_tr_b16 a[230:231], v6 offset:2176
  v_fma_f32 v103, v103, v24, v25
  v_cvt_pk_bf16_f32 v248, v96, v97
  v_mfma_f32_32x32x16_bf16 a[112:127], a[236:239], v[232:235], a[112:127]
  ds_read_b64_tr_b16 a[232:233], v6 offset:1984
  ds_read_b64_tr_b16 a[234:235], v6 offset:2240
  v_cvt_pk_bf16_f32 v249, v98, v99
  v_cvt_pk_bf16_f32 v250, v100, v101
  v_cvt_pk_bf16_f32 v251, v102, v103
  s_waitcnt lgkmcnt(6)
  v_mfma_f32_32x32x16_bf16 a[0:15], a[208:211], v[236:239], a[0:15]
  ds_read_b64_tr_b16 a[236:237], v6 offset:2048
  ds_read_b64_tr_b16 a[238:239], v6 offset:2304
  v_lshlrev_b32 v96, 16, v252
  v_and_b32 v97, s95, v252
  v_lshlrev_b32 v98, 16, v253
  s_waitcnt vmcnt(6)
  s_barrier
  v_mfma_f32_32x32x16_bf16 a[16:31], a[212:215], v[236:239], a[16:31]
  v_add_u32 v6, 0xfffe0000, v6
  ds_read_b64_tr_b16 a[208:209], v6 offset:0
  ds_read_b64_tr_b16 a[210:211], v6 offset:256
  s_add_u32 m0, s47, 55552
  s_mul_i32 s45, s64, 4608
  s_add_u32 s44, s45, s83
  v_mfma_f32_32x32x16_bf16 a[32:47], a[216:219], v[236:239], a[32:47]
  ds_read_b64_tr_b16 a[212:213], v6 offset:80
  ds_read_b64_tr_b16 a[214:215], v6 offset:336
  v_and_b32 v99, s95, v253
  v_lshlrev_b32 v100, 16, v254
  v_and_b32 v101, s95, v254
  v_mfma_f32_32x32x16_bf16 a[48:63], a[220:223], v[236:239], a[48:63]
  buffer_load_dwordx4 v16, s[12:15], s44 offen offset:0 lds
  ds_read_b64_tr_b16 a[216:217], v6 offset:160
  ds_read_b64_tr_b16 a[218:219], v6 offset:416
  v_lshlrev_b32 v102, 16, v255
  v_and_b32 v103, s95, v255
  s_waitcnt lgkmcnt(6)
  v_mfma_f32_32x32x16_bf16 a[64:79], a[224:227], v[236:239], a[64:79]
  v_add_u32 v7, 0xfffef800, v7
  ds_read_b64_tr_b16 a[220:221], v7 offset:0
  ds_read_b64_tr_b16 a[222:223], v7 offset:256
  v_fma_f32 v96, v96, v24, v25
  v_fma_f32 v97, v97, v24, v25
  v_mfma_f32_32x32x16_bf16 a[80:95], a[228:231], v[236:239], a[80:95]
  ds_read_b64_tr_b16 a[224:225], v6 offset:4288
  ds_read_b64_tr_b16 a[226:227], v6 offset:4544
  v_fma_f32 v98, v98, v24, v25
  v_fma_f32 v99, v99, v24, v25
  v_fma_f32 v100, v100, v24, v25
  v_mfma_f32_32x32x16_bf16 a[96:111], a[232:235], v[236:239], a[96:111]
  buffer_load_dwordx4 v17, s[12:15], s44 offen offset:1088 lds
  ds_read_b64_tr_b16 a[228:229], v6 offset:4352
  ds_read_b64_tr_b16 a[230:231], v6 offset:4608
  v_fma_f32 v101, v101, v24, v25
  v_fma_f32 v102, v102, v24, v25
  v_mfma_f32_32x32x16_bf16 a[112:127], a[236:239], v[236:239], a[112:127]
  ds_read_b64_tr_b16 a[232:233], v6 offset:4416
  ds_read_b64_tr_b16 a[234:235], v6 offset:4672
  v_fma_f32 v103, v103, v24, v25
  v_cvt_pk_bf16_f32 v252, v96, v97
  v_cvt_pk_bf16_f32 v253, v98, v99
  s_waitcnt lgkmcnt(6)
  v_mfma_f32_32x32x16_bf16 a[0:15], a[208:211], v[240:243], a[0:15]
  ds_read_b64_tr_b16 a[236:237], v6 offset:4480
  ds_read_b64_tr_b16 a[238:239], v6 offset:4736
  v_cvt_pk_bf16_f32 v254, v100, v101
  v_cvt_pk_bf16_f32 v255, v102, v103
  v_readfirstlane_b32 s92, v26
  s_nop 0
  s_cmp_lg_u32 s92, 0
  s_cbranch_scc0 L_slow_tag
L_back_tag:
  s_and_b32 s92, s92, -16
  s_xor_b32 s93, s92, 0x5bd1e995
  v_mfma_f32_32x32x16_bf16 a[16:31], a[212:215], v[240:243], a[16:31]
  buffer_load_dwordx4 v18, s[12:15], s44 offen offset:2176 lds
  ds_read_b64_tr_b16 a[208:209], v6 offset:8576
  ds_read_b64_tr_b16 a[210:211], v6 offset:8832
  v_mfma_f32_32x32x16_bf16 a[32:47], a[216:219], v[240:243], a[32:47]
  ds_read_b64_tr_b16 a[212:213], v6 offset:8656
  ds_read_b64_tr_b16 a[214:215], v6 offset:8912
  v_mfma_f32_32x32x16_bf16 a[48:63], a[220:223], v[240:243], a[48:63]
  ds_read_b64_tr_b16 a[216:217], v6 offset:8736
  ds_read_b64_tr_b16 a[218:219], v6 offset:8992
  s_waitcnt lgkmcnt(6)
  v_mfma_f32_32x32x16_bf16 a[64:79], a[224:227], v[240:243], a[64:79]
  buffer_load_dwordx4 v19, s[12:15], s44 offen offset:3264 lds
  ds_read_b64_tr_b16 a[220:221], v7 offset:8576
  ds_read_b64_tr_b16 a[222:223], v7 offset:8832
  v_mfma_f32_32x32x16_bf16 a[80:95], a[228:231], v[240:243], a[80:95]
  ds_read_b64_tr_b16 a[224:225], v6 offset:12864
  ds_read_b64_tr_b16 a[226:227], v6 offset:13120
  s_add_u32 m0, s47, 59840
  s_add_u32 s44, s45, s84
  v_mfma_f32_32x32x16_bf16 a[96:111], a[232:235], v[240:243], a[96:111]
  ds_read_b64_tr_b16 a[228:229], v6 offset:12928
  ds_read_b64_tr_b16 a[230:231], v6 offset:13184
  v_mfma_f32_32x32x16_bf16 a[112:127], a[236:239], v[240:243], a[112:127]
  buffer_load_dwordx4 v20, s[12:15], s44 offen offset:0 lds
  ds_read_b64_tr_b16 a[232:233], v6 offset:12992
  ds_read_b64_tr_b16 a[234:235], v6 offset:13248
  s_waitcnt lgkmcnt(6)
  v_mfma_f32_32x32x16_bf16 a[0:15], a[208:211], v[244:247], a[0:15]
  ds_read_b64_tr_b16 a[236:237], v6 offset:13056
  ds_read_b64_tr_b16 a[238:239], v6 offset:13312
  s_add_u32 m0, s47, 76800
  s_mul_i32 s45, s65, 4608
  s_add_u32 s44, s45, s83
  v_mfma_f32_32x32x16_bf16 a[16:31], a[212:215], v[244:247], a[16:31]
  ds_read_b64_tr_b16 a[208:209], v6 offset:17152
  ds_read_b64_tr_b16 a[210:211], v6 offset:17408
  v_mfma_f32_32x32x16_bf16 a[32:47], a[216:219], v[244:247], a[32:47]
  buffer_load_dwordx4 v16, s[12:15], s44 offen offset:0 lds
  ds_read_b64_tr_b16 a[212:213], v6 offset:17232
  ds_read_b64_tr_b16 a[214:215], v6 offset:17488
  v_mfma_f32_32x32x16_bf16 a[48:63], a[220:223], v[244:247], a[48:63]
  ds_read_b64_tr_b16 a[216:217], v6 offset:17312
  ds_read_b64_tr_b16 a[218:219], v6 offset:17568
  s_waitcnt lgkmcnt(6)
  v_mfma_f32_32x32x16_bf16 a[64:79], a[224:227], v[244:247], a[64:79]
  ds_read_b64_tr_b16 a[220:221], v7 offset:17152
  ds_read_b64_tr_b16 a[222:223], v7 offset:17408
  v_mfma_f32_32x32x16_bf16 a[80:95], a[228:231], v[244:247], a[80:95]
  buffer_load_dwordx4 v17, s[12:15], s44 offen offset:1088 lds
  ds_read_b64_tr_b16 a[224:225], v6 offset:21440
  ds_read_b64_tr_b16 a[226:227], v6 offset:21696
  v_mfma_f32_32x32x16_bf16 a[96:111], a[232:235], v[244:247], a[96:111]
  ds_read_b64_tr_b16 a[228:229], v6 offset:21504
  ds_read_b64_tr_b16 a[230:231], v6 offset:21760
  v_mfma_f32_32x32x16_bf16 a[112:127], a[236:239], v[244:247], a[112:127]
  ds_read_b64_tr_b16 a[232:233], v6 offset:21568
  ds_read_b64_tr_b16 a[234:235], v6 offset:21824
  s_waitcnt lgkmcnt(6)
  v_mfma_f32_32x32x16_bf16 a[0:15], a[208:211], v[248:251], a[0:15]
  buffer_load_dwordx4 v18, s[12:15], s44 offen offset:2176 lds
  ds_read_b64_tr_b16 a[236:237], v6 offset:21632
  ds_read_b64_tr_b16 a[238:239], v6 offset:21888
  v_mfma_f32_32x32x16_bf16 a[16:31], a[212:215], v[248:251], a[16:31]
  ds_read_b64_tr_b16 a[208:209], v6 offset:25728
  ds_read_b64_tr_b16 a[210:211], v6 offset:25984
  v_mfma_f32_32x32x16_bf16 a[32:47], a[216:219], v[248:251], a[32:47]
  ds_read_b64_tr_b16 a[212:213], v6 offset:25808
  ds_read_b64_tr_b16 a[214:215], v6 offset:26064
  v_mfma_f32_32x32x16_bf16 a[48:63], a[220:223], v[248:251], a[48:63]
  buffer_load_dwordx4 v19, s[12:15], s44 offen offset:3264 lds
  ds_read_b64_tr_b16 a[216:217], v6 offset:25888
  ds_read_b64_tr_b16 a[218:219], v6 offset:26144
  s_waitcnt lgkmcnt(6)
  v_mfma_f32_32x32x16_bf16 a[64:79], a[224:227], v[248:251], a[64:79]
  ds_read_b64_tr_b16 a[220:221], v7 offset:25728
  ds_read_b64_tr_b16 a[222:223], v7 offset:25984
  s_add_u32 m0, s47, 81088
  s_add_u32 s44, s45, s84
  v_mfma_f32_32x32x16_bf16 a[80:95], a[228:231], v[248:251], a[80:95]
  ds_read_b64_tr_b16 a[224:225], v6 offset:30016
  ds_read_b64_tr_b16 a[226:227], v6 offset:30272
  v_mfma_f32_32x32x16_bf16 a[96:111], a[232:235], v[248:251], a[96:111]
  buffer_load_dwordx4 v20, s[12:15], s44 offen offset:0 lds
  ds_read_b64_tr_b16 a[228:229], v6 offset:30080
  ds_read_b64_tr_b16 a[230:231], v6 offset:30336
  v_mfma_f32_32x32x16_bf16 a[112:127], a[236:239], v[248:251], a[112:127]
  ds_read_b64_tr_b16 a[232:233], v6 offset:30144
  ds_read_b64_tr_b16 a[234:235], v6 offset:30400
  s_waitcnt lgkmcnt(6)
  v_mfma_f32_32x32x16_bf16 a[0:15], a[208:211], v[252:255], a[0:15]
  ds_read_b64_tr_b16 a[236:237], v6 offset:30208
  ds_read_b64_tr_b16 a[238:239], v6 offset:30464
  s_waitcnt vmcnt(15)
  s_barrier
  v_mfma_f32_32x32x16_bf16 a[16:31], a[212:215], v[252:255], a[16:31]
  v_add_u32 v6, 0x21800, v6
  ds_read_b64_tr_b16 a[208:209], v6 offset:0
  ds_read_b64_tr_b16 a[210:211], v6 offset:256
  s_add_u32 m0, s47, 98048
  s_mul_i32 s45, s66, 4608
  s_add_u32 s44, s45, s83
  v_mfma_f32_32x32x16_bf16 a[32:47], a[216:219], v[252:255], a[32:47]
  buffer_load_dwordx4 v16, s[12:15], s44 offen offset:0 lds
L_pg3:
  s_cbranch_execz L_pg7
  ds_read_b64_tr_b16 a[212:213], v6 offset:64
  ds_read_b64_tr_b16 a[214:215], v6 offset:320
  v_mfma_f32_32x32x16_bf16 a[48:63], a[220:223], v[252:255], a[48:63]
  ds_read_b64_tr_b16 a[216:217], v6 offset:128
  ds_read_b64_tr_b16 a[218:219], v6 offset:384
  s_waitcnt lgkmcnt(6)
  v_mfma_f32_32x32x16_bf16 a[64:79], a[224:227], v[252:255], a[64:79]
  ds_read_b64_tr_b16 a[220:221], v6 offset:192
  ds_read_b64_tr_b16 a[222:223], v6 offset:448
  v_mfma_f32_32x32x16_bf16 a[80:95], a[228:231], v[252:255], a[80:95]
  buffer_load_dwordx4 v17, s[12:15], s44 offen offset:1088 lds
  v_add_u32 v8, 0x22800, v8
  ds_read_b64_tr_b16 a[224:225], v8 offset:192
  ds_read_b64_tr_b16 a[226:227], v8 offset:448
  v_mfma_f32_32x32x16_bf16 a[96:111], a[232:235], v[252:255], a[96:111]
  ds_read_b64_tr_b16 a[228:229], v6 offset:5312
  ds_read_b64_tr_b16 a[230:231], v6 offset:5568
  v_mfma_f32_32x32x16_bf16 a[112:127], a[236:239], v[252:255], a[112:127]
  ds_read_b64_tr_b16 a[232:233], v6 offset:5376
  ds_read_b64_tr_b16 a[234:235], v6 offset:5632
  s_waitcnt lgkmcnt(6)
  v_mfma_f32_32x32x16_bf16 a[128:143], a[208:211], v[112:115], 0
  buffer_load_dwordx4 v18, s[12:15], s44 offen offset:2176 lds
  ds_read_b64_tr_b16 a[236:237], v6 offset:5440
  ds_read_b64_tr_b16 a[238:239], v6 offset:5696
  v_mfma_f32_32x32x16_bf16 a[144:159], a[212:215], v[112:115], 0
  ds_read_b64_tr_b16 a[208:209], v6 offset:5504
  ds_read_b64_tr_b16 a[210:211], v6 offset:5760
  v_mov_b32 v25, s93
  v_mfma_f32_32x32x16_bf16 a[160:175], a[216:219], v[112:115], 0
  ds_read_b64_tr_b16 a[212:213], v8 offset:5504
  ds_read_b64_tr_b16 a[214:215], v8 offset:5760
  v_accvgpr_read_b32 v96, a16
  v_accvgpr_read_b32 v97, a17
  v_accvgpr_read_b32 v98, a18
  v_accvgpr_read_b32 v99, a19
  v_accvgpr_read_b32 v100, a20
  v_accvgpr_read_b32 v101, a21
  v_mfma_f32_32x32x16_bf16 a[176:191], a[220:223], v[112:115], 0
  buffer_load_dwordx4 v19, s[12:15], s44 offen offset:3264 lds
  ds_read_b64_tr_b16 a[216:217], v6 offset:10624
  ds_read_b64_tr_b16 a[218:219], v6 offset:10880
  v_accvgpr_read_b32 v102, a22
  v_accvgpr_read_b32 v103, a23
  v_cvt_pk_bf16_f32 v28, v96, v97
  v_cvt_pk_bf16_f32 v29, v98, v99
  v_cvt_pk_bf16_f32 v30, v100, v101
  s_waitcnt lgkmcnt(6)
  v_mfma_f32_32x32x16_bf16 a[192:207], a[224:227], v[112:115], 0
  ds_read_b64_tr_b16 a[220:221], v6 offset:10688
  ds_read_b64_tr_b16 a[222:223], v6 offset:10944
  s_add_u32 m0, s47, 102336
  s_add_u32 s44, s45, s84
  v_cvt_pk_bf16_f32 v31, v102, v103
  v_accvgpr_read_b32 v96, a24
  v_accvgpr_read_b32 v97, a25
  v_accvgpr_read_b32 v98, a26
  v_mfma_f32_32x32x16_bf16 a[128:143], a[228:231], v[116:119], a[128:143]
  ds_read_b64_tr_b16 a[224:225], v6 offset:10752
  ds_read_b64_tr_b16 a[226:227], v6 offset:11008
  v_accvgpr_read_b32 v99, a27
  v_accvgpr_read_b32 v100, a28
  v_accvgpr_read_b32 v101, a29
  v_accvgpr_read_b32 v102, a30
  v_accvgpr_read_b32 v103, a31
  v_cvt_pk_bf16_f32 v32, v96, v97
  v_mfma_f32_32x32x16_bf16 a[144:159], a[232:235], v[116:119], a[144:159]
  buffer_load_dwordx4 v20, s[12:15], s44 offen offset:0 lds
  ds_read_b64_tr_b16 a[228:229], v6 offset:10816
  ds_read_b64_tr_b16 a[230:231], v6 offset:11072
  v_cvt_pk_bf16_f32 v33, v98, v99
  v_cvt_pk_bf16_f32 v34, v100, v101
  v_cvt_pk_bf16_f32 v35, v102, v103
  buffer_store_dwordx4 v[28:31], v21, s[28:31], s89 offen sc1
  v_accvgpr_read_b32 v96, a52
  v_mfma_f32_32x32x16_bf16 a[160:175], a[236:239], v[116:119], a[160:175]
  ds_read_b64_tr_b16 a[232:233], v8 offset:10816
  ds_read_b64_tr_b16 a[234:235], v8 offset:11072
  v_accvgpr_read_b32 v97, a53
  v_accvgpr_read_b32 v98, a54
  v_accvgpr_read_b32 v99, a55
  v_accvgpr_read_b32 v100, a56
  v_accvgpr_read_b32 v101, a57
  v_accvgpr_read_b32 v102, a58
  s_waitcnt lgkmcnt(6)
  v_mfma_f32_32x32x16_bf16 a[176:191], a[208:211], v[116:119], a[176:191]
  ds_read_b64_tr_b16 a[236:237], v6 offset:15936
  ds_read_b64_tr_b16 a[238:239], v6 offset:16192
  v_accvgpr_read_b32 v103, a59
  v_cvt_pk_bf16_f32 v36, v96, v97
  v_cvt_pk_bf16_f32 v37, v98, v99
  v_cvt_pk_bf16_f32 v38, v100, v101
  v_cvt_pk_bf16_f32 v39, v102, v103
  v_cndmask_b32_e64 v42, 0, v32, s[96:97]
  v_mfma_f32_32x32x16_bf16 a[192:207], a[212:215], v[116:119], a[192:207]
  ds_read_b64_tr_b16 a[208:209], v6 offset:16000
  ds_read_b64_tr_b16 a[210:211], v6 offset:16256
  v_cndmask_b32_e64 v43, 0, v37, s[96:97]
  v_cndmask_b32_e64 v32, v32, v36, s[96:97]
  v_lshrrev_b32 v104, 1, v21
  buffer_store_dwordx4 v[32:35], v21, s[28:31], s89 offen offset:1024 sc1
  v_mov_b32 v40, 0x3f803f80
  v_mov_b32 v41, 0x3f803f80
  v_mfma_f32_32x32x16_bf16 a[128:143], a[216:219], v[120:123], a[128:143]
  ds_read_b64_tr_b16 a[212:213], v6 offset:16064
  ds_read_b64_tr_b16 a[214:215], v6 offset:16320
  v_accvgpr_read_b32 v96, a32
  v_accvgpr_read_b32 v97, a33
  v_accvgpr_read_b32 v98, a34
  v_accvgpr_read_b32 v99, a35
  v_accvgpr_read_b32 v100, a36
  v_accvgpr_read_b32 v101, a37
  v_mfma_f32_32x32x16_bf16 a[144:159], a[220:223], v[120:123], a[144:159]
  ds_read_b64_tr_b16 a[216:217], v6 offset:16128
  ds_read_b64_tr_b16 a[218:219], v6 offset:16384
  v_accvgpr_read_b32 v102, a38
  v_accvgpr_read_b32 v103, a39
  v_cvt_pk_bf16_f32 v44, v96, v97
  v_cvt_pk_bf16_f32 v45, v98, v99
  v_cvt_pk_bf16_f32 v46, v100, v101
  v_cvt_pk_bf16_f32 v47, v102, v103
  s_waitcnt lgkmcnt(6)
  v_mfma_f32_32x32x16_bf16 a[160:175], a[224:227], v[120:123], a[160:175]
  buffer_store_dwordx2 v[42:43], v104, s[28:31], s89 offen offset:2048 sc1
  ds_read_b64_tr_b16 a[220:221], v8 offset:16128
  ds_read_b64_tr_b16 a[222:223], v8 offset:16384
  v_accvgpr_read_b32 v96, a40
  v_accvgpr_read_b32 v97, a41
  v_accvgpr_read_b32 v98, a42
  v_accvgpr_read_b32 v99, a43
  v_accvgpr_read_b32 v100, a44
  s_waitcnt vmcnt(18)
  s_barrier
  v_mfma_f32_32x32x16_bf16 a[176:191], a[228:231], v[120:123], a[176:191]
  v_add_u32 v6, 0xfffe6800, v6
  ds_read_b64_tr_b16 a[224:225], v6 offset:1536
  ds_read_b64_tr_b16 a[226:227], v6 offset:1792
  s_add_u32 m0, s47, 0
  s_mul_i32 s45, s67, 4608
  s_add_u32 s44, s45, s83
  v_accvgpr_read_b32 v101, a45
  v_accvgpr_read_b32 v102, a46
  v_mfma_f32_32x32x16_bf16 a[192:207], a[232:235], v[120:123], a[192:207]
  buffer_load_dwordx4 v16, s[12:15], s44 offen offset:0 lds
  ds_read_b64_tr_b16 a[228:229], v6 offset:1600
  ds_read_b64_tr_b16 a[230:231], v6 offset:1856
  v_accvgpr_read_b32 v103, a47
  v_cvt_pk_bf16_f32 v48, v96, v97
  v_cvt_pk_bf16_f32 v49, v98, v99
  v_cvt_pk_bf16_f32 v50, v100, v101
  v_cvt_pk_bf16_f32 v51, v102, v103
  v_mfma_f32_32x32x16_bf16 a[128:143], a[236:239], v[124:127], a[128:143]
  buffer_store_dwordx4 v[44:47], v21, s[28:31], s89 offen offset:2560 sc1
  ds_read_b64_tr_b16 a[232:233], v6 offset:1664
  ds_read_b64_tr_b16 a[234:235], v6 offset:1920
  v_accvgpr_read_b32 v96, a0
  v_accvgpr_read_b32 v97, a1
  v_accvgpr_read_b32 v98, a2
  v_accvgpr_read_b32 v99, a3
  v_accvgpr_read_b32 v100, a4
  s_waitcnt lgkmcnt(6)
  v_mfma_f32_32x32x16_bf16 a[144:159], a[208:211], v[124:127], a[144:159]
  ds_read_b64_tr_b16 a[236:237], v6 offset:1728
  ds_read_b64_tr_b16 a[238:239], v6 offset:1984
  v_accvgpr_read_b32 v101, a5
  v_accvgpr_read_b32 v102, a6
  v_accvgpr_read_b32 v103, a7
  v_mul_f32 v96, 0x3eae1a93, v96
  v_mul_f32 v97, 0x3eae1a93, v97
  v_mul_f32 v98, 0x3eae1a93, v98
  v_mfma_f32_32x32x16_bf16 a[160:175], a[212:215], v[124:127], a[160:175]
  buffer_load_dwordx4 v17, s[12:15], s44 offen offset:1088 lds
  v_add_u32 v8, 0xfffe6800, v8
  ds_read_b64_tr_b16 a[208:209], v8 offset:1728
  ds_read_b64_tr_b16 a[210:211], v8 offset:1984
  v_mul_f32 v99, 0x3eae1a93, v99
  v_mul_f32 v100, 0x3eae1a93, v100
  v_mul_f32 v101, 0x3eae1a93, v101
  v_mul_f32 v102, 0x3eae1a93, v102
  v_mfma_f32_32x32x16_bf16 a[176:191], a[216:219], v[124:127], a[176:191]
  buffer_store_dwordx4 v[48:51], v21, s[28:31], s89 offen offset:3584 sc1
  ds_read_b64_tr_b16 a[212:213], v6 offset:6848
  ds_read_b64_tr_b16 a[214:215], v6 offset:7104
  v_mul_f32 v103, 0x3eae1a93, v103
  v_cvt_pk_bf16_f32 v60, v96, v97
  v_cvt_pk_bf16_f32 v61, v98, v99
  v_cvt_pk_bf16_f32 v62, v100, v101
  v_cvt_pk_bf16_f32 v63, v102, v103
  v_mfma_f32_32x32x16_bf16 a[192:207], a[220:223], v[124:127], a[192:207]
  ds_read_b64_tr_b16 a[216:217], v6 offset:6912
  ds_read_b64_tr_b16 a[218:219], v6 offset:7168
  v_accvgpr_read_b32 v96, a8
  v_accvgpr_read_b32 v97, a9
  v_accvgpr_read_b32 v98, a10
  v_accvgpr_read_b32 v99, a11
  v_accvgpr_read_b32 v100, a12
  v_accvgpr_read_b32 v101, a13
  s_waitcnt lgkmcnt(6)
  v_mfma_f32_32x32x16_bf16 a[128:143], a[224:227], v[128:131], a[128:143]
  buffer_load_dwordx4 v18, s[12:15], s44 offen offset:2176 lds
  ds_read_b64_tr_b16 a[220:221], v6 offset:6976
  ds_read_b64_tr_b16 a[222:223], v6 offset:7232
  v_accvgpr_read_b32 v102, a14
  v_accvgpr_read_b32 v103, a15
  v_mul_f32 v96, 0x3eae1a93, v96
  v_mul_f32 v97, 0x3eae1a93, v97
  v_mul_f32 v98, 0x3eae1a93, v98
  v_mfma_f32_32x32x16_bf16 a[144:159], a[228:231], v[128:131], a[144:159]
  ds_read_b64_tr_b16 a[224:225], v6 offset:7040
  ds_read_b64_tr_b16 a[226:227], v6 offset:7296
  v_mul_f32 v99, 0x3eae1a93, v99
  v_mul_f32 v100, 0x3eae1a93, v100
  v_mul_f32 v101, 0x3eae1a93, v101
  v_mul_f32 v102, 0x3eae1a93, v102
  v_mul_f32 v103, 0x3eae1a93, v103
  v_cvt_pk_bf16_f32 v64, v96, v97
  v_mfma_f32_32x32x16_bf16 a[160:175], a[232:235], v[128:131], a[160:175]
  buffer_store_dwordx4 v[38:41], v23, s[28:31], s89 offen offset:3584 sc1
  ds_read_b64_tr_b16 a[228:229], v8 offset:7040
  ds_read_b64_tr_b16 a[230:231], v8 offset:7296
  v_cvt_pk_bf16_f32 v65, v98, v99
  v_cvt_pk_bf16_f32 v66, v100, v101
  v_cvt_pk_bf16_f32 v67, v102, v103
  v_accvgpr_read_b32 v96, a48
  v_accvgpr_read_b32 v97, a49
  v_mfma_f32_32x32x16_bf16 a[176:191], a[236:239], v[128:131], a[176:191]
  buffer_load_dwordx4 v19, s[12:15], s44 offen offset:3264 lds
  ds_read_b64_tr_b16 a[232:233], v6 offset:12160
  ds_read_b64_tr_b16 a[234:235], v6 offset:12416
  v_accvgpr_read_b32 v98, a50
  v_accvgpr_read_b32 v99, a51
  v_mul_f32 v96, 0x3eae1a93, v96
  v_mul_f32 v97, 0x3eae1a93, v97
  v_mul_f32 v98, 0x3eae1a93, v98
  s_waitcnt lgkmcnt(6)
  v_mfma_f32_32x32x16_bf16 a[192:207], a[208:211], v[128:131], a[192:207]
  ds_read_b64_tr_b16 a[236:237], v6 offset:12224
  ds_read_b64_tr_b16 a[238:239], v6 offset:12480
  s_add_u32 m0, s47, 4288
  s_add_u32 s44, s45, s84
  v_mul_f32 v99, 0x3eae1a93, v99
  v_mfma_f32_32x32x16_bf16 a[128:143], a[212:215], v[132:135], a[128:143]
  ds_read_b64_tr_b16 a[208:209], v6 offset:12288
  ds_read_b64_tr_b16 a[210:211], v6 offset:12544
  v_cvt_pk_bf16_f32 v74, v96, v97
  v_cvt_pk_bf16_f32 v75, v98, v99
  v_mov_b32 v73, 0x3f80
  v_mfma_f32_32x32x16_bf16 a[144:159], a[216:219], v[132:135], a[144:159]
  buffer_load_dwordx4 v20, s[12:15], s44 offen offset:0 lds
  ds_read_b64_tr_b16 a[212:213], v6 offset:12352
  ds_read_b64_tr_b16 a[214:215], v6 offset:12608
  v_cndmask_b32_e64 v68, v73, v64, s[96:97]
  v_cndmask_b32_e64 v64, v64, v74, s[96:97]
  v_mfma_f32_32x32x16_bf16 a[160:175], a[220:223], v[132:135], a[160:175]
  ds_read_b64_tr_b16 a[216:217], v8 offset:12352
  ds_read_b64_tr_b16 a[218:219], v8 offset:12608
  v_cndmask_b32_e64 v73, v73, v75, s[96:97]
  v_mov_b32 v69, 0
  v_mov_b32 v70, 0
  s_waitcnt lgkmcnt(6)
  v_mfma_f32_32x32x16_bf16 a[176:191], a[224:227], v[132:135], a[176:191]
  ds_read_b64_tr_b16 a[220:221], v6 offset:17472
  ds_read_b64_tr_b16 a[222:223], v6 offset:17728
  v_mov_b32 v71, 0
  v_mov_b32 v72, 0
  v_mov_b32 v74, 0
  v_mfma_f32_32x32x16_bf16 a[192:207], a[228:231], v[132:135], a[192:207]
  ds_read_b64_tr_b16 a[224:225], v6 offset:17536
  ds_read_b64_tr_b16 a[226:227], v6 offset:17792
  v_mov_b32 v75, 0
  v_accvgpr_read_b32 v96, a64
  v_accvgpr_read_b32 v97, a65
  v_mfma_f32_32x32x16_bf16 a[128:143], a[232:235], v[136:139], a[128:143]
  ds_read_b64_tr_b16 a[228:229], v6 offset:17600
  ds_read_b64_tr_b16 a[230:231], v6 offset:17856
  v_accvgpr_read_b32 v98, a66
  v_accvgpr_read_b32 v99, a67
  v_accvgpr_read_b32 v100, a68
  v_mfma_f32_32x32x16_bf16 a[144:159], a[236:239], v[136:139], a[144:159]
  ds_read_b64_tr_b16 a[232:233], v6 offset:17664
  ds_read_b64_tr_b16 a[234:235], v6 offset:17920
  v_accvgpr_read_b32 v101, a69
  v_accvgpr_read_b32 v102, a70
  v_accvgpr_read_b32 v103, a71
  s_waitcnt lgkmcnt(6)
  v_mfma_f32_32x32x16_bf16 a[160:175], a[208:211], v[136:139], a[160:175]
  ds_read_b64_tr_b16 a[236:237], v8 offset:17664
  ds_read_b64_tr_b16 a[238:239], v8 offset:17920
  v_cvt_pk_bf16_f32 v28, v96, v97
  v_cvt_pk_bf16_f32 v29, v98, v99
  v_cvt_pk_bf16_f32 v30, v100, v101
  s_waitcnt vmcnt(21)
  s_barrier
  v_mfma_f32_32x32x16_bf16 a[176:191], a[212:215], v[136:139], a[176:191]
  ds_read_b64_tr_b16 a[208:209], v6 offset:22784
  ds_read_b64_tr_b16 a[210:211], v6 offset:23040
  v_cvt_pk_bf16_f32 v31, v102, v103
  v_pk_max_i16 v28, v28, 0
  v_pk_max_i16 v29, v29, 0
  v_mfma_f32_32x32x16_bf16 a[192:207], a[216:219], v[136:139], a[192:207]
  ds_read_b64_tr_b16 a[212:213], v6 offset:22848
  ds_read_b64_tr_b16 a[214:215], v6 offset:23104
  v_pk_max_i16 v30, v30, 0
  v_pk_max_i16 v31, v31, 0
  v_accvgpr_read_b32 v96, a72
  v_mfma_f32_32x32x16_bf16 a[128:143], a[220:223], v[140:143], a[128:143]
  ds_read_b64_tr_b16 a[216:217], v6 offset:22912
  ds_read_b64_tr_b16 a[218:219], v6 offset:23168
  v_accvgpr_read_b32 v97, a73
  v_accvgpr_read_b32 v98, a74
  v_accvgpr_read_b32 v99, a75
  s_waitcnt lgkmcnt(6)
  v_mfma_f32_32x32x16_bf16 a[144:159], a[224:227], v[140:143], a[144:159]
  ds_read_b64_tr_b16 a[220:221], v6 offset:22976
  ds_read_b64_tr_b16 a[222:223], v6 offset:23232
  v_accvgpr_read_b32 v100, a76
  v_accvgpr_read_b32 v101, a77
  v_accvgpr_read_b32 v102, a78
  v_mfma_f32_32x32x16_bf16 a[160:175], a[228:231], v[140:143], a[160:175]
  ds_read_b64_tr_b16 a[224:225], v8 offset:22976
  ds_read_b64_tr_b16 a[226:227], v8 offset:23232
  v_accvgpr_read_b32 v103, a79
  v_cvt_pk_bf16_f32 v32, v96, v97
  v_cvt_pk_bf16_f32 v33, v98, v99
  v_mfma_f32_32x32x16_bf16 a[176:191], a[232:235], v[140:143], a[176:191]
  ds_read_b64_tr_b16 a[228:229], v6 offset:28096
  ds_read_b64_tr_b16 a[230:231], v6 offset:28352
  v_cvt_pk_bf16_f32 v34, v100, v101
  v_cvt_pk_bf16_f32 v35, v102, v103
  v_pk_max_i16 v32, v32, 0
  v_mfma_f32_32x32x16_bf16 a[192:207], a[236:239], v[140:143], a[192:207]
  ds_read_b64_tr_b16 a[232:233], v6 offset:28160
  ds_read_b64_tr_b16 a[234:235], v6 offset:28416
  v_pk_max_i16 v33, v33, 0
  v_pk_max_i16 v34, v34, 0
  v_pk_max_i16 v35, v35, 0
  s_waitcnt lgkmcnt(6)
  v_mfma_f32_32x32x16_bf16 a[128:143], a[208:211], v[144:147], a[128:143]
  ds_read_b64_tr_b16 a[236:237], v6 offset:28224
  ds_read_b64_tr_b16 a[238:239], v6 offset:28480
  v_accvgpr_read_b32 v96, a80
  v_accvgpr_read_b32 v97, a81
  v_accvgpr_read_b32 v98, a82
  v_mfma_f32_32x32x16_bf16 a[144:159], a[212:215], v[144:147], a[144:159]
  ds_read_b64_tr_b16 a[208:209], v6 offset:28288
  ds_read_b64_tr_b16 a[210:211], v6 offset:28544
  v_accvgpr_read_b32 v99, a83
  v_accvgpr_read_b32 v100, a84
  v_accvgpr_read_b32 v101, a85
  v_mfma_f32_32x32x16_bf16 a[160:175], a[216:219], v[144:147], a[160:175]
  ds_read_b64_tr_b16 a[212:213], v8 offset:28288
  ds_read_b64_tr_b16 a[214:215], v8 offset:28544
  s_lshr_b32 s3, s2, 3
  s_lshl_b32 s3, s3, 2
  s_add_u32 s3, s3, s60
  s_lshl_b32 s3, s3, 9
  v_mfma_f32_32x32x16_bf16 a[176:191], a[220:223], v[144:147], a[176:191]
  ds_read_b64_tr_b16 a[216:217], v6 offset:33408
  ds_read_b64_tr_b16 a[218:219], v6 offset:33664
  v_accvgpr_read_b32 v26, a246
  buffer_load_dword v26, v26, s[36:39], s3 offen
  v_accvgpr_read_b32 v102, a86
  s_waitcnt lgkmcnt(6)
  v_mfma_f32_32x32x16_bf16 a[192:207], a[224:227], v[144:147], a[192:207]
  ds_read_b64_tr_b16 a[220:221], v6 offset:33472
  ds_read_b64_tr_b16 a[222:223], v6 offset:33728
  v_accvgpr_read_b32 v103, a87
  v_cvt_pk_bf16_f32 v36, v96, v97
  v_cvt_pk_bf16_f32 v37, v98, v99
  v_mfma_f32_32x32x16_bf16 a[128:143], a[228:231], v[148:151], a[128:143]
  ds_read_b64_tr_b16 a[224:225], v6 offset:33536
  ds_read_b64_tr_b16 a[226:227], v6 offset:33792
  v_cvt_pk_bf16_f32 v38, v100, v101
  v_cvt_pk_bf16_f32 v39, v102, v103
  v_pk_max_i16 v36, v36, 0
  v_mfma_f32_32x32x16_bf16 a[144:159], a[232:235], v[148:151], a[144:159]
  ds_read_b64_tr_b16 a[228:229], v6 offset:33600
  ds_read_b64_tr_b16 a[230:231], v6 offset:33856
  v_pk_max_i16 v37, v37, 0
  v_pk_max_i16 v38, v38, 0
  v_pk_max_i16 v39, v39, 0
  v_mfma_f32_32x32x16_bf16 a[160:175], a[236:239], v[148:151], a[160:175]
  ds_read_b64_tr_b16 a[232:233], v8 offset:33600
  ds_read_b64_tr_b16 a[234:235], v8 offset:33856
  v_accvgpr_read_b32 v96, a88
  v_accvgpr_read_b32 v97, a89
  v_accvgpr_read_b32 v98, a90
  s_waitcnt lgkmcnt(6)
  v_mfma_f32_32x32x16_bf16 a[176:191], a[208:211], v[148:151], a[176:191]
  ds_read_b64_tr_b16 a[236:237], v6 offset:38720
  ds_read_b64_tr_b16 a[238:239], v6 offset:38976
  v_accvgpr_read_b32 v99, a91
  v_accvgpr_read_b32 v100, a92
  v_accvgpr_read_b32 v101, a93
  v_mfma_f32_32x32x16_bf16 a[192:207], a[212:215], v[148:151], a[192:207]
  ds_read_b64_tr_b16 a[208:209], v6 offset:38784
  ds_read_b64_tr_b16 a[210:211], v6 offset:39040
  v_accvgpr_read_b32 v102, a94
  v_accvgpr_read_b32 v103, a95
  v_cvt_pk_bf16_f32 v40, v96, v97
  v_mfma_f32_32x32x16_bf16 a[128:143], a[216:219], v[152:155], a[128:143]
  ds_read_b64_tr_b16 a[212:213], v6 offset:38848
  ds_read_b64_tr_b16 a[214:215], v6 offset:39104
  v_cvt_pk_bf16_f32 v41, v98, v99
  v_cvt_pk_bf16_f32 v42, v100, v101
  v_cvt_pk_bf16_f32 v43, v102, v103
  v_mfma_f32_32x32x16_bf16 a[144:159], a[220:223], v[152:155], a[144:159]
  ds_read_b64_tr_b16 a[216:217], v6 offset:38912
  ds_read_b64_tr_b16 a[218:219], v6 offset:39168
  v_pk_max_i16 v40, v40, 0
  v_pk_max_i16 v41, v41, 0
  v_pk_max_i16 v42, v42, 0
  s_waitcnt lgkmcnt(6)
  v_mfma_f32_32x32x16_bf16 a[160:175], a[224:227], v[152:155], a[160:175]
  ds_read_b64_tr_b16 a[220:221], v8 offset:38912
  ds_read_b64_tr_b16 a[222:223], v8 offset:39168
  s_waitcnt vmcnt(3)
  s_add_u32 s76, s92, 1
  v_mov_b32 v24, s76
  buffer_store_dwordx2 v[24:25], v4, s[28:31], s90 offen sc1
  s_barrier
  v_mfma_f32_32x32x16_bf16 a[176:191], a[228:231], v[152:155], a[176:191]
  ds_read_b64_tr_b16 a[224:225], v6 offset:44032
  ds_read_b64_tr_b16 a[226:227], v6 offset:44288
  s_add_u32 m0, s47, 21248
  s_mul_i32 s45, s68, 4608
  s_add_u32 s44, s45, s83
  v_mfma_f32_32x32x16_bf16 a[192:207], a[232:235], v[152:155], a[192:207]
  buffer_load_dwordx4 v16, s[12:15], s44 offen offset:0 lds
  ds_read_b64_tr_b16 a[228:229], v6 offset:44096
  ds_read_b64_tr_b16 a[230:231], v6 offset:44352
  v_pk_max_i16 v43, v43, 0
  v_accvgpr_read_b32 v96, a96
  v_mfma_f32_32x32x16_bf16 a[128:143], a[236:239], v[156:159], a[128:143]
  ds_read_b64_tr_b16 a[232:233], v6 offset:44160
  ds_read_b64_tr_b16 a[234:235], v6 offset:44416
  v_accvgpr_read_b32 v97, a97
  v_accvgpr_read_b32 v98, a98
  v_accvgpr_read_b32 v99, a99
  s_waitcnt lgkmcnt(6)
  v_mfma_f32_32x32x16_bf16 a[144:159], a[208:211], v[156:159], a[144:159]
  ds_read_b64_tr_b16 a[236:237], v6 offset:44224
  ds_read_b64_tr_b16 a[238:239], v6 offset:44480
  s_add_u32 s51, s56, 0
  buffer_store_dwordx4 v[28:31], v21, s[28:31], s51 offen offset:0 sc1
  v_accvgpr_read_b32 v100, a100
  v_mfma_f32_32x32x16_bf16 a[160:175], a[212:215], v[156:159], a[160:175]
  buffer_load_dwordx4 v17, s[12:15], s44 offen offset:1088 lds
  ds_read_b64_tr_b16 a[208:209], v8 offset:44224
  ds_read_b64_tr_b16 a[210:211], v8 offset:44480
  v_accvgpr_read_b32 v101, a101
  v_accvgpr_read_b32 v102, a102
  v_mfma_f32_32x32x16_bf16 a[176:191], a[216:219], v[156:159], a[176:191]
  ds_read_b64_tr_b16 a[212:213], v6 offset:49344
  ds_read_b64_tr_b16 a[214:215], v6 offset:49600
  v_accvgpr_read_b32 v103, a103
  v_cvt_pk_bf16_f32 v44, v96, v97
  v_cvt_pk_bf16_f32 v45, v98, v99
  v_mfma_f32_32x32x16_bf16 a[192:207], a[220:223], v[156:159], a[192:207]
  ds_read_b64_tr_b16 a[216:217], v6 offset:49408
  ds_read_b64_tr_b16 a[218:219], v6 offset:49664
  v_cvt_pk_bf16_f32 v46, v100, v101
  v_cvt_pk_bf16_f32 v47, v102, v103
  v_pk_max_i16 v44, v44, 0
  s_waitcnt lgkmcnt(6)
  v_mfma_f32_32x32x16_bf16 a[128:143], a[224:227], v[160:163], a[128:143]
  buffer_load_dwordx4 v18, s[12:15], s44 offen offset:2176 lds
  ds_read_b64_tr_b16 a[220:221], v6 offset:49472
  ds_read_b64_tr_b16 a[222:223], v6 offset:49728
  v_pk_max_i16 v45, v45, 0
  v_pk_max_i16 v46, v46, 0
  v_mfma_f32_32x32x16_bf16 a[144:159], a[228:231], v[160:163], a[144:159]
  ds_read_b64_tr_b16 a[224:225], v6 offset:49536
  ds_read_b64_tr_b16 a[226:227], v6 offset:49792
  v_pk_max_i16 v47, v47, 0
  v_accvgpr_read_b32 v96, a104
  v_accvgpr_read_b32 v97, a105
  v_mfma_f32_32x32x16_bf16 a[160:175], a[232:235], v[160:163], a[160:175]
  buffer_store_dwordx4 v[32:35], v21, s[28:31], s51 offen offset:1024 sc1
  ds_read_b64_tr_b16 a[228:229], v8 offset:49536
  ds_read_b64_tr_b16 a[230:231], v8 offset:49792
  v_accvgpr_read_b32 v98, a106
  v_accvgpr_read_b32 v99, a107
  v_mfma_f32_32x32x16_bf16 a[176:191], a[236:239], v[160:163], a[176:191]
  buffer_load_dwordx4 v19, s[12:15], s44 offen offset:3264 lds
  ds_read_b64_tr_b16 a[232:233], v6 offset:54656
  ds_read_b64_tr_b16 a[234:235], v6 offset:54912
  v_accvgpr_read_b32 v100, a108
  v_accvgpr_read_b32 v101, a109
  s_waitcnt lgkmcnt(6)
  v_mfma_f32_32x32x16_bf16 a[192:207], a[208:211], v[160:163], a[192:207]
  ds_read_b64_tr_b16 a[236:237], v6 offset:54720
  ds_read_b64_tr_b16 a[238:239], v6 offset:54976
  s_add_u32 m0, s47, 25536
  s_add_u32 s44, s45, s84
  v_accvgpr_read_b32 v102, a110
  v_mfma_f32_32x32x16_bf16 a[128:143], a[212:215], v[164:167], a[128:143]
  ds_read_b64_tr_b16 a[208:209], v6 offset:54784
  ds_read_b64_tr_b16 a[210:211], v6 offset:55040
  v_accvgpr_read_b32 v103, a111
  v_cvt_pk_bf16_f32 v48, v96, v97
  v_cvt_pk_bf16_f32 v49, v98, v99
  v_mfma_f32_32x32x16_bf16 a[144:159], a[216:219], v[164:167], a[144:159]
  buffer_load_dwordx4 v20, s[12:15], s44 offen offset:0 lds
  ds_read_b64_tr_b16 a[212:213], v6 offset:54848
  ds_read_b64_tr_b16 a[214:215], v6 offset:55104
  v_cvt_pk_bf16_f32 v50, v100, v101
  v_cvt_pk_bf16_f32 v51, v102, v103
  v_mfma_f32_32x32x16_bf16 a[160:175], a[220:223], v[164:167], a[160:175]
  ds_read_b64_tr_b16 a[216:217], v8 offset:54848
  ds_read_b64_tr_b16 a[218:219], v8 offset:55104
  v_pk_max_i16 v48, v48, 0
  v_pk_max_i16 v49, v49, 0
  v_pk_max_i16 v50, v50, 0
  s_waitcnt lgkmcnt(6)
  v_mfma_f32_32x32x16_bf16 a[176:191], a[224:227], v[164:167], a[176:191]
  ds_read_b64_tr_b16 a[220:221], v6 offset:59968
  ds_read_b64_tr_b16 a[222:223], v6 offset:60224
  v_pk_max_i16 v51, v51, 0
  v_accvgpr_read_b32 v96, a112
  v_accvgpr_read_b32 v97, a113
  v_mfma_f32_32x32x16_bf16 a[192:207], a[228:231], v[164:167], a[192:207]
  ds_read_b64_tr_b16 a[224:225], v6 offset:60032
  ds_read_b64_tr_b16 a[226:227], v6 offset:60288
  v_accvgpr_read_b32 v98, a114
  v_accvgpr_read_b32 v99, a115
  v_accvgpr_read_b32 v100, a116
  v_mfma_f32_32x32x16_bf16 a[128:143], a[232:235], v[168:171], a[128:143]
  ds_read_b64_tr_b16 a[228:229], v6 offset:60096
  ds_read_b64_tr_b16 a[230:231], v6 offset:60352
  v_accvgpr_read_b32 v101, a117
  v_accvgpr_read_b32 v102, a118
  v_accvgpr_read_b32 v103, a119
  v_mfma_f32_32x32x16_bf16 a[144:159], a[236:239], v[168:171], a[144:159]
  buffer_store_dwordx4 v[36:39], v21, s[28:31], s51 offen offset:2048 sc1
L_pg4:
  s_cbranch_execz L_pg8
  ds_read_b64_tr_b16 a[232:233], v6 offset:60160
  ds_read_b64_tr_b16 a[234:235], v6 offset:60416
  v_cvt_pk_bf16_f32 v52, v96, v97
  v_cvt_pk_bf16_f32 v53, v98, v99
  s_waitcnt lgkmcnt(6)
  v_mfma_f32_32x32x16_bf16 a[160:175], a[208:211], v[168:171], a[160:175]
  ds_read_b64_tr_b16 a[236:237], v8 offset:60160
  ds_read_b64_tr_b16 a[238:239], v8 offset:60416
  v_cvt_pk_bf16_f32 v54, v100, v101
  v_cvt_pk_bf16_f32 v55, v102, v103
  v_pk_max_i16 v52, v52, 0
  s_barrier
  v_mfma_f32_32x32x16_bf16 a[176:191], a[212:215], v[168:171], a[176:191]
  v_add_u32 v6, 0xf800, v6
  ds_read_b64_tr_b16 a[208:209], v6 offset:1792
  ds_read_b64_tr_b16 a[210:211], v6 offset:2048
  s_add_u32 m0, s47, 42496
  s_mul_i32 s45, s69, 4608
  s_add_u32 s44, s45, s83
  v_mfma_f32_32x32x16_bf16 a[192:207], a[216:219], v[168:171], a[192:207]
  buffer_load_dwordx4 v16, s[12:15], s44 offen offset:0 lds
  ds_read_b64_tr_b16 a[212:213], v6 offset:1856
  ds_read_b64_tr_b16 a[214:215], v6 offset:2112
  v_pk_max_i16 v53, v53, 0
  v_pk_max_i16 v54, v54, 0
  v_mfma_f32_32x32x16_bf16 a[128:143], a[220:223], v[172:175], a[128:143]
  ds_read_b64_tr_b16 a[216:217], v6 offset:1920
  ds_read_b64_tr_b16 a[218:219], v6 offset:2176
  v_pk_max_i16 v55, v55, 0
  v_accvgpr_read_b32 v96, a120
  v_accvgpr_read_b32 v97, a121
  s_waitcnt lgkmcnt(6)
  v_mfma_f32_32x32x16_bf16 a[144:159], a[224:227], v[172:175], a[144:159]
  buffer_store_dwordx4 v[40:43], v21, s[28:31], s51 offen offset:3072 sc1
  ds_read_b64_tr_b16 a[220:221], v6 offset:1984
  ds_read_b64_tr_b16 a[222:223], v6 offset:2240
  v_accvgpr_read_b32 v98, a122
  v_accvgpr_read_b32 v99, a123
  v_mfma_f32_32x32x16_bf16 a[160:175], a[228:231], v[172:175], a[160:175]
  buffer_load_dwordx4 v17, s[12:15], s44 offen offset:1088 lds
  v_add_u32 v8, 0xf800, v8
  ds_read_b64_tr_b16 a[224:225], v8 offset:1984
  ds_read_b64_tr_b16 a[226:227], v8 offset:2240
  v_accvgpr_read_b32 v100, a124
  v_mfma_f32_32x32x16_bf16 a[176:191], a[232:235], v[172:175], a[176:191]
  ds_read_b64_tr_b16 a[228:229], v6 offset:7104
  ds_read_b64_tr_b16 a[230:231], v6 offset:7360
  v_accvgpr_read_b32 v101, a125
  v_accvgpr_read_b32 v102, a126
  v_accvgpr_read_b32 v103, a127
  v_mfma_f32_32x32x16_bf16 a[192:207], a[236:239], v[172:175], a[192:207]
  ds_read_b64_tr_b16 a[232:233], v6 offset:7168
  ds_read_b64_tr_b16 a[234:235], v6 offset:7424
  v_cvt_pk_bf16_f32 v56, v96, v97
  v_cvt_pk_bf16_f32 v57, v98, v99
  v_cvt_pk_bf16_f32 v58, v100, v101
  s_waitcnt lgkmcnt(6)
  v_mfma_f32_32x32x16_bf16 a[128:143], a[208:211], v[176:179], a[128:143]
  buffer_load_dwordx4 v18, s[12:15], s44 offen offset:2176 lds
  ds_read_b64_tr_b16 a[236:237], v6 offset:7232
  ds_read_b64_tr_b16 a[238:239], v6 offset:7488
  v_cvt_pk_bf16_f32 v59, v102, v103
  v_pk_max_i16 v56, v56, 0
  v_mfma_f32_32x32x16_bf16 a[144:159], a[212:215], v[176:179], a[144:159]
  ds_read_b64_tr_b16 a[208:209], v6 offset:7296
  ds_read_b64_tr_b16 a[210:211], v6 offset:7552
  v_pk_max_i16 v57, v57, 0
  v_pk_max_i16 v58, v58, 0
  v_pk_max_i16 v59, v59, 0
  v_mfma_f32_32x32x16_bf16 a[160:175], a[216:219], v[176:179], a[160:175]
  ds_read_b64_tr_b16 a[212:213], v8 offset:7296
  ds_read_b64_tr_b16 a[214:215], v8 offset:7552
  v_mfma_f32_32x32x16_bf16 a[176:191], a[220:223], v[176:179], a[176:191]
  buffer_load_dwordx4 v19, s[12:15], s44 offen offset:3264 lds
  ds_read_b64_tr_b16 a[216:217], v6 offset:12416
  ds_read_b64_tr_b16 a[218:219], v6 offset:12672
  s_waitcnt lgkmcnt(6)
  v_mfma_f32_32x32x16_bf16 a[192:207], a[224:227], v[176:179], a[192:207]
  ds_read_b64_tr_b16 a[220:221], v6 offset:12480
  ds_read_b64_tr_b16 a[222:223], v6 offset:12736
  s_add_u32 m0, s47, 46784
  s_add_u32 s44, s45, s84
  v_mfma_f32_32x32x16_bf16 a[128:143], a[228:231], v[180:183], a[128:143]
  ds_read_b64_tr_b16 a[224:225], v6 offset:12544
  ds_read_b64_tr_b16 a[226:227], v6 offset:12800
  s_add_u32 s51, s56, 4096
  buffer_store_dwordx4 v[44:47], v21, s[28:31], s51 offen offset:0 sc1
  v_mfma_f32_32x32x16_bf16 a[144:159], a[232:235], v[180:183], a[144:159]
  buffer_load_dwordx4 v20, s[12:15], s44 offen offset:0 lds
  ds_read_b64_tr_b16 a[228:229], v6 offset:12608
  ds_read_b64_tr_b16 a[230:231], v6 offset:12864
  v_mfma_f32_32x32x16_bf16 a[160:175], a[236:239], v[180:183], a[160:175]
  ds_read_b64_tr_b16 a[232:233], v8 offset:12608
  ds_read_b64_tr_b16 a[234:235], v8 offset:12864
  s_waitcnt lgkmcnt(6)
  v_mfma_f32_32x32x16_bf16 a[176:191], a[208:211], v[180:183], a[176:191]
  ds_read_b64_tr_b16 a[236:237], v6 offset:17728
  ds_read_b64_tr_b16 a[238:239], v6 offset:17984
  v_mfma_f32_32x32x16_bf16 a[192:207], a[212:215], v[180:183], a[192:207]
  s_waitcnt vmcnt(16)
  buffer_load_dwordx2 v[26:27], v5, s[28:31], 0 offen sc1
  ds_read_b64_tr_b16 a[208:209], v6 offset:17792
  ds_read_b64_tr_b16 a[210:211], v6 offset:18048
  v_mfma_f32_32x32x16_bf16 a[128:143], a[216:219], v[184:187], a[128:143]
  ds_read_b64_tr_b16 a[212:213], v6 offset:17856
  ds_read_b64_tr_b16 a[214:215], v6 offset:18112
  v_mfma_f32_32x32x16_bf16 a[144:159], a[220:223], v[184:187], a[144:159]
  ds_read_b64_tr_b16 a[216:217], v6 offset:17920
  ds_read_b64_tr_b16 a[218:219], v6 offset:18176
  s_waitcnt lgkmcnt(6)
  v_mfma_f32_32x32x16_bf16 a[160:175], a[224:227], v[184:187], a[160:175]
  ds_read_b64_tr_b16 a[220:221], v8 offset:17920
  ds_read_b64_tr_b16 a[222:223], v8 offset:18176
  s_barrier
  v_mfma_f32_32x32x16_bf16 a[176:191], a[228:231], v[184:187], a[176:191]
  v_add_u32 v6, 0xfffe8800, v6
  ds_read_b64_tr_b16 a[224:225], v6 offset:0
  ds_read_b64_tr_b16 a[226:227], v6 offset:256
  s_add_u32 m0, s47, 63744
  s_mul_i32 s45, s70, 4608
  s_add_u32 s44, s45, s83
  v_mfma_f32_32x32x16_bf16 a[192:207], a[232:235], v[184:187], a[192:207]
  buffer_load_dwordx4 v16, s[12:15], s44 offen offset:0 lds
  ds_read_b64_tr_b16 a[228:229], v6 offset:64
  ds_read_b64_tr_b16 a[230:231], v6 offset:320
  v_mfma_f32_32x32x16_bf16 a[128:143], a[236:239], v[188:191], a[128:143]
  buffer_store_dwordx4 v[48:51], v21, s[28:31], s51 offen offset:1024 sc1
  ds_read_b64_tr_b16 a[232:233], v6 offset:128
  ds_read_b64_tr_b16 a[234:235], v6 offset:384
  s_waitcnt lgkmcnt(6)
  v_mfma_f32_32x32x16_bf16 a[144:159], a[208:211], v[188:191], a[144:159]
  ds_read_b64_tr_b16 a[236:237], v6 offset:192
  ds_read_b64_tr_b16 a[238:239], v6 offset:448
  v_mfma_f32_32x32x16_bf16 a[160:175], a[212:215], v[188:191], a[160:175]
  buffer_load_dwordx4 v17, s[12:15], s44 offen offset:1088 lds
  v_add_u32 v8, 0xfffe8800, v8
  ds_read_b64_tr_b16 a[208:209], v8 offset:192
  ds_read_b64_tr_b16 a[210:211], v8 offset:448
  v_mfma_f32_32x32x16_bf16 a[176:191], a[216:219], v[188:191], a[176:191]
  ds_read_b64_tr_b16 a[212:213], v6 offset:5312
  ds_read_b64_tr_b16 a[214:215], v6 offset:5568
  v_mfma_f32_32x32x16_bf16 a[192:207], a[220:223], v[188:191], a[192:207]
  ds_read_b64_tr_b16 a[216:217], v6 offset:5376
  ds_read_b64_tr_b16 a[218:219], v6 offset:5632
  s_waitcnt lgkmcnt(6)
  v_mfma_f32_32x32x16_bf16 a[128:143], a[224:227], v[192:195], a[128:143]
  buffer_load_dwordx4 v18, s[12:15], s44 offen offset:2176 lds
  ds_read_b64_tr_b16 a[220:221], v6 offset:5440
  ds_read_b64_tr_b16 a[222:223], v6 offset:5696
  v_mfma_f32_32x32x16_bf16 a[144:159], a[228:231], v[192:195], a[144:159]
  ds_read_b64_tr_b16 a[224:225], v6 offset:5504
  ds_read_b64_tr_b16 a[226:227], v6 offset:5760
  v_mfma_f32_32x32x16_bf16 a[160:175], a[232:235], v[192:195], a[160:175]
  ds_read_b64_tr_b16 a[228:229], v8 offset:5504
  ds_read_b64_tr_b16 a[230:231], v8 offset:5760
  v_mfma_f32_32x32x16_bf16 a[176:191], a[236:239], v[192:195], a[176:191]
  buffer_load_dwordx4 v19, s[12:15], s44 offen offset:3264 lds
  ds_read_b64_tr_b16 a[232:233], v6 offset:10624
  ds_read_b64_tr_b16 a[234:235], v6 offset:10880
  buffer_store_dwordx4 v[52:55], v21, s[28:31], s51 offen offset:2048 sc1
  s_waitcnt lgkmcnt(6)
  v_mfma_f32_32x32x16_bf16 a[192:207], a[208:211], v[192:195], a[192:207]
  ds_read_b64_tr_b16 a[236:237], v6 offset:10688
  ds_read_b64_tr_b16 a[238:239], v6 offset:10944
  s_add_u32 m0, s47, 68032
  s_add_u32 s44, s45, s84
  v_mfma_f32_32x32x16_bf16 a[128:143], a[212:215], v[196:199], a[128:143]
  ds_read_b64_tr_b16 a[208:209], v6 offset:10752
  ds_read_b64_tr_b16 a[210:211], v6 offset:11008
  v_mfma_f32_32x32x16_bf16 a[144:159], a[216:219], v[196:199], a[144:159]
  buffer_load_dwordx4 v20, s[12:15], s44 offen offset:0 lds
  ds_read_b64_tr_b16 a[212:213], v6 offset:10816
  ds_read_b64_tr_b16 a[214:215], v6 offset:11072
  v_mfma_f32_32x32x16_bf16 a[160:175], a[220:223], v[196:199], a[160:175]
  ds_read_b64_tr_b16 a[216:217], v8 offset:10816
  ds_read_b64_tr_b16 a[218:219], v8 offset:11072
  s_waitcnt lgkmcnt(6)
  v_mfma_f32_32x32x16_bf16 a[176:191], a[224:227], v[196:199], a[176:191]
  ds_read_b64_tr_b16 a[220:221], v6 offset:15936
  ds_read_b64_tr_b16 a[222:223], v6 offset:16192
  v_mfma_f32_32x32x16_bf16 a[192:207], a[228:231], v[196:199], a[192:207]
  buffer_store_dwordx4 v[56:59], v21, s[28:31], s51 offen offset:3072 sc1
  ds_read_b64_tr_b16 a[224:225], v6 offset:16000
  ds_read_b64_tr_b16 a[226:227], v6 offset:16256
  v_mfma_f32_32x32x16_bf16 a[128:143], a[232:235], v[200:203], a[128:143]
  ds_read_b64_tr_b16 a[228:229], v6 offset:16064
  ds_read_b64_tr_b16 a[230:231], v6 offset:16320
  v_mfma_f32_32x32x16_bf16 a[144:159], a[236:239], v[200:203], a[144:159]
  ds_read_b64_tr_b16 a[232:233], v6 offset:16128
  ds_read_b64_tr_b16 a[234:235], v6 offset:16384
  s_waitcnt lgkmcnt(6)
  v_mfma_f32_32x32x16_bf16 a[160:175], a[208:211], v[200:203], a[160:175]
  ds_read_b64_tr_b16 a[236:237], v8 offset:16128
  ds_read_b64_tr_b16 a[238:239], v8 offset:16384
  v_mov_b32 v78, 0x3f803f80
  v_mov_b32 v79, 0
  v_mov_b32 v82, 0x3f803f80
  s_waitcnt vmcnt(17)
  s_barrier
  v_mfma_f32_32x32x16_bf16 a[176:191], a[212:215], v[200:203], a[176:191]
  ds_read_b64_tr_b16 a[208:209], v6 offset:21248
  ds_read_b64_tr_b16 a[210:211], v6 offset:21504
  v_mov_b32 v83, 0
  v_mov_b32 v86, 0x3f803f80
  v_mov_b32 v87, 0
  v_mfma_f32_32x32x16_bf16 a[192:207], a[216:219], v[200:203], a[192:207]
  ds_read_b64_tr_b16 a[212:213], v6 offset:21312
  ds_read_b64_tr_b16 a[214:215], v6 offset:21568
  v_mov_b32 v90, 0x3f803f80
  v_mov_b32 v91, 0
  v_mov_b32 v94, 0x3f803f80
  v_mfma_f32_32x32x16_bf16 a[128:143], a[220:223], v[204:207], a[128:143]
  ds_read_b64_tr_b16 a[216:217], v6 offset:21376
  ds_read_b64_tr_b16 a[218:219], v6 offset:21632
  v_mov_b32 v95, 0
  v_mov_b32 v98, 0x3f803f80
  v_mov_b32 v99, 0
  s_waitcnt lgkmcnt(6)
  v_mfma_f32_32x32x16_bf16 a[144:159], a[224:227], v[204:207], a[144:159]
  ds_read_b64_tr_b16 a[220:221], v6 offset:21440
  ds_read_b64_tr_b16 a[222:223], v6 offset:21696
  v_mov_b32 v102, 0x3f803f80
  v_mov_b32 v103, 0
  v_mov_b32 v106, 0x3f803f80
  v_mfma_f32_32x32x16_bf16 a[160:175], a[228:231], v[204:207], a[160:175]
  ds_read_b64_tr_b16 a[224:225], v8 offset:21440
  ds_read_b64_tr_b16 a[226:227], v8 offset:21696
  v_mov_b32 v107, 0
  v_mov_b32 v110, 0x3f803f80
  v_mov_b32 v111, 0
  v_mfma_f32_32x32x16_bf16 a[176:191], a[232:235], v[204:207], a[176:191]
  ds_read_b64_tr_b16 a[228:229], v6 offset:26560
  ds_read_b64_tr_b16 a[230:231], v6 offset:26816
  v_mfma_f32_32x32x16_bf16 a[192:207], a[236:239], v[204:207], a[192:207]
  ds_read_b64_tr_b16 a[232:233], v6 offset:26624
  ds_read_b64_tr_b16 a[234:235], v6 offset:26880
  s_waitcnt lgkmcnt(6)
  v_mfma_f32_32x32x16_bf16 a[128:143], a[208:211], v[208:211], a[128:143]
  ds_read_b64_tr_b16 a[236:237], v6 offset:26688
  ds_read_b64_tr_b16 a[238:239], v6 offset:26944
  v_mfma_f32_32x32x16_bf16 a[144:159], a[212:215], v[208:211], a[144:159]
  ds_read_b64_tr_b16 a[208:209], v6 offset:26752
  ds_read_b64_tr_b16 a[210:211], v6 offset:27008
  s_add_u32 s75, s92, 1
  s_waitcnt vmcnt(8)
  v_subrev_u32 v26, s75, v26
  v_cmp_eq_u32 s[52:53], s93, v27
  v_cmp_ge_u32 vcc, 14, v26
  s_nop 0
  s_and_b32 vcc_lo, vcc_lo, s52
  s_cmp_eq_u32 vcc_lo, 0xfff
  s_cbranch_scc0 L_slow_kv
L_back_kv:
  v_mfma_f32_32x32x16_bf16 a[160:175], a[216:219], v[208:211], a[160:175]
  ds_read_b64_tr_b16 a[212:213], v8 offset:26752
  ds_read_b64_tr_b16 a[214:215], v8 offset:27008
  s_add_u32 m0, s48, 143360
  s_mov_b32 s44, s73
  v_add_u32 v22, s74, v21
  v_lshrrev_b32 v23, 1, v21
  v_add_u32 v23, s74, v23
  v_mfma_f32_32x32x16_bf16 a[176:191], a[220:223], v[208:211], a[176:191]
  buffer_load_dwordx4 v21, s[28:31], s44 offen offset:0 sc1 lds
  ds_read_b64_tr_b16 a[216:217], v6 offset:31872
  ds_read_b64_tr_b16 a[218:219], v6 offset:32128
  s_waitcnt lgkmcnt(6)
  v_mfma_f32_32x32x16_bf16 a[192:207], a[224:227], v[208:211], a[192:207]
  ds_read_b64_tr_b16 a[220:221], v6 offset:31936
  ds_read_b64_tr_b16 a[222:223], v6 offset:32192
  v_mfma_f32_32x32x16_bf16 a[128:143], a[228:231], v[212:215], a[128:143]
  ds_read_b64_tr_b16 a[224:225], v6 offset:32000
  ds_read_b64_tr_b16 a[226:227], v6 offset:32256
  v_mfma_f32_32x32x16_bf16 a[144:159], a[232:235], v[212:215], a[144:159]
  buffer_load_dwordx4 v21, s[28:31], s44 offen offset:1024 sc1 lds
  ds_read_b64_tr_b16 a[228:229], v6 offset:32064
  ds_read_b64_tr_b16 a[230:231], v6 offset:32320
  v_mfma_f32_32x32x16_bf16 a[160:175], a[236:239], v[212:215], a[160:175]
  ds_read_b64_tr_b16 a[232:233], v8 offset:32064
  ds_read_b64_tr_b16 a[234:235], v8 offset:32320
  s_waitcnt lgkmcnt(6)
  v_mfma_f32_32x32x16_bf16 a[176:191], a[208:211], v[212:215], a[176:191]
  ds_read_b64_tr_b16 a[236:237], v6 offset:37184
  ds_read_b64_tr_b16 a[238:239], v6 offset:37440
  v_mfma_f32_32x32x16_bf16 a[192:207], a[212:215], v[212:215], a[192:207]
  buffer_load_dwordx4 v21, s[28:31], s44 offen offset:2048 sc1 lds
  ds_read_b64_tr_b16 a[208:209], v6 offset:37248
  ds_read_b64_tr_b16 a[210:211], v6 offset:37504
  v_mfma_f32_32x32x16_bf16 a[128:143], a[216:219], v[216:219], a[128:143]
  buffer_load_dwordx4 v21, s[28:31], s44 offen offset:3072 sc1 lds
  ds_read_b64_tr_b16 a[212:213], v6 offset:37312
  ds_read_b64_tr_b16 a[214:215], v6 offset:37568
  v_mfma_f32_32x32x16_bf16 a[144:159], a[220:223], v[216:219], a[144:159]
  ds_read_b64_tr_b16 a[216:217], v6 offset:37376
  ds_read_b64_tr_b16 a[218:219], v6 offset:37632
  s_add_u32 m0, s48, 147456
  s_add_u32 s44, s44, 4096
  s_waitcnt lgkmcnt(6)
  v_mfma_f32_32x32x16_bf16 a[160:175], a[224:227], v[216:219], a[160:175]
  buffer_load_dwordx4 v21, s[28:31], s44 offen offset:0 sc1 lds
  ds_read_b64_tr_b16 a[220:221], v8 offset:37376
  ds_read_b64_tr_b16 a[222:223], v8 offset:37632
  s_barrier
  v_mfma_f32_32x32x16_bf16 a[176:191], a[228:231], v[216:219], a[176:191]
  ds_read_b64_tr_b16 a[224:225], v6 offset:42496
  ds_read_b64_tr_b16 a[226:227], v6 offset:42752
  s_add_u32 m0, s48, 102400
  s_mov_b32 s44, s71
  v_mfma_f32_32x32x16_bf16 a[192:207], a[232:235], v[216:219], a[192:207]
  buffer_load_dwordx4 v21, s[28:31], s44 offen offset:0 sc1 lds
  ds_read_b64_tr_b16 a[228:229], v6 offset:42560
  ds_read_b64_tr_b16 a[230:231], v6 offset:42816
  v_mfma_f32_32x32x16_bf16 a[128:143], a[236:239], v[220:223], a[128:143]
  ds_read_b64_tr_b16 a[232:233], v6 offset:42624
  ds_read_b64_tr_b16 a[234:235], v6 offset:42880
  s_waitcnt lgkmcnt(6)
  v_mfma_f32_32x32x16_bf16 a[144:159], a[208:211], v[220:223], a[144:159]
  ds_read_b64_tr_b16 a[236:237], v6 offset:42688
  ds_read_b64_tr_b16 a[238:239], v6 offset:42944
  v_mfma_f32_32x32x16_bf16 a[160:175], a[212:215], v[220:223], a[160:175]
  buffer_load_dwordx4 v21, s[28:31], s44 offen offset:1024 sc1 lds
  ds_read_b64_tr_b16 a[208:209], v8 offset:42688
  ds_read_b64_tr_b16 a[210:211], v8 offset:42944
  v_mfma_f32_32x32x16_bf16 a[176:191], a[216:219], v[220:223], a[176:191]
  ds_read_b64_tr_b16 a[212:213], v6 offset:47808
  ds_read_b64_tr_b16 a[214:215], v6 offset:48064
  v_mfma_f32_32x32x16_bf16 a[192:207], a[220:223], v[220:223], a[192:207]
  ds_read_b64_tr_b16 a[216:217], v6 offset:47872
  ds_read_b64_tr_b16 a[218:219], v6 offset:48128
  s_waitcnt lgkmcnt(6)
  v_mfma_f32_32x32x16_bf16 a[128:143], a[224:227], v[224:227], a[128:143]
  buffer_load_dwordx4 v21, s[28:31], s44 offen offset:2048 sc1 lds
  ds_read_b64_tr_b16 a[220:221], v6 offset:47936
  ds_read_b64_tr_b16 a[222:223], v6 offset:48192
  s_add_u32 s75, s57, 21504
  v_add_u32 v5, s75, v4
  s_mov_b32 s42, s75
  v_mfma_f32_32x32x16_bf16 a[144:159], a[228:231], v[224:227], a[144:159]
  ds_read_b64_tr_b16 a[224:225], v6 offset:48000
  ds_read_b64_tr_b16 a[226:227], v6 offset:48256
  v_mfma_f32_32x32x16_bf16 a[160:175], a[232:235], v[224:227], a[160:175]
  ds_read_b64_tr_b16 a[228:229], v8 offset:48000
  ds_read_b64_tr_b16 a[230:231], v8 offset:48256
  v_mfma_f32_32x32x16_bf16 a[176:191], a[236:239], v[224:227], a[176:191]
  ds_read_b64_tr_b16 a[232:233], v6 offset:53120
  ds_read_b64_tr_b16 a[234:235], v6 offset:53376
  s_waitcnt lgkmcnt(6)
  v_mfma_f32_32x32x16_bf16 a[192:207], a[208:211], v[224:227], a[192:207]
  buffer_load_dwordx4 v21, s[28:31], s44 offen offset:3072 sc1 lds
  ds_read_b64_tr_b16 a[236:237], v6 offset:53184
  ds_read_b64_tr_b16 a[238:239], v6 offset:53440
  v_mfma_f32_32x32x16_bf16 a[128:143], a[212:215], v[228:231], a[128:143]
  ds_read_b64_tr_b16 a[208:209], v6 offset:53248
  ds_read_b64_tr_b16 a[210:211], v6 offset:53504
  s_add_u32 m0, s48, 106496
  s_add_u32 s44, s44, 4096
  v_mfma_f32_32x32x16_bf16 a[144:159], a[216:219], v[228:231], a[144:159]
  ds_read_b64_tr_b16 a[212:213], v6 offset:53312
  ds_read_b64_tr_b16 a[214:215], v6 offset:53568
  v_mfma_f32_32x32x16_bf16 a[160:175], a[220:223], v[228:231], a[160:175]
  buffer_load_dwordx4 v21, s[28:31], s44 offen offset:0 sc1 lds
  ds_read_b64_tr_b16 a[216:217], v8 offset:53312
  ds_read_b64_tr_b16 a[218:219], v8 offset:53568
  s_waitcnt lgkmcnt(6)
  v_mfma_f32_32x32x16_bf16 a[176:191], a[224:227], v[228:231], a[176:191]
  ds_read_b64_tr_b16 a[220:221], v6 offset:58432
  ds_read_b64_tr_b16 a[222:223], v6 offset:58688
  s_add_u32 m0, s48, 122880
  s_mov_b32 s44, s72
  v_mfma_f32_32x32x16_bf16 a[192:207], a[228:231], v[228:231], a[192:207]
  ds_read_b64_tr_b16 a[224:225], v6 offset:58496
  ds_read_b64_tr_b16 a[226:227], v6 offset:58752
  v_mfma_f32_32x32x16_bf16 a[128:143], a[232:235], v[232:235], a[128:143]
  buffer_load_dwordx4 v21, s[28:31], s44 offen offset:0 sc1 lds
  ds_read_b64_tr_b16 a[228:229], v6 offset:58560
  ds_read_b64_tr_b16 a[230:231], v6 offset:58816
  v_mfma_f32_32x32x16_bf16 a[144:159], a[236:239], v[232:235], a[144:159]
  ds_read_b64_tr_b16 a[232:233], v6 offset:58624
  ds_read_b64_tr_b16 a[234:235], v6 offset:58880
  s_waitcnt lgkmcnt(6)
  v_mfma_f32_32x32x16_bf16 a[160:175], a[208:211], v[232:235], a[160:175]
  ds_read_b64_tr_b16 a[236:237], v8 offset:58624
  ds_read_b64_tr_b16 a[238:239], v8 offset:58880
  s_waitcnt vmcnt(12)
  s_barrier
  v_mfma_f32_32x32x16_bf16 a[176:191], a[212:215], v[232:235], a[176:191]
  buffer_load_dwordx4 v21, s[28:31], s44 offen offset:1024 sc1 lds
  ds_read_b64_tr_b16 a[208:209], v6 offset:63744
  ds_read_b64_tr_b16 a[210:211], v6 offset:64000
  v_mfma_f32_32x32x16_bf16 a[192:207], a[216:219], v[232:235], a[192:207]
  ds_read_b64_tr_b16 a[212:213], v6 offset:63808
  ds_read_b64_tr_b16 a[214:215], v6 offset:64064
  v_mfma_f32_32x32x16_bf16 a[128:143], a[220:223], v[236:239], a[128:143]
  ds_read_b64_tr_b16 a[216:217], v6 offset:63872
  ds_read_b64_tr_b16 a[218:219], v6 offset:64128
  s_waitcnt lgkmcnt(6)
  v_mfma_f32_32x32x16_bf16 a[144:159], a[224:227], v[236:239], a[144:159]
  buffer_load_dwordx4 v21, s[28:31], s44 offen offset:2048 sc1 lds
  ds_read_b64_tr_b16 a[220:221], v6 offset:63936
  ds_read_b64_tr_b16 a[222:223], v6 offset:64192
  v_mfma_f32_32x32x16_bf16 a[160:175], a[228:231], v[236:239], a[160:175]
  ds_read_b64_tr_b16 a[224:225], v8 offset:63936
  ds_read_b64_tr_b16 a[226:227], v8 offset:64192
  v_mfma_f32_32x32x16_bf16 a[176:191], a[232:235], v[236:239], a[176:191]
  v_add_u32 v6, 0x10800, v6
  ds_read_b64_tr_b16 a[228:229], v6 offset:1472
  ds_read_b64_tr_b16 a[230:231], v6 offset:1728
  v_mfma_f32_32x32x16_bf16 a[192:207], a[236:239], v[236:239], a[192:207]
  ds_read_b64_tr_b16 a[232:233], v6 offset:1536
  ds_read_b64_tr_b16 a[234:235], v6 offset:1792
  s_waitcnt lgkmcnt(6)
  v_mfma_f32_32x32x16_bf16 a[128:143], a[208:211], v[240:243], a[128:143]
  buffer_load_dwordx4 v21, s[28:31], s44 offen offset:3072 sc1 lds
  ds_read_b64_tr_b16 a[236:237], v6 offset:1600
  ds_read_b64_tr_b16 a[238:239], v6 offset:1856
  v_mfma_f32_32x32x16_bf16 a[144:159], a[212:215], v[240:243], a[144:159]
  ds_read_b64_tr_b16 a[208:209], v6 offset:1664
  ds_read_b64_tr_b16 a[210:211], v6 offset:1920
  s_add_u32 m0, s48, 126976
  s_add_u32 s44, s44, 4096
  v_mfma_f32_32x32x16_bf16 a[160:175], a[216:219], v[240:243], a[160:175]
  v_add_u32 v8, 0x10800, v8
  ds_read_b64_tr_b16 a[212:213], v8 offset:1664
  ds_read_b64_tr_b16 a[214:215], v8 offset:1920
  v_mfma_f32_32x32x16_bf16 a[176:191], a[220:223], v[240:243], a[176:191]
  buffer_load_dwordx4 v21, s[28:31], s44 offen offset:0 sc1 lds
  ds_read_b64_tr_b16 a[216:217], v6 offset:6784
  ds_read_b64_tr_b16 a[218:219], v6 offset:7040
  s_waitcnt lgkmcnt(6)
  v_mfma_f32_32x32x16_bf16 a[192:207], a[224:227], v[240:243], a[192:207]
  ds_read_b64_tr_b16 a[220:221], v6 offset:6848
  ds_read_b64_tr_b16 a[222:223], v6 offset:7104
  s_and_b32 s44, s59, 1
  s_mul_i32 s79, s44, 640
  s_lshl_b32 s45, s44, 6
  s_add_u32 s66, s45, 512
  v_mfma_f32_32x32x16_bf16 a[128:143], a[228:231], v[244:247], a[128:143]
  ds_read_b64_tr_b16 a[224:225], v6 offset:6912
  ds_read_b64_tr_b16 a[226:227], v6 offset:7168
  s_add_u32 s45, s58, 0
  s_and_b32 s45, s45, 3
  s_lshl_b32 s45, s45, 7
  s_add_u32 s62, s45, s79
  v_mfma_f32_32x32x16_bf16 a[144:159], a[232:235], v[244:247], a[144:159]
  ds_read_b64_tr_b16 a[228:229], v6 offset:6976
  ds_read_b64_tr_b16 a[230:231], v6 offset:7232
  s_add_u32 s45, s58, 1
  s_and_b32 s45, s45, 3
  s_lshl_b32 s45, s45, 7
  s_add_u32 s63, s45, s79
  v_mfma_f32_32x32x16_bf16 a[160:175], a[236:239], v[244:247], a[160:175]
  ds_read_b64_tr_b16 a[232:233], v8 offset:6976
  ds_read_b64_tr_b16 a[234:235], v8 offset:7232
  s_add_u32 s45, s58, 2
  s_and_b32 s45, s45, 3
  s_lshl_b32 s45, s45, 7
  s_add_u32 s64, s45, s79
  s_waitcnt lgkmcnt(6)
  v_mfma_f32_32x32x16_bf16 a[176:191], a[208:211], v[244:247], a[176:191]
  ds_read_b64_tr_b16 a[236:237], v6 offset:12096
  ds_read_b64_tr_b16 a[238:239], v6 offset:12352
  s_add_u32 s45, s58, 3
  s_and_b32 s45, s45, 3
  s_lshl_b32 s45, s45, 7
  s_add_u32 s65, s45, s79
  v_mfma_f32_32x32x16_bf16 a[192:207], a[212:215], v[244:247], a[192:207]
  ds_read_b64_tr_b16 a[208:209], v6 offset:12160
  ds_read_b64_tr_b16 a[210:211], v6 offset:12416
  s_xor_b32 s44, s59, 0
  s_and_b32 s45, s44, 1
  s_mul_i32 s100, s44, 288
  s_lshl_b32 s101, s45, 5
  v_mfma_f32_32x32x16_bf16 a[128:143], a[216:219], v[248:251], a[128:143]
  ds_read_b64_tr_b16 a[212:213], v6 offset:12224
  ds_read_b64_tr_b16 a[214:215], v6 offset:12480
  s_add_u32 s101, s101, s100
  s_xor_b32 s45, s45, 1
  s_lshl_b32 s45, s45, 8
  s_add_u32 s100, s100, s45
  v_mfma_f32_32x32x16_bf16 a[144:159], a[220:223], v[248:251], a[144:159]
  ds_read_b64_tr_b16 a[216:217], v6 offset:12288
  ds_read_b64_tr_b16 a[218:219], v6 offset:12544
  s_mul_i32 s45, s60, 40
  s_add_u32 s45, s45, s101
  s_mul_i32 s67, s45, 1152
  s_lshl_b32 s45, s60, 6
  s_waitcnt lgkmcnt(6)
  v_mfma_f32_32x32x16_bf16 a[160:175], a[224:227], v[248:251], a[160:175]
  ds_read_b64_tr_b16 a[220:221], v8 offset:12288
  ds_read_b64_tr_b16 a[222:223], v8 offset:12544
  s_add_u32 s45, s45, s101
  s_mul_i32 s84, s45, 1152
  s_lshl_b32 s45, s60, 5
  s_add_u32 s45, s45, s101
  v_mfma_f32_32x32x16_bf16 a[176:191], a[228:231], v[248:251], a[176:191]
  s_add_u32 s45, s45, 160
  s_cmp_eq_u32 s60, 3
  s_cselect_b32 s45, s100, s45
  s_mul_i32 s69, s45, 1152
  s_waitcnt vmcnt(15)
  s_add_u32 s76, s92, 2
  v_mov_b32 v24, s76
  buffer_store_dwordx2 v[24:25], v4, s[28:31], s90 offen sc1
  s_waitcnt vmcnt(1)
  s_barrier
  v_mfma_f32_32x32x16_bf16 a[192:207], a[232:235], v[248:251], a[192:207]
  ds_read_b64 v[80:81], v23 offset:7168
  ds_read_b64 v[84:85], v23 offset:12288
  ds_read_b128 a[4:7], v22 offset:5120
  s_and_b32 s45, s60, 1
  s_lshl_b32 s45, s45, 4
  s_add_u32 s45, s45, s100
  s_mul_i32 s86, s45, 1152
  v_mfma_f32_32x32x16_bf16 a[128:143], a[236:239], v[252:255], a[128:143]
  ds_read_b64 v[88:89], v23 offset:17408
  ds_read_b64 v[92:93], v23 offset:22528
  ds_read_b128 a[8:11], v22 offset:10240
  s_mul_i32 s44, s44, 36
  s_lshl_b32 s45, s60, 3
  s_lshr_b32 s100, s60, 1
  s_lshl_b32 s100, s100, 2
  s_waitcnt lgkmcnt(6)
  v_mfma_f32_32x32x16_bf16 a[144:159], a[208:211], v[252:255], a[144:159]
  ds_read_b64 v[96:97], v23 offset:27648
  ds_read_b64 v[100:101], v23 offset:32768
  ds_read_b128 a[12:15], v22 offset:15360
  s_add_u32 s45, s45, s100
  s_add_u32 s45, s45, s44
  s_mul_i32 s80, s45, 1152
  s_add_u32 s45, s44, 16
  v_mfma_f32_32x32x16_bf16 a[160:175], a[212:215], v[252:255], a[160:175]
  ds_read_b64 v[104:105], v23 offset:37888
  ds_read_b64 v[76:77], v23 offset:2048
  ds_read_b128 a[16:19], v22 offset:20480
  s_mul_i32 s82, s45, 1152
  s_bitcmp1_b32 s60, 0
  s_cselect_b32 s45, 20, 0
  s_add_u32 s45, s45, s44
  v_mfma_f32_32x32x16_bf16 a[176:191], a[216:219], v[252:255], a[176:191]
  ds_read_b64 v[108:109], v23 offset:43008
  s_mul_i32 s88, s45, 1152
  v_mfma_f32_32x32x16_bf16 a[192:207], a[220:223], v[252:255], a[192:207]
  s_xor_b32 s44, s59, 1
  s_and_b32 s45, s44, 1
  s_mul_i32 s100, s44, 288
  s_lshl_b32 s101, s45, 5
  s_waitcnt lgkmcnt(10)
  v_mfma_f32_32x32x16_bf16 v[152:167], a[4:7], v[60:63], 0
  ds_read_b128 a[20:23], v22 offset:25600
  v_and_b32 v248, 31, v1
  v_lshrrev_b32 v249, 5, v1
  v_lshlrev_b32 v249, 2, v249
  v_sub_u32 v248, v248, v249
  v_cvt_f32_i32 v248, v248
  v_add_f32 v248, 0.5, v248
  v_mul_f32 v249, 0x7149f2ca, v248
  v_sub_f32 v232, 0x00000000, v249
  s_waitcnt lgkmcnt(1)
  s_cmp_ge_u32 s58, 2
  s_cbranch_scc1 L_nobias
  s_lshl_b32 s75, s58, 2
  s_add_u32 s75, s75, s60
  s_mov_b32 exec_lo, 0
  s_cmp_ge_u32 s75, 8
  s_cbranch_scc1 L_bias_done
  v_mov_b32 v76, 0xf149
  v_mov_b32 v77, 0xf149
  s_cmp_ge_u32 s75, 7
  s_cbranch_scc1 L_bias_done
  v_mov_b32 v80, 0xf149
  v_mov_b32 v81, 0xf149
  s_cmp_ge_u32 s75, 6
  s_cbranch_scc1 L_bias_done
  v_mov_b32 v84, 0xf149
  v_mov_b32 v85, 0xf149
  s_cmp_ge_u32 s75, 5
  s_cbranch_scc1 L_bias_done
  v_mov_b32 v88, 0xf149
  v_mov_b32 v89, 0xf149
  s_cmp_ge_u32 s75, 4
  s_cbranch_scc1 L_bias_done
  v_mov_b32 v92, 0xf149
  v_mov_b32 v93, 0xf149
  s_cmp_ge_u32 s75, 3
  s_cbranch_scc1 L_bias_done
  v_mov_b32 v96, 0xf149
  v_mov_b32 v97, 0xf149
  s_cmp_ge_u32 s75, 2
  s_cbranch_scc1 L_bias_done
  v_mov_b32 v100, 0xf149
  v_mov_b32 v101, 0xf149
  s_cmp_ge_u32 s75, 1
  s_cbranch_scc1 L_bias_done
  v_mov_b32 v104, 0xf149
  v_mov_b32 v105, 0xf149
L_bias_done:
  s_mov_b32 exec_lo, -1
  s_nop 1
L_nobias:
  v_mfma_f32_32x32x16_bf16 v[152:167], v[80:83], v[68:71], v[152:167]
L_pg5:
  s_cbranch_execz L_pg9
  ds_read_b128 a[24:27], v22 offset:30720
  v_min_f32 v216, 0, v232
  v_min_f32_e64 v232, 0, -v232
  v_sub_f32 v233, 0x7149f2ca, v249
  v_min_f32 v217, 0, v233
  v_min_f32_e64 v233, 0, -v233
  v_sub_f32 v234, 0x71c9f2ca, v249
  v_min_f32 v218, 0, v234
  v_min_f32_e64 v234, 0, -v234
  s_barrier
  v_mfma_f32_32x32x16_bf16 v[168:183], a[8:11], v[60:63], 0
  ds_read_b128 a[28:31], v22 offset:35840
  v_sub_f32 v235, 0x72177617, v249
  v_min_f32 v219, 0, v235
  v_min_f32_e64 v235, 0, -v235
  v_sub_f32 v236, 0x72c9f2ca, v249
  v_min_f32 v220, 0, v236
  v_min_f32_e64 v236, 0, -v236
  v_sub_f32 v237, 0x72e33123, v249
  v_min_f32 v221, 0, v237
  v_mfma_f32_32x32x16_bf16 v[168:183], v[84:87], v[68:71], v[168:183]
  ds_read_b128 a[0:3], v22 offset:0
  v_min_f32_e64 v237, 0, -v237
  v_sub_f32 v238, 0x72fc6f7c, v249
  v_min_f32 v222, 0, v238
  v_min_f32_e64 v238, 0, -v238
  v_sub_f32 v239, 0x730ad6eb, v249
  v_min_f32 v223, 0, v239
  v_min_f32_e64 v239, 0, -v239
  v_sub_f32 v240, 0x7349f2ca, v249
  v_mfma_f32_32x32x16_bf16 v[184:199], a[12:15], v[60:63], 0
  buffer_load_dwordx2 v[26:27], v5, s[28:31], 0 offen sc1
  ds_read_b128 a[32:35], v22 offset:40960
  v_max_f32 v16, v152, v153
  v_max_f32 v17, v154, v155
  v_max3_f32 v16, v16, v156, v157
  v_max3_f32 v17, v17, v158, v159
  v_min_f32 v224, 0, v240
  v_min_f32_e64 v240, 0, -v240
  v_sub_f32 v241, 0x735691f6, v249
  v_mfma_f32_32x32x16_bf16 v[184:199], v[88:91], v[68:71], v[184:199]
  ds_read_b128 a[40:43], v22 offset:6144
  v_max3_f32 v16, v16, v160, v161
  v_max3_f32 v17, v17, v162, v163
  v_max3_f32 v16, v16, v164, v165
  v_max3_f32 v17, v17, v166, v167
  v_min_f32 v225, 0, v241
  v_min_f32_e64 v241, 0, -v241
  v_sub_f32 v242, 0x73633123, v249
  v_min_f32 v226, 0, v242
  v_mfma_f32_32x32x16_bf16 v[152:167], a[16:19], v[60:63], 0
  ds_read_b128 a[44:47], v22 offset:11264
  v_max3_f32 v16, v16, v168, v169
  v_max3_f32 v17, v17, v170, v171
  v_max3_f32 v16, v16, v172, v173
  v_max3_f32 v17, v17, v174, v175
  v_min_f32_e64 v242, 0, -v242
  v_sub_f32 v243, 0x736fd050, v249
  v_min_f32 v227, 0, v243
  v_min_f32_e64 v243, 0, -v243
  v_mfma_f32_32x32x16_bf16 v[152:167], v[92:95], v[68:71], v[152:167]
  ds_read_b128 a[48:51], v22 offset:16384
  v_max3_f32 v16, v16, v176, v177
  v_max3_f32 v17, v17, v178, v179
  v_max3_f32 v16, v16, v180, v181
  v_max3_f32 v17, v17, v182, v183
  v_sub_f32 v244, 0x73977617, v249
  v_min_f32 v228, 0, v244
  v_min_f32_e64 v244, 0, -v244
  v_sub_f32 v245, 0x739dc5ae, v249
  s_waitcnt lgkmcnt(7)
  v_mfma_f32_32x32x16_bf16 v[168:183], a[20:23], v[60:63], 0
  ds_read_b128 a[52:55], v22 offset:21504
  v_max3_f32 v16, v16, v184, v185
  v_max3_f32 v17, v17, v186, v187
  v_max3_f32 v16, v16, v188, v189
  v_max3_f32 v17, v17, v190, v191
  v_min_f32 v229, 0, v245
  v_min_f32_e64 v245, 0, -v245
  v_sub_f32 v246, 0x73a41544, v249
  v_min_f32 v230, 0, v246
  v_mfma_f32_32x32x16_bf16 v[168:183], v[96:99], v[68:71], v[168:183]
  ds_read_b128 a[56:59], v22 offset:26624
  v_max3_f32 v16, v16, v192, v193
  v_max3_f32 v17, v17, v194, v195
  v_max3_f32 v16, v16, v196, v197
  v_max3_f32 v17, v17, v198, v199
  v_min_f32_e64 v246, 0, -v246
  v_sub_f32 v247, 0x73aa64da, v249
  v_min_f32 v231, 0, v247
  v_min_f32_e64 v247, 0, -v247
  s_waitcnt lgkmcnt(8)
  v_mfma_f32_32x32x16_bf16 v[184:199], a[24:27], v[60:63], 0
  ds_read_b128 a[60:63], v22 offset:31744
  v_max3_f32 v16, v16, v152, v153
  v_max3_f32 v17, v17, v154, v155
  v_max3_f32 v16, v16, v156, v157
  v_max3_f32 v17, v17, v158, v159
  v_accvgpr_read_b32 v248, a128
  v_accvgpr_read_b32 v249, a129
  v_accvgpr_read_b32 v250, a130
  v_accvgpr_read_b32 v251, a131
  v_mfma_f32_32x32x16_bf16 v[184:199], v[100:103], v[68:71], v[184:199]
  ds_read_b128 a[64:67], v22 offset:36864
  v_max3_f32 v16, v16, v160, v161
  v_max3_f32 v17, v17, v162, v163
  v_max3_f32 v16, v16, v164, v165
  v_max3_f32 v17, v17, v166, v167
  v_accvgpr_read_b32 v252, a132
  v_accvgpr_read_b32 v253, a133
  v_accvgpr_read_b32 v254, a134
  v_accvgpr_read_b32 v255, a135
  s_waitcnt lgkmcnt(9)
  v_mfma_f32_32x32x16_bf16 v[152:167], a[28:31], v[60:63], 0
  ds_read_b128 a[36:39], v22 offset:1024
  v_max3_f32 v16, v16, v168, v169
  v_max3_f32 v17, v17, v170, v171
  v_max3_f32 v16, v16, v172, v173
  v_max3_f32 v17, v17, v174, v175
  v_cvt_pk_bf16_f32 v112, v248, v249
  v_cvt_pk_bf16_f32 v113, v250, v251
  v_cvt_pk_bf16_f32 v114, v252, v253
  v_cvt_pk_bf16_f32 v115, v254, v255
  v_mfma_f32_32x32x16_bf16 v[152:167], v[104:107], v[68:71], v[152:167]
  ds_read_b128 a[68:71], v22 offset:41984
  v_max3_f32 v16, v16, v176, v177
  v_max3_f32 v17, v17, v178, v179
  v_max3_f32 v16, v16, v180, v181
  v_max3_f32 v17, v17, v182, v183
  v_pk_max_i16 v112, v112, 0
  v_pk_max_i16 v113, v113, 0
  v_pk_max_i16 v114, v114, 0
  v_pk_max_i16 v115, v115, 0
  s_waitcnt lgkmcnt(10)
  v_mfma_f32_32x32x16_bf16 v[168:183], a[0:3], v[60:63], v[216:231]
  v_max3_f32 v16, v16, v184, v185
  v_max3_f32 v17, v17, v186, v187
  v_max3_f32 v16, v16, v188, v189
  v_max3_f32 v17, v17, v190, v191
  v_accvgpr_read_b32 v248, a136
  v_accvgpr_read_b32 v249, a137
  v_accvgpr_read_b32 v250, a138
  v_accvgpr_read_b32 v251, a139
  v_accvgpr_read_b32 v252, a140
  v_mfma_f32_32x32x16_bf16 v[168:183], v[76:79], v[68:71], v[168:183]
  v_max3_f32 v16, v16, v192, v193
  v_max3_f32 v17, v17, v194, v195
  v_max3_f32 v16, v16, v196, v197
  v_max3_f32 v17, v17, v198, v199
  v_accvgpr_read_b32 v253, a141
  v_accvgpr_read_b32 v254, a142
  v_accvgpr_read_b32 v255, a143
  v_cvt_pk_bf16_f32 v116, v248, v249
  v_cvt_pk_bf16_f32 v117, v250, v251
  v_cvt_pk_bf16_f32 v118, v252, v253
  v_cvt_pk_bf16_f32 v119, v254, v255
  v_pk_max_i16 v116, v116, 0
  v_pk_max_i16 v117, v117, 0
  v_pk_max_i16 v118, v118, 0
  v_pk_max_i16 v119, v119, 0
  s_waitcnt lgkmcnt(9)
  v_mfma_f32_32x32x16_bf16 v[184:199], a[32:35], v[60:63], v[232:247]
  v_max3_f32 v16, v16, v152, v153
  v_max3_f32 v17, v17, v154, v155
  v_max3_f32 v16, v16, v156, v157
  v_max3_f32 v17, v17, v158, v159
  s_add_u32 s51, s56, 8192
  buffer_store_dwordx4 v[112:115], v21, s[28:31], s51 offen offset:0 sc1
  v_accvgpr_read_b32 v248, a144
  v_accvgpr_read_b32 v249, a145
  v_accvgpr_read_b32 v250, a146
  v_mfma_f32_32x32x16_bf16 v[184:199], v[108:111], v[68:71], v[184:199]
  v_max3_f32 v16, v16, v160, v161
  v_max3_f32 v17, v17, v162, v163
  v_max3_f32 v16, v16, v164, v165
  v_max3_f32 v17, v17, v166, v167
  v_accvgpr_read_b32 v251, a147
  v_accvgpr_read_b32 v252, a148
  v_accvgpr_read_b32 v253, a149
  v_accvgpr_read_b32 v254, a150
  v_accvgpr_read_b32 v255, a151
  s_waitcnt lgkmcnt(8)
  v_mfma_f32_32x32x16_bf16 v[152:167], a[40:43], v[64:67], 0
  v_max3_f32 v16, v16, v168, v169
  v_max3_f32 v17, v17, v170, v171
  v_max3_f32 v16, v16, v172, v173
  v_max3_f32 v17, v17, v174, v175
  v_cvt_pk_bf16_f32 v120, v248, v249
  v_cvt_pk_bf16_f32 v121, v250, v251
  v_cvt_pk_bf16_f32 v122, v252, v253
  v_cvt_pk_bf16_f32 v123, v254, v255
  v_pk_max_i16 v120, v120, 0
  v_mfma_f32_32x32x16_bf16 v[152:167], v[80:83], v[72:75], v[152:167]
  v_max3_f32 v16, v16, v176, v177
  v_max3_f32 v17, v17, v178, v179
  v_max3_f32 v16, v16, v180, v181
  v_max3_f32 v17, v17, v182, v183
  v_pk_max_i16 v121, v121, 0
  v_pk_max_i16 v122, v122, 0
  v_pk_max_i16 v123, v123, 0
  v_accvgpr_read_b32 v248, a152
  v_accvgpr_read_b32 v249, a153
  s_waitcnt lgkmcnt(7)
  v_mfma_f32_32x32x16_bf16 v[168:183], a[44:47], v[64:67], 0
  v_max3_f32 v16, v16, v184, v185
  v_max3_f32 v17, v17, v186, v187
  v_max3_f32 v16, v16, v188, v189
  v_max3_f32 v17, v17, v190, v191
  s_add_u32 s75, s92, 2
  s_waitcnt vmcnt(1)
  v_subrev_u32 v26, s75, v26
  v_cmp_eq_u32 s[52:53], s93, v27
  v_cmp_ge_u32 vcc, 13, v26
  s_nop 0
  s_and_b32 vcc_lo, vcc_lo, s52
  s_cmp_eq_u32 vcc_lo, 0x1
  s_cbranch_scc0 L_slow_h1
L_back_h1:
  v_mfma_f32_32x32x16_bf16 v[168:183], v[84:87], v[72:75], v[168:183]
  v_max3_f32 v16, v16, v192, v193
  v_max3_f32 v17, v17, v194, v195
  v_max3_f32 v16, v16, v196, v197
  v_max3_f32 v17, v17, v198, v199
  s_add_u32 s55, s57, 0
  buffer_load_dwordx4 a[104:107], v21, s[28:31], s55 offen offset:0 sc1
  v_accvgpr_read_b32 v250, a154
  v_accvgpr_read_b32 v251, a155
  v_accvgpr_read_b32 v252, a156
  buffer_store_dwordx4 v[116:119], v21, s[28:31], s51 offen offset:1024 sc1
  s_waitcnt lgkmcnt(6)
  v_mfma_f32_32x32x16_bf16 v[184:199], a[48:51], v[64:67], 0
  v_max_f32 v18, v152, v153
  v_max_f32 v19, v154, v155
  v_max3_f32 v18, v18, v156, v157
  v_max3_f32 v19, v19, v158, v159
  v_max_f32 v16, v16, v17
  v_mov_b32 v17, v16
  s_nop 1
  v_permlane32_swap_b32 v16, v17
  v_max_f32 v16, v16, v17
  v_sub_f32 v16, 0, v16
  v_cvt_pk_bf16_f32 v17, v16, v16
  v_lshlrev_b32 v17, 16, v17
  v_sub_f32 v16, v16, v17
  v_cvt_pk_bf16_f32 v16, v17, v16
  v_cndmask_b32_e64 v70, 0, v16, s[96:97]
  s_add_u32 s101, s101, s100
  s_xor_b32 s45, s45, 1
  s_lshl_b32 s45, s45, 8
  s_add_u32 s100, s100, s45
  v_mfma_f32_32x32x16_bf16 v[184:199], v[88:91], v[72:75], v[184:199]
  v_max3_f32 v18, v18, v160, v161
  v_max3_f32 v19, v19, v162, v163
  v_max3_f32 v18, v18, v164, v165
  v_max3_f32 v19, v19, v166, v167
  v_accvgpr_read_b32 v253, a157
  v_accvgpr_read_b32 v254, a158
  v_accvgpr_read_b32 v255, a159
  v_cvt_pk_bf16_f32 v124, v248, v249
  v_cvt_pk_bf16_f32 v125, v250, v251
  v_cvt_pk_bf16_f32 v126, v252, v253
  v_cvt_pk_bf16_f32 v127, v254, v255
  v_pk_max_i16 v124, v124, 0
  v_pk_max_i16 v125, v125, 0
  v_pk_max_i16 v126, v126, 0
  v_pk_max_i16 v127, v127, 0
  s_waitcnt lgkmcnt(5)
  v_mfma_f32_32x32x16_bf16 v[152:167], a[52:55], v[64:67], 0
  buffer_store_dwordx4 v[120:123], v21, s[28:31], s51 offen offset:2048 sc1
  v_max3_f32 v18, v18, v168, v169
  v_max3_f32 v19, v19, v170, v171
  v_max3_f32 v18, v18, v172, v173
  v_max3_f32 v19, v19, v174, v175
  v_accvgpr_read_b32 v248, a160
  v_accvgpr_read_b32 v249, a161
  v_accvgpr_read_b32 v250, a162
  v_accvgpr_read_b32 v251, a163
  v_mfma_f32_32x32x16_bf16 v[152:167], v[92:95], v[72:75], v[152:167]
  buffer_load_dwordx4 a[108:111], v21, s[28:31], s55 offen offset:1024 sc1
  v_max3_f32 v18, v18, v176, v177
  v_max3_f32 v19, v19, v178, v179
  v_max3_f32 v18, v18, v180, v181
  v_max3_f32 v19, v19, v182, v183
  v_accvgpr_read_b32 v252, a164
  v_accvgpr_read_b32 v253, a165
  v_accvgpr_read_b32 v254, a166
  v_accvgpr_read_b32 v255, a167
  s_waitcnt lgkmcnt(4)
  v_mfma_f32_32x32x16_bf16 v[168:183], a[56:59], v[64:67], 0
  v_max3_f32 v18, v18, v184, v185
  v_max3_f32 v19, v19, v186, v187
  v_max3_f32 v18, v18, v188, v189
  v_max3_f32 v19, v19, v190, v191
  v_cvt_pk_bf16_f32 v128, v248, v249
  v_cvt_pk_bf16_f32 v129, v250, v251
  v_cvt_pk_bf16_f32 v130, v252, v253
  v_cvt_pk_bf16_f32 v131, v254, v255
  v_pk_max_i16 v128, v128, 0
  v_mfma_f32_32x32x16_bf16 v[168:183], v[96:99], v[72:75], v[168:183]
  v_max3_f32 v18, v18, v192, v193
  v_max3_f32 v19, v19, v194, v195
  v_max3_f32 v18, v18, v196, v197
  v_max3_f32 v19, v19, v198, v199
  v_pk_max_i16 v129, v129, 0
  v_pk_max_i16 v130, v130, 0
  v_pk_max_i16 v131, v131, 0
  v_accvgpr_read_b32 v248, a168
  v_accvgpr_read_b32 v249, a169
  s_waitcnt lgkmcnt(3)
  v_mfma_f32_32x32x16_bf16 v[184:199], a[60:63], v[64:67], 0
  buffer_store_dwordx4 v[124:127], v21, s[28:31], s51 offen offset:3072 sc1
  v_max3_f32 v18, v18, v152, v153
  v_max3_f32 v19, v19, v154, v155
  v_max3_f32 v18, v18, v156, v157
  v_max3_f32 v19, v19, v158, v159
  v_accvgpr_read_b32 v250, a170
  v_accvgpr_read_b32 v251, a171
  v_accvgpr_read_b32 v252, a172
  v_accvgpr_read_b32 v253, a173
  v_mfma_f32_32x32x16_bf16 v[184:199], v[100:103], v[72:75], v[184:199]
  buffer_load_dwordx4 a[112:115], v21, s[28:31], s55 offen offset:2048 sc1
  v_max3_f32 v18, v18, v160, v161
  v_max3_f32 v19, v19, v162, v163
  v_max3_f32 v18, v18, v164, v165
  v_max3_f32 v19, v19, v166, v167
  v_accvgpr_read_b32 v254, a174
  v_accvgpr_read_b32 v255, a175
  v_cvt_pk_bf16_f32 v132, v248, v249
  v_cvt_pk_bf16_f32 v133, v250, v251
  s_waitcnt lgkmcnt(2)
  v_mfma_f32_32x32x16_bf16 v[152:167], a[64:67], v[64:67], 0
  v_max3_f32 v18, v18, v168, v169
  v_max3_f32 v19, v19, v170, v171
  v_max3_f32 v18, v18, v172, v173
  v_max3_f32 v19, v19, v174, v175
  v_cvt_pk_bf16_f32 v134, v252, v253
  v_cvt_pk_bf16_f32 v135, v254, v255
  v_pk_max_i16 v132, v132, 0
  v_pk_max_i16 v133, v133, 0
  v_pk_max_i16 v134, v134, 0
  v_mfma_f32_32x32x16_bf16 v[152:167], v[104:107], v[72:75], v[152:167]
  v_max3_f32 v18, v18, v176, v177
  v_max3_f32 v19, v19, v178, v179
  v_max3_f32 v18, v18, v180, v181
  v_max3_f32 v19, v19, v182, v183
  v_pk_max_i16 v135, v135, 0
  v_accvgpr_read_b32 v248, a176
  v_accvgpr_read_b32 v249, a177
  v_accvgpr_read_b32 v250, a178
  v_accvgpr_read_b32 v251, a179
  s_waitcnt lgkmcnt(1)
  v_mfma_f32_32x32x16_bf16 v[168:183], a[36:39], v[64:67], v[216:231]
  v_max3_f32 v18, v18, v184, v185
  v_max3_f32 v19, v19, v186, v187
  v_max3_f32 v18, v18, v188, v189
  v_max3_f32 v19, v19, v190, v191
  s_add_u32 s51, s56, 12288
  buffer_store_dwordx4 v[128:131], v21, s[28:31], s51 offen offset:0 sc1
  v_accvgpr_read_b32 v252, a180
  v_accvgpr_read_b32 v253, a181
  v_accvgpr_read_b32 v254, a182
  v_mfma_f32_32x32x16_bf16 v[168:183], v[76:79], v[72:75], v[168:183]
  buffer_load_dwordx4 a[116:119], v21, s[28:31], s55 offen offset:3072 sc1
  v_max3_f32 v18, v18, v192, v193
  v_max3_f32 v19, v19, v194, v195
  v_max3_f32 v18, v18, v196, v197
  v_max3_f32 v19, v19, v198, v199
  v_accvgpr_read_b32 v255, a183
  v_cvt_pk_bf16_f32 v136, v248, v249
  v_cvt_pk_bf16_f32 v137, v250, v251
  v_cvt_pk_bf16_f32 v138, v252, v253
  s_waitcnt lgkmcnt(0)
  v_mfma_f32_32x32x16_bf16 v[184:199], a[68:71], v[64:67], v[232:247]
  v_max3_f32 v18, v18, v152, v153
  v_max3_f32 v19, v19, v154, v155
  v_max3_f32 v18, v18, v156, v157
  v_max3_f32 v19, v19, v158, v159
  v_cvt_pk_bf16_f32 v139, v254, v255
  v_pk_max_i16 v136, v136, 0
  v_pk_max_i16 v137, v137, 0
  v_pk_max_i16 v138, v138, 0
  v_pk_max_i16 v139, v139, 0
  v_mfma_f32_32x32x16_bf16 v[184:199], v[108:111], v[72:75], v[184:199]
  ds_read_b64_tr_b16 a[224:225], v2 offset:5120
  ds_read_b64_tr_b16 a[226:227], v2 offset:5248
  v_max3_f32 v18, v18, v160, v161
  v_max3_f32 v19, v19, v162, v163
  v_max3_f32 v18, v18, v164, v165
  v_max3_f32 v19, v19, v166, v167
  v_accvgpr_read_b32 v248, a184
  v_accvgpr_read_b32 v249, a185
  v_accvgpr_read_b32 v250, a186
  v_mfma_f32_32x32x16_bf16 v[152:167], a[4:7], v[60:63], 0
  buffer_store_dwordx4 v[132:135], v21, s[28:31], s51 offen offset:1024 sc1
  ds_read_b64_tr_b16 a[228:229], v2 offset:5376
  ds_read_b64_tr_b16 a[230:231], v2 offset:5504
  v_max3_f32 v18, v18, v168, v169
  v_max3_f32 v19, v19, v170, v171
  v_max3_f32 v18, v18, v172, v173
  v_max3_f32 v19, v19, v174, v175
  v_mfma_f32_32x32x16_bf16 v[152:167], v[80:83], v[68:71], v[152:167]
  v_max3_f32 v18, v18, v176, v177
  v_max3_f32 v19, v19, v178, v179
  v_max3_f32 v18, v18, v180, v181
  v_max3_f32 v19, v19, v182, v183
  s_add_u32 s55, s57, 4096
  buffer_load_dwordx4 a[120:123], v21, s[28:31], s55 offen offset:0 sc1
  v_mfma_f32_32x32x16_bf16 v[168:183], a[8:11], v[60:63], 0
  v_max3_f32 v18, v18, v184, v185
  v_max3_f32 v19, v19, v186, v187
  v_max3_f32 v18, v18, v188, v189
  v_max3_f32 v19, v19, v190, v191
  s_nop 0
  v_exp_f32 v152, v152
  v_exp_f32 v153, v153
  v_exp_f32 v154, v154
  v_exp_f32 v155, v155
  v_exp_f32 v156, v156
  v_exp_f32 v157, v157
  v_exp_f32 v158, v158
  v_exp_f32 v159, v159
  s_mul_i32 s45, s60, 40
  s_add_u32 s45, s45, s101
  s_mul_i32 s68, s45, 1152
  s_lshl_b32 s45, s60, 6
  v_accvgpr_read_b32 v251, a187
  v_accvgpr_read_b32 v252, a188
  v_accvgpr_read_b32 v253, a189
  v_accvgpr_read_b32 v254, a190
  v_accvgpr_read_b32 v255, a191
  v_cvt_pk_bf16_f32 v140, v248, v249
  v_cvt_pk_bf16_f32 v141, v250, v251
  v_cvt_pk_bf16_f32 v142, v252, v253
  v_cvt_pk_bf16_f32 v143, v254, v255
  v_pk_max_i16 v140, v140, 0
  v_pk_max_i16 v141, v141, 0
  v_pk_max_i16 v142, v142, 0
  v_pk_max_i16 v143, v143, 0
  v_mfma_f32_32x32x16_bf16 v[168:183], v[84:87], v[68:71], v[168:183]
  buffer_store_dwordx4 v[136:139], v21, s[28:31], s51 offen offset:2048 sc1
  ds_read_b64_tr_b16 a[232:233], v2 offset:10240
  ds_read_b64_tr_b16 a[234:235], v2 offset:10368
  v_max3_f32 v18, v18, v192, v193
  v_max3_f32 v19, v19, v194, v195
  v_max3_f32 v18, v18, v196, v197
  v_max3_f32 v19, v19, v198, v199
  v_exp_f32 v160, v160
  v_exp_f32 v161, v161
  v_exp_f32 v162, v162
  v_exp_f32 v163, v163
  v_exp_f32 v164, v164
  v_exp_f32 v165, v165
  v_exp_f32 v166, v166
  v_exp_f32 v167, v167
  v_cvt_pk_bf16_f32 v152, v152, v153
  v_cvt_pk_bf16_f32 v153, v154, v155
  v_cvt_pk_bf16_f32 v154, v156, v157
  v_cvt_pk_bf16_f32 v155, v158, v159
  v_cvt_pk_bf16_f32 v156, v160, v161
  v_cvt_pk_bf16_f32 v157, v162, v163
  v_cvt_pk_bf16_f32 v158, v164, v165
  v_cvt_pk_bf16_f32 v159, v166, v167
  v_mfma_f32_32x32x16_bf16 v[184:199], a[12:15], v[60:63], 0
  ds_read_b64_tr_b16 a[236:237], v2 offset:10496
  ds_read_b64_tr_b16 a[238:239], v2 offset:10624
  v_exp_f32 v168, v168
  v_exp_f32 v169, v169
  v_exp_f32 v170, v170
  v_exp_f32 v171, v171
  v_exp_f32 v172, v172
  s_add_u32 s45, s45, s101
  s_mul_i32 s85, s45, 1152
  s_lshl_b32 s45, s60, 5
  s_add_u32 s45, s45, s101
  v_mfma_f32_32x32x16_bf16 v[184:199], v[88:91], v[68:71], v[184:199]
  buffer_load_dwordx4 a[124:127], v21, s[28:31], s55 offen offset:1024 sc1
  v_exp_f32 v173, v173
  v_exp_f32 v174, v174
  v_exp_f32 v175, v175
  v_exp_f32 v176, v176
  v_exp_f32 v177, v177
  s_waitcnt lgkmcnt(2)
  v_mfma_f32_32x32x16_bf16 a[72:87], a[224:227], v[152:155], 0
  buffer_store_dwordx4 v[140:143], v21, s[28:31], s51 offen offset:3072 sc1
  v_exp_f32 v178, v178
  v_exp_f32 v179, v179
  v_exp_f32 v180, v180
  v_exp_f32 v181, v181
  v_cvt_pk_bf16_f32 v168, v168, v169
  v_cvt_pk_bf16_f32 v169, v170, v171
  v_mfma_f32_32x32x16_bf16 a[72:87], a[228:231], v[156:159], a[72:87]
  ds_read_b64_tr_b16 a[208:209], v2 offset:15360
  ds_read_b64_tr_b16 a[210:211], v2 offset:15488
  v_max_f32 v18, v18, v19
  v_mov_b32 v19, v18
  s_nop 1
  v_permlane32_swap_b32 v18, v19
  v_max_f32 v18, v18, v19
  v_sub_f32 v18, 0, v18
  v_cvt_pk_bf16_f32 v19, v18, v18
  v_lshlrev_b32 v19, 16, v19
  v_sub_f32 v18, v18, v19
  v_cvt_pk_bf16_f32 v18, v19, v18
  v_cndmask_b32_e64 v74, 0, v18, s[96:97]
  v_exp_f32 v182, v182
  v_exp_f32 v183, v183
  v_cvt_pk_bf16_f32 v170, v172, v173
  v_cvt_pk_bf16_f32 v171, v174, v175
  v_cvt_pk_bf16_f32 v172, v176, v177
  v_cvt_pk_bf16_f32 v173, v178, v179
  v_cvt_pk_bf16_f32 v174, v180, v181
  v_cvt_pk_bf16_f32 v175, v182, v183
  s_add_u32 s45, s45, 160
  s_cmp_eq_u32 s60, 3
  s_cselect_b32 s45, s100, s45
  s_mul_i32 s70, s45, 1152
  v_mfma_f32_32x32x16_bf16 v[200:215], a[16:19], v[60:63], 0
  ds_read_b64_tr_b16 a[212:213], v2 offset:15616
  ds_read_b64_tr_b16 a[214:215], v2 offset:15744
  v_exp_f32 v184, v184
  v_exp_f32 v185, v185
  v_exp_f32 v186, v186
  v_exp_f32 v187, v187
  v_exp_f32 v188, v188
  s_and_b32 s45, s60, 1
  s_lshl_b32 s45, s45, 4
  s_add_u32 s45, s45, s100
  s_mul_i32 s87, s45, 1152
  v_accvgpr_read_b32 v248, a192
  v_accvgpr_read_b32 v249, a193
  v_accvgpr_read_b32 v250, a194
  v_accvgpr_read_b32 v251, a195
  v_accvgpr_read_b32 v252, a196
  v_accvgpr_read_b32 v253, a197
  v_accvgpr_read_b32 v254, a198
  v_accvgpr_read_b32 v255, a199
  v_cvt_pk_bf16_f32 v144, v248, v249
  v_cvt_pk_bf16_f32 v145, v250, v251
  v_cvt_pk_bf16_f32 v146, v252, v253
  v_cvt_pk_bf16_f32 v147, v254, v255
  v_pk_max_i16 v144, v144, 0
  v_pk_max_i16 v145, v145, 0
  v_pk_max_i16 v146, v146, 0
  v_pk_max_i16 v147, v147, 0
  v_accvgpr_read_b32 v248, a200
  v_accvgpr_read_b32 v249, a201
  v_accvgpr_read_b32 v250, a202
  v_accvgpr_read_b32 v251, a203
  v_accvgpr_read_b32 v252, a204
  v_accvgpr_read_b32 v253, a205
  v_accvgpr_read_b32 v254, a206
  v_accvgpr_read_b32 v255, a207
  v_cvt_pk_bf16_f32 v148, v248, v249
  v_cvt_pk_bf16_f32 v149, v250, v251
  v_cvt_pk_bf16_f32 v150, v252, v253
  v_cvt_pk_bf16_f32 v151, v254, v255
  v_pk_max_i16 v148, v148, 0
  v_pk_max_i16 v149, v149, 0
L_pg6:
  s_cbranch_execz L_pg10
  v_pk_max_i16 v150, v150, 0
  v_pk_max_i16 v151, v151, 0
  v_mfma_f32_32x32x16_bf16 v[200:215], v[92:95], v[68:71], v[200:215]
  buffer_load_dwordx4 a[128:131], v21, s[28:31], s55 offen offset:2048 sc1
  v_exp_f32 v189, v189
  v_exp_f32 v190, v190
  v_exp_f32 v191, v191
  v_exp_f32 v192, v192
  v_exp_f32 v193, v193
  v_mfma_f32_32x32x16_bf16 a[72:87], a[232:235], v[168:171], a[72:87]
  v_exp_f32 v194, v194
  v_exp_f32 v195, v195
  v_exp_f32 v196, v196
  v_exp_f32 v197, v197
  v_cvt_pk_bf16_f32 v184, v184, v185
  v_cvt_pk_bf16_f32 v185, v186, v187
  s_add_u32 s51, s56, 16384
  buffer_store_dwordx4 v[144:147], v21, s[28:31], s51 offen offset:0 sc1
  s_waitcnt lgkmcnt(4)
  v_mfma_f32_32x32x16_bf16 a[72:87], a[236:239], v[172:175], a[72:87]
  ds_read_b64_tr_b16 a[216:217], v2 offset:20480
  ds_read_b64_tr_b16 a[218:219], v2 offset:20608
  v_exp_f32 v198, v198
  v_exp_f32 v199, v199
  v_cvt_pk_bf16_f32 v186, v188, v189
  v_cvt_pk_bf16_f32 v187, v190, v191
  v_cvt_pk_bf16_f32 v188, v192, v193
  v_cvt_pk_bf16_f32 v189, v194, v195
  v_cvt_pk_bf16_f32 v190, v196, v197
  v_cvt_pk_bf16_f32 v191, v198, v199
  s_mul_i32 s44, s44, 36
  s_lshl_b32 s45, s60, 3
  s_lshr_b32 s100, s60, 1
  s_lshl_b32 s100, s100, 2
  v_mfma_f32_32x32x16_bf16 v[152:167], a[20:23], v[60:63], 0
  buffer_store_dwordx4 v[148:151], v21, s[28:31], s51 offen offset:1024 sc1
  ds_read_b64_tr_b16 a[220:221], v2 offset:20736
  ds_read_b64_tr_b16 a[222:223], v2 offset:20864
  v_exp_f32 v200, v200
  v_exp_f32 v201, v201
  v_exp_f32 v202, v202
  v_exp_f32 v203, v203
  v_exp_f32 v204, v204
  v_mfma_f32_32x32x16_bf16 v[152:167], v[96:99], v[68:71], v[152:167]
  buffer_load_dwordx4 a[132:135], v21, s[28:31], s55 offen offset:3072 sc1
  v_exp_f32 v205, v205
  v_exp_f32 v206, v206
  v_exp_f32 v207, v207
  v_exp_f32 v208, v208
  v_exp_f32 v209, v209
  s_waitcnt lgkmcnt(2)
  v_mfma_f32_32x32x16_bf16 a[72:87], a[208:211], v[184:187], a[72:87]
  v_exp_f32 v210, v210
  v_exp_f32 v211, v211
  v_exp_f32 v212, v212
  v_exp_f32 v213, v213
  v_cvt_pk_bf16_f32 v200, v200, v201
  v_cvt_pk_bf16_f32 v201, v202, v203
  s_add_u32 s45, s45, s100
  s_add_u32 s45, s45, s44
  s_mul_i32 s81, s45, 1152
  s_add_u32 s45, s44, 16
  v_mfma_f32_32x32x16_bf16 a[72:87], a[212:215], v[188:191], a[72:87]
  ds_read_b64_tr_b16 a[224:225], v2 offset:25600
  ds_read_b64_tr_b16 a[226:227], v2 offset:25728
  v_exp_f32 v214, v214
  v_exp_f32 v215, v215
  v_cvt_pk_bf16_f32 v202, v204, v205
  v_cvt_pk_bf16_f32 v203, v206, v207
  v_cvt_pk_bf16_f32 v204, v208, v209
  v_cvt_pk_bf16_f32 v205, v210, v211
  v_cvt_pk_bf16_f32 v206, v212, v213
  v_cvt_pk_bf16_f32 v207, v214, v215
  s_mul_i32 s100, s45, 1152
  s_cmp_eq_u32 s60, 1
  s_cselect_b32 s45, 20, 0
  s_add_u32 s45, s45, s44
  v_mfma_f32_32x32x16_bf16 v[168:183], a[24:27], v[60:63], 0
  ds_read_b64_tr_b16 a[228:229], v2 offset:25856
  ds_read_b64_tr_b16 a[230:231], v2 offset:25984
  v_exp_f32 v152, v152
  v_exp_f32 v153, v153
  v_exp_f32 v154, v154
  v_exp_f32 v155, v155
  v_exp_f32 v156, v156
  s_mul_i32 s45, s45, 1152
  s_bitcmp1_b32 s60, 0
  s_cselect_b32 s82, s100, s82
  s_cmp_ge_u32 s60, 2
  s_cselect_b32 s94, s82, s45
  v_mfma_f32_32x32x16_bf16 v[168:183], v[100:103], v[68:71], v[168:183]
  v_exp_f32 v157, v157
  v_exp_f32 v158, v158
  v_exp_f32 v159, v159
  v_exp_f32 v160, v160
  v_exp_f32 v161, v161
  s_and_b32 s83, s50, 1024
  v_mfma_f32_32x32x16_bf16 a[72:87], a[216:219], v[200:203], a[72:87]
  v_exp_f32 v162, v162
  v_exp_f32 v163, v163
  v_exp_f32 v164, v164
  v_exp_f32 v165, v165
  v_cvt_pk_bf16_f32 v152, v152, v153
  v_cvt_pk_bf16_f32 v153, v154, v155
  v_accvgpr_read_b32 v12, a243
  v_add_u32 v13, 8192, v12
  v_add_u32 v14, 16384, v12
  v_add_u32 v15, 24576, v12
  s_waitcnt lgkmcnt(4)
  v_mfma_f32_32x32x16_bf16 a[72:87], a[220:223], v[204:207], a[72:87]
  ds_read_b64_tr_b16 a[232:233], v2 offset:30720
  ds_read_b64_tr_b16 a[234:235], v2 offset:30848
  v_exp_f32 v166, v166
  v_exp_f32 v167, v167
  v_cvt_pk_bf16_f32 v154, v156, v157
  v_cvt_pk_bf16_f32 v155, v158, v159
  v_cvt_pk_bf16_f32 v156, v160, v161
  v_cvt_pk_bf16_f32 v157, v162, v163
  v_cvt_pk_bf16_f32 v158, v164, v165
  v_cvt_pk_bf16_f32 v159, v166, v167
  s_add_u32 m0, s48, 0
  s_add_u32 s44, s67, s62
  v_mfma_f32_32x32x16_bf16 v[184:199], a[28:31], v[60:63], 0
  buffer_load_dwordx4 v12, s[16:19], s44 offen offset:0 lds
  ds_read_b64_tr_b16 a[236:237], v2 offset:30976
  ds_read_b64_tr_b16 a[238:239], v2 offset:31104
  v_exp_f32 v168, v168
  v_exp_f32 v169, v169
  v_exp_f32 v170, v170
  v_exp_f32 v171, v171
  v_exp_f32 v172, v172
  v_mfma_f32_32x32x16_bf16 v[184:199], v[104:107], v[68:71], v[184:199]
  buffer_load_dwordx4 v13, s[16:19], s44 offen offset:1024 lds
  v_exp_f32 v173, v173
  v_exp_f32 v174, v174
  v_exp_f32 v175, v175
  v_exp_f32 v176, v176
  v_exp_f32 v177, v177
  s_waitcnt lgkmcnt(2)
  v_mfma_f32_32x32x16_bf16 a[72:87], a[224:227], v[152:155], a[72:87]
  buffer_load_dwordx4 v14, s[16:19], s44 offen offset:2048 lds
  v_exp_f32 v178, v178
  v_exp_f32 v179, v179
  v_exp_f32 v180, v180
  v_exp_f32 v181, v181
  v_cvt_pk_bf16_f32 v168, v168, v169
  v_cvt_pk_bf16_f32 v169, v170, v171
  v_mfma_f32_32x32x16_bf16 a[72:87], a[228:231], v[156:159], a[72:87]
  buffer_load_dwordx4 v15, s[16:19], s44 offen offset:3072 lds
  ds_read_b64_tr_b16 a[208:209], v2 offset:35840
  ds_read_b64_tr_b16 a[210:211], v2 offset:35968
  v_exp_f32 v182, v182
  v_exp_f32 v183, v183
  v_cvt_pk_bf16_f32 v170, v172, v173
  v_cvt_pk_bf16_f32 v171, v174, v175
  v_cvt_pk_bf16_f32 v172, v176, v177
  v_cvt_pk_bf16_f32 v173, v178, v179
  v_cvt_pk_bf16_f32 v174, v180, v181
  v_cvt_pk_bf16_f32 v175, v182, v183
  v_mfma_f32_32x32x16_bf16 v[200:215], a[0:3], v[60:63], v[216:231]
  ds_read_b64_tr_b16 a[212:213], v2 offset:36096
  ds_read_b64_tr_b16 a[214:215], v2 offset:36224
  v_exp_f32 v184, v184
  v_exp_f32 v185, v185
  v_exp_f32 v186, v186
  v_exp_f32 v187, v187
  v_exp_f32 v188, v188
  s_add_u32 m0, s48, 4096
  s_add_u32 s44, s44, 36864
  v_mfma_f32_32x32x16_bf16 v[200:215], v[76:79], v[68:71], v[200:215]
  buffer_load_dwordx4 v12, s[16:19], s44 offen offset:0 lds
  v_exp_f32 v189, v189
  v_exp_f32 v190, v190
  v_exp_f32 v191, v191
  v_exp_f32 v192, v192
  v_exp_f32 v193, v193
  v_mfma_f32_32x32x16_bf16 a[72:87], a[232:235], v[168:171], a[72:87]
  v_exp_f32 v194, v194
  v_exp_f32 v195, v195
  v_exp_f32 v196, v196
  v_exp_f32 v197, v197
  v_cvt_pk_bf16_f32 v184, v184, v185
  v_cvt_pk_bf16_f32 v185, v186, v187
  s_add_u32 m0, s49, 20480
  s_add_u32 s44, s69, s62
  s_waitcnt lgkmcnt(4)
  v_mfma_f32_32x32x16_bf16 a[72:87], a[236:239], v[172:175], a[72:87]
  ds_read_b64_tr_b16 a[216:217], v2 offset:0
  ds_read_b64_tr_b16 a[218:219], v2 offset:128
  v_exp_f32 v198, v198
  v_exp_f32 v199, v199
  v_cvt_pk_bf16_f32 v186, v188, v189
  v_cvt_pk_bf16_f32 v187, v190, v191
  v_cvt_pk_bf16_f32 v188, v192, v193
  v_cvt_pk_bf16_f32 v189, v194, v195
  v_cvt_pk_bf16_f32 v190, v196, v197
  v_cvt_pk_bf16_f32 v191, v198, v199
  v_mfma_f32_32x32x16_bf16 v[152:167], a[32:35], v[60:63], v[232:247]
  ds_read_b64_tr_b16 a[220:221], v2 offset:256
  ds_read_b64_tr_b16 a[222:223], v2 offset:384
  v_exp_f32 v200, v200
  v_exp_f32 v201, v201
  v_exp_f32 v202, v202
  v_exp_f32 v203, v203
  v_exp_f32 v204, v204
  v_mfma_f32_32x32x16_bf16 v[152:167], v[108:111], v[68:71], v[152:167]
  buffer_load_dwordx4 v12, s[16:19], s44 offen offset:0 lds
  v_exp_f32 v205, v205
  v_exp_f32 v206, v206
  v_exp_f32 v207, v207
  v_exp_f32 v208, v208
  v_exp_f32 v209, v209
  s_waitcnt lgkmcnt(2)
  v_mfma_f32_32x32x16_bf16 a[72:87], a[208:211], v[184:187], a[72:87]
  v_exp_f32 v210, v210
  v_exp_f32 v211, v211
  v_exp_f32 v212, v212
  v_exp_f32 v213, v213
  v_cvt_pk_bf16_f32 v200, v200, v201
  v_cvt_pk_bf16_f32 v201, v202, v203
  v_mfma_f32_32x32x16_bf16 a[72:87], a[212:215], v[188:191], a[72:87]
  ds_read_b64_tr_b16 a[224:225], v2 offset:40960
  ds_read_b64_tr_b16 a[226:227], v2 offset:41088
  v_exp_f32 v214, v214
  v_exp_f32 v215, v215
  v_cvt_pk_bf16_f32 v202, v204, v205
  v_cvt_pk_bf16_f32 v203, v206, v207
  v_cvt_pk_bf16_f32 v204, v208, v209
  v_cvt_pk_bf16_f32 v205, v210, v211
  v_cvt_pk_bf16_f32 v206, v212, v213
  v_cvt_pk_bf16_f32 v207, v214, v215
  v_mfma_f32_32x32x16_bf16 v[168:183], a[40:43], v[64:67], 0
  ds_read_b64_tr_b16 a[228:229], v2 offset:41216
  ds_read_b64_tr_b16 a[230:231], v2 offset:41344
  v_exp_f32 v152, v152
  v_exp_f32 v153, v153
  v_exp_f32 v154, v154
  v_exp_f32 v155, v155
  v_exp_f32 v156, v156
  v_mfma_f32_32x32x16_bf16 v[168:183], v[80:83], v[72:75], v[168:183]
  buffer_load_dwordx4 v13, s[16:19], s44 offen offset:1024 lds
  v_exp_f32 v157, v157
  v_exp_f32 v158, v158
  v_exp_f32 v159, v159
  v_exp_f32 v160, v160
  v_exp_f32 v161, v161
  v_mfma_f32_32x32x16_bf16 a[72:87], a[216:219], v[200:203], a[72:87]
  v_exp_f32 v162, v162
  v_exp_f32 v163, v163
  v_exp_f32 v164, v164
  v_exp_f32 v165, v165
  v_cvt_pk_bf16_f32 v152, v152, v153
  v_cvt_pk_bf16_f32 v153, v154, v155
  s_waitcnt lgkmcnt(4)
  v_mfma_f32_32x32x16_bf16 a[72:87], a[220:223], v[204:207], a[72:87]
  ds_read_b64_tr_b16 a[232:233], v3 offset:5120
  ds_read_b64_tr_b16 a[234:235], v3 offset:5248
  v_exp_f32 v166, v166
  v_exp_f32 v167, v167
  v_cvt_pk_bf16_f32 v154, v156, v157
  v_cvt_pk_bf16_f32 v155, v158, v159
  v_cvt_pk_bf16_f32 v156, v160, v161
  v_cvt_pk_bf16_f32 v157, v162, v163
  v_cvt_pk_bf16_f32 v158, v164, v165
  v_cvt_pk_bf16_f32 v159, v166, v167
  v_mfma_f32_32x32x16_bf16 v[184:199], a[44:47], v[64:67], 0
  ds_read_b64_tr_b16 a[236:237], v3 offset:5376
  ds_read_b64_tr_b16 a[238:239], v3 offset:5504
  v_exp_f32 v168, v168
  v_exp_f32 v169, v169
  v_exp_f32 v170, v170
  v_exp_f32 v171, v171
  v_exp_f32 v172, v172
  v_mfma_f32_32x32x16_bf16 v[184:199], v[84:87], v[72:75], v[184:199]
  buffer_load_dwordx4 v14, s[16:19], s44 offen offset:2048 lds
  v_exp_f32 v173, v173
  v_exp_f32 v174, v174
  v_exp_f32 v175, v175
  v_exp_f32 v176, v176
  v_exp_f32 v177, v177
  s_waitcnt lgkmcnt(2)
  v_mfma_f32_32x32x16_bf16 a[72:87], a[224:227], v[152:155], a[72:87]
  v_exp_f32 v178, v178
  v_exp_f32 v179, v179
  v_exp_f32 v180, v180
  v_exp_f32 v181, v181
  v_cvt_pk_bf16_f32 v168, v168, v169
  v_cvt_pk_bf16_f32 v169, v170, v171
  v_mfma_f32_32x32x16_bf16 a[72:87], a[228:231], v[156:159], a[72:87]
  ds_read_b64_tr_b16 a[208:209], v3 offset:10240
  ds_read_b64_tr_b16 a[210:211], v3 offset:10368
  v_exp_f32 v182, v182
  v_exp_f32 v183, v183
  v_cvt_pk_bf16_f32 v170, v172, v173
  v_cvt_pk_bf16_f32 v171, v174, v175
  v_cvt_pk_bf16_f32 v172, v176, v177
  v_cvt_pk_bf16_f32 v173, v178, v179
  v_cvt_pk_bf16_f32 v174, v180, v181
  v_cvt_pk_bf16_f32 v175, v182, v183
  v_mfma_f32_32x32x16_bf16 v[200:215], a[48:51], v[64:67], 0
  ds_read_b64_tr_b16 a[212:213], v3 offset:10496
  ds_read_b64_tr_b16 a[214:215], v3 offset:10624
  v_exp_f32 v184, v184
  v_exp_f32 v185, v185
  v_exp_f32 v186, v186
  v_exp_f32 v187, v187
  v_exp_f32 v188, v188
  s_cmp_eq_u32 s60, 1
  s_cselect_b32 s3, 0, 0x80000000
  v_min_u32 v20, 35, v1
  v_mul_u32_u24 v20, 1152, v20
  v_mfma_f32_32x32x16_bf16 v[200:215], v[88:91], v[72:75], v[200:215]
  buffer_load_dwordx4 v15, s[16:19], s44 offen offset:3072 lds
  v_exp_f32 v189, v189
  v_exp_f32 v190, v190
  v_exp_f32 v191, v191
  v_exp_f32 v192, v192
  v_exp_f32 v193, v193
  v_mfma_f32_32x32x16_bf16 a[88:103], a[232:235], v[168:171], 0
  v_exp_f32 v194, v194
  v_exp_f32 v195, v195
  v_exp_f32 v196, v196
  v_exp_f32 v197, v197
  v_cvt_pk_bf16_f32 v184, v184, v185
  v_cvt_pk_bf16_f32 v185, v186, v187
  s_add_u32 m0, s50, 36864
  s_add_u32 s44, s80, s62
  s_waitcnt lgkmcnt(4)
  v_mfma_f32_32x32x16_bf16 a[88:103], a[236:239], v[172:175], a[88:103]
  buffer_load_dwordx4 v12, s[20:23], s44 offen offset:0 lds
  ds_read_b64_tr_b16 a[216:217], v3 offset:15360
  ds_read_b64_tr_b16 a[218:219], v3 offset:15488
  v_exp_f32 v198, v198
  v_exp_f32 v199, v199
  v_cvt_pk_bf16_f32 v186, v188, v189
  v_cvt_pk_bf16_f32 v187, v190, v191
  v_cvt_pk_bf16_f32 v188, v192, v193
  v_cvt_pk_bf16_f32 v189, v194, v195
  v_cvt_pk_bf16_f32 v190, v196, v197
  v_cvt_pk_bf16_f32 v191, v198, v199
  v_accvgpr_read_b32 v22, a84
  v_mfma_f32_32x32x16_bf16 v[152:167], a[52:55], v[64:67], 0
  ds_read_b64_tr_b16 a[220:221], v3 offset:15616
  ds_read_b64_tr_b16 a[222:223], v3 offset:15744
  v_exp_f32 v200, v200
  v_exp_f32 v201, v201
  v_exp_f32 v202, v202
  v_exp_f32 v203, v203
  v_exp_f32 v204, v204
  s_waitcnt vmcnt(11)
  s_add_u32 s76, s92, 3
  v_mov_b32 v24, s76
  buffer_store_dwordx2 v[24:25], v4, s[28:31], s90 offen sc1
  v_mfma_f32_32x32x16_bf16 v[152:167], v[92:95], v[72:75], v[152:167]
  v_exp_f32 v205, v205
  v_exp_f32 v206, v206
  v_exp_f32 v207, v207
  v_exp_f32 v208, v208
  v_exp_f32 v209, v209
  v_or_b32 v20, s3, v20
  s_and_b32 s3, s2, 3
  s_mul_i32 s3, s3, 1327104
  s_lshr_b32 s43, s2, 3
  s_waitcnt lgkmcnt(2)
  v_mfma_f32_32x32x16_bf16 a[88:103], a[208:211], v[184:187], a[88:103]
  v_exp_f32 v210, v210
  v_exp_f32 v211, v211
  v_exp_f32 v212, v212
  v_exp_f32 v213, v213
  v_cvt_pk_bf16_f32 v200, v200, v201
  v_cvt_pk_bf16_f32 v201, v202, v203
  s_mul_i32 s43, s43, 41472
  s_add_u32 s3, s3, s43
  buffer_load_dword v20, v20, s[16:19], s3 offen offset:512
  v_mfma_f32_32x32x16_bf16 a[88:103], a[212:215], v[188:191], a[88:103]
  ds_read_b64_tr_b16 a[224:225], v3 offset:20480
  ds_read_b64_tr_b16 a[226:227], v3 offset:20608
  v_exp_f32 v214, v214
  v_exp_f32 v215, v215
  v_cvt_pk_bf16_f32 v202, v204, v205
  v_cvt_pk_bf16_f32 v203, v206, v207
  v_cvt_pk_bf16_f32 v204, v208, v209
  v_cvt_pk_bf16_f32 v205, v210, v211
  v_cvt_pk_bf16_f32 v206, v212, v213
  v_cvt_pk_bf16_f32 v207, v214, v215
  v_accvgpr_read_b32 v248, a72
  v_accvgpr_read_b32 v249, a73
  v_mfma_f32_32x32x16_bf16 v[168:183], a[56:59], v[64:67], 0
  ds_read_b64_tr_b16 a[228:229], v3 offset:20736
  ds_read_b64_tr_b16 a[230:231], v3 offset:20864
  v_exp_f32 v152, v152
  v_exp_f32 v153, v153
  v_exp_f32 v154, v154
  v_exp_f32 v155, v155
  v_exp_f32 v156, v156
  v_accvgpr_read_b32 v250, a74
  v_accvgpr_read_b32 v251, a75
  v_mfma_f32_32x32x16_bf16 v[168:183], v[96:99], v[72:75], v[168:183]
  v_exp_f32 v157, v157
  v_exp_f32 v158, v158
  v_exp_f32 v159, v159
  v_exp_f32 v160, v160
  v_exp_f32 v161, v161
  v_accvgpr_read_b32 v252, a76
  v_accvgpr_read_b32 v253, a77
  v_mfma_f32_32x32x16_bf16 a[88:103], a[216:219], v[200:203], a[88:103]
  v_exp_f32 v162, v162
  v_exp_f32 v163, v163
  v_exp_f32 v164, v164
  v_exp_f32 v165, v165
  v_cvt_pk_bf16_f32 v152, v152, v153
  v_cvt_pk_bf16_f32 v153, v154, v155
  v_accvgpr_read_b32 v254, a78
  v_accvgpr_read_b32 v255, a79
  s_waitcnt lgkmcnt(4)
  v_mfma_f32_32x32x16_bf16 a[88:103], a[220:223], v[204:207], a[88:103]
  ds_read_b64_tr_b16 a[232:233], v3 offset:25600
  ds_read_b64_tr_b16 a[234:235], v3 offset:25728
  v_exp_f32 v166, v166
  v_exp_f32 v167, v167
  v_cvt_pk_bf16_f32 v154, v156, v157
  v_cvt_pk_bf16_f32 v155, v158, v159
  v_cvt_pk_bf16_f32 v156, v160, v161
  v_cvt_pk_bf16_f32 v157, v162, v163
  v_cvt_pk_bf16_f32 v158, v164, v165
  v_cvt_pk_bf16_f32 v159, v166, v167
  v_rcp_f32 v22, v22
  v_mfma_f32_32x32x16_bf16 v[184:199], a[60:63], v[64:67], 0
  ds_read_b64_tr_b16 a[236:237], v3 offset:25856
  ds_read_b64_tr_b16 a[238:239], v3 offset:25984
  v_exp_f32 v168, v168
  v_exp_f32 v169, v169
  v_exp_f32 v170, v170
  v_exp_f32 v171, v171
  v_exp_f32 v172, v172
  v_accvgpr_read_b32 v23, a80
  v_mul_f32 v248, v22, v248
  v_mfma_f32_32x32x16_bf16 v[184:199], v[100:103], v[72:75], v[184:199]
  v_exp_f32 v173, v173
  v_exp_f32 v174, v174
  v_exp_f32 v175, v175
  v_exp_f32 v176, v176
  v_exp_f32 v177, v177
  v_mul_f32 v249, v22, v249
  v_mul_f32 v250, v22, v250
  s_waitcnt lgkmcnt(2)
  v_mfma_f32_32x32x16_bf16 a[88:103], a[224:227], v[152:155], a[88:103]
  v_exp_f32 v178, v178
  v_exp_f32 v179, v179
  v_exp_f32 v180, v180
  v_exp_f32 v181, v181
  v_cvt_pk_bf16_f32 v168, v168, v169
  v_cvt_pk_bf16_f32 v169, v170, v171
  v_mul_f32 v251, v22, v251
  v_mul_f32 v252, v22, v252
  v_mfma_f32_32x32x16_bf16 a[88:103], a[228:231], v[156:159], a[88:103]
  ds_read_b64_tr_b16 a[208:209], v3 offset:30720
  ds_read_b64_tr_b16 a[210:211], v3 offset:30848
  v_exp_f32 v182, v182
  v_exp_f32 v183, v183
  v_cvt_pk_bf16_f32 v170, v172, v173
  v_cvt_pk_bf16_f32 v171, v174, v175
  v_cvt_pk_bf16_f32 v172, v176, v177
  v_cvt_pk_bf16_f32 v173, v178, v179
  v_cvt_pk_bf16_f32 v174, v180, v181
  v_cvt_pk_bf16_f32 v175, v182, v183
  v_mul_f32 v253, v22, v253
  v_mul_f32 v254, v22, v254
  v_mfma_f32_32x32x16_bf16 v[200:215], a[64:67], v[64:67], 0
  ds_read_b64_tr_b16 a[212:213], v3 offset:30976
  ds_read_b64_tr_b16 a[214:215], v3 offset:31104
  v_exp_f32 v184, v184
  v_exp_f32 v185, v185
  v_exp_f32 v186, v186
  v_exp_f32 v187, v187
  v_exp_f32 v188, v188
  v_mul_f32 v255, v22, v255
  v_cvt_pk_bf16_f32 v60, v248, v249
  v_mfma_f32_32x32x16_bf16 v[200:215], v[104:107], v[72:75], v[200:215]
  v_exp_f32 v189, v189
  v_exp_f32 v190, v190
  v_exp_f32 v191, v191
  v_exp_f32 v192, v192
  v_exp_f32 v193, v193
  v_cvt_pk_bf16_f32 v61, v250, v251
  v_cvt_pk_bf16_f32 v62, v252, v253
  v_mfma_f32_32x32x16_bf16 a[88:103], a[232:235], v[168:171], a[88:103]
  v_exp_f32 v194, v194
  v_exp_f32 v195, v195
  v_exp_f32 v196, v196
  v_exp_f32 v197, v197
  v_cvt_pk_bf16_f32 v184, v184, v185
  v_cvt_pk_bf16_f32 v185, v186, v187
  v_cvt_pk_bf16_f32 v63, v254, v255
  v_accvgpr_read_b32 v248, a81
  s_waitcnt lgkmcnt(4)
  v_mfma_f32_32x32x16_bf16 a[88:103], a[236:239], v[172:175], a[88:103]
  ds_read_b64_tr_b16 a[216:217], v3 offset:35840
  ds_read_b64_tr_b16 a[218:219], v3 offset:35968
  v_exp_f32 v198, v198
  v_exp_f32 v199, v199
  v_cvt_pk_bf16_f32 v186, v188, v189
  v_cvt_pk_bf16_f32 v187, v190, v191
  v_cvt_pk_bf16_f32 v188, v192, v193
  v_cvt_pk_bf16_f32 v189, v194, v195
  v_cvt_pk_bf16_f32 v190, v196, v197
  v_cvt_pk_bf16_f32 v191, v198, v199
  v_mul_f32 v23, v22, v23
  v_mul_f32 v248, v22, v248
  v_cvt_pk_bf16_f32 v248, v23, v248
  v_cndmask_b32_e64 v68, 0, v248, s[96:97]
  v_mov_b32 v70, 0
  v_mfma_f32_32x32x16_bf16 v[152:167], a[36:39], v[64:67], v[216:231]
  ds_read_b64_tr_b16 a[220:221], v3 offset:36096
  ds_read_b64_tr_b16 a[222:223], v3 offset:36224
  v_exp_f32 v200, v200
  v_exp_f32 v201, v201
  v_exp_f32 v202, v202
  v_exp_f32 v203, v203
  v_exp_f32 v204, v204
  s_add_u32 s51, s56, 16384
  buffer_store_dwordx4 v[60:63], v21, s[28:31], s51 offen offset:2048 sc1
  v_mfma_f32_32x32x16_bf16 v[152:167], v[76:79], v[72:75], v[152:167]
  ds_read_b64_tr_b16 a[224:225], v3 offset:0
  ds_read_b64_tr_b16 a[226:227], v3 offset:128
  v_exp_f32 v205, v205
  v_exp_f32 v206, v206
  v_exp_f32 v207, v207
  v_exp_f32 v208, v208
  v_exp_f32 v209, v209
  s_add_u32 m0, s48, 40960
  s_add_u32 s44, s68, s62
  s_waitcnt lgkmcnt(4)
  v_mfma_f32_32x32x16_bf16 a[88:103], a[208:211], v[184:187], a[88:103]
  buffer_load_dwordx4 v12, s[16:19], s44 offen offset:0 lds
  ds_read_b64_tr_b16 a[228:229], v3 offset:256
  ds_read_b64_tr_b16 a[230:231], v3 offset:384
  v_exp_f32 v210, v210
  v_exp_f32 v211, v211
  v_exp_f32 v212, v212
  v_exp_f32 v213, v213
  v_cvt_pk_bf16_f32 v200, v200, v201
  v_cvt_pk_bf16_f32 v201, v202, v203
  v_mfma_f32_32x32x16_bf16 a[88:103], a[212:215], v[188:191], a[88:103]
  buffer_load_dwordx4 v13, s[16:19], s44 offen offset:1024 lds
  ds_read_b64_tr_b16 a[232:233], v3 offset:40960
  ds_read_b64_tr_b16 a[234:235], v3 offset:41088
  v_exp_f32 v214, v214
  v_exp_f32 v215, v215
  v_cvt_pk_bf16_f32 v202, v204, v205
  v_cvt_pk_bf16_f32 v203, v206, v207
  v_cvt_pk_bf16_f32 v204, v208, v209
  v_cvt_pk_bf16_f32 v205, v210, v211
  v_cvt_pk_bf16_f32 v206, v212, v213
  v_cvt_pk_bf16_f32 v207, v214, v215
  v_mfma_f32_32x32x16_bf16 v[168:183], a[68:71], v[64:67], v[232:247]
  buffer_load_dwordx4 v14, s[16:19], s44 offen offset:2048 lds
  ds_read_b64_tr_b16 a[236:237], v3 offset:41216
  ds_read_b64_tr_b16 a[238:239], v3 offset:41344
  v_exp_f32 v152, v152
  v_exp_f32 v153, v153
  v_exp_f32 v154, v154
  v_exp_f32 v155, v155
  v_exp_f32 v156, v156
  s_waitcnt vmcnt(11)
  s_barrier
  v_mfma_f32_32x32x16_bf16 v[168:183], v[108:111], v[72:75], v[168:183]
  buffer_load_dwordx4 v15, s[16:19], s44 offen offset:3072 lds
  ds_read_b64_tr_b16 a[208:209], v9 offset:0
  ds_read_b64_tr_b16 a[210:211], v9 offset:1024
  v_exp_f32 v157, v157
  v_exp_f32 v158, v158
  v_exp_f32 v159, v159
  v_exp_f32 v160, v160
  v_exp_f32 v161, v161
  v_mfma_f32_32x32x16_bf16 a[88:103], a[216:219], v[200:203], a[88:103]
  ds_read_b64_tr_b16 a[212:213], v10 offset:0
  ds_read_b64_tr_b16 a[214:215], v10 offset:1024
  v_exp_f32 v162, v162
  v_exp_f32 v163, v163
  v_exp_f32 v164, v164
  v_exp_f32 v165, v165
  v_cvt_pk_bf16_f32 v152, v152, v153
  v_cvt_pk_bf16_f32 v153, v154, v155
  s_add_u32 m0, s48, 45056
  s_add_u32 s44, s44, 36864
  s_waitcnt lgkmcnt(12)
  v_mfma_f32_32x32x16_bf16 a[88:103], a[220:223], v[204:207], a[88:103]
  buffer_load_dwordx4 v12, s[16:19], s44 offen offset:0 lds
  ds_read_b64_tr_b16 a[216:217], v9 offset:2048
  ds_read_b64_tr_b16 a[218:219], v9 offset:3072
  v_exp_f32 v166, v166
  v_exp_f32 v167, v167
  v_cvt_pk_bf16_f32 v154, v156, v157
  v_cvt_pk_bf16_f32 v155, v158, v159
  v_cvt_pk_bf16_f32 v156, v160, v161
  v_cvt_pk_bf16_f32 v157, v162, v163
  v_cvt_pk_bf16_f32 v158, v164, v165
  v_cvt_pk_bf16_f32 v159, v166, v167
  s_waitcnt lgkmcnt(6)
  v_mfma_f32_32x32x16_bf16 a[88:103], a[224:227], v[152:155], a[88:103]
  ds_read_b64_tr_b16 a[220:221], v10 offset:2048
  ds_read_b64_tr_b16 a[222:223], v10 offset:3072
  v_exp_f32 v168, v168
  v_exp_f32 v169, v169
  v_exp_f32 v170, v170
  v_exp_f32 v171, v171
  v_exp_f32 v172, v172
  v_exp_f32 v173, v173
  v_exp_f32 v174, v174
  v_exp_f32 v175, v175
  v_exp_f32 v176, v176
  v_exp_f32 v177, v177
  s_add_u32 m0, s49, 61440
  s_add_u32 s44, s70, s62
  v_mfma_f32_32x32x16_bf16 a[88:103], a[228:231], v[156:159], a[88:103]
  buffer_load_dwordx4 v12, s[16:19], s44 offen offset:0 lds
  ds_read_b64_tr_b16 a[224:225], v9 offset:4096
  ds_read_b64_tr_b16 a[226:227], v9 offset:5120
  v_exp_f32 v178, v178
  v_exp_f32 v179, v179
  v_exp_f32 v180, v180
  v_exp_f32 v181, v181
  v_exp_f32 v182, v182
  v_exp_f32 v183, v183
  v_cvt_pk_bf16_f32 v168, v168, v169
  v_cvt_pk_bf16_f32 v169, v170, v171
  v_cvt_pk_bf16_f32 v170, v172, v173
  v_cvt_pk_bf16_f32 v171, v174, v175
  v_cvt_pk_bf16_f32 v172, v176, v177
  v_cvt_pk_bf16_f32 v173, v178, v179
  v_cvt_pk_bf16_f32 v174, v180, v181
  v_cvt_pk_bf16_f32 v175, v182, v183
  v_mfma_f32_32x32x16_bf16 a[88:103], a[232:235], v[168:171], a[88:103]
  buffer_load_dwordx4 v13, s[16:19], s44 offen offset:1024 lds
  ds_read_b64_tr_b16 a[228:229], v10 offset:4096
  ds_read_b64_tr_b16 a[230:231], v10 offset:5120
  v_mfma_f32_32x32x16_bf16 a[88:103], a[236:239], v[172:175], a[88:103]
  buffer_load_dwordx4 v14, s[16:19], s44 offen offset:2048 lds
  ds_read_b64_tr_b16 a[232:233], v9 offset:6144
  ds_read_b64_tr_b16 a[234:235], v9 offset:7168
  s_waitcnt lgkmcnt(6)
  v_mfma_f32_32x32x16_bf16 v[152:167], a[208:211], v[28:31], 0
  buffer_load_dwordx4 v15, s[16:19], s44 offen offset:3072 lds
  ds_read_b64_tr_b16 a[236:237], v10 offset:6144
  ds_read_b64_tr_b16 a[238:239], v10 offset:7168
  buffer_load_dwordx2 v[26:27], v5, s[28:31], 0 offen sc1
  v_mfma_f32_32x32x16_bf16 v[168:183], a[212:215], v[28:31], 0
  ds_read_b64_tr_b16 a[208:209], v9 offset:8192
  ds_read_b64_tr_b16 a[210:211], v9 offset:9216
  s_add_u32 m0, s48, 77824
  s_add_u32 s44, s67, s63
  v_mfma_f32_32x32x16_bf16 v[152:167], a[216:219], v[32:35], v[152:167]
  buffer_load_dwordx4 v12, s[16:19], s44 offen offset:0 lds
  ds_read_b64_tr_b16 a[212:213], v10 offset:8192
  ds_read_b64_tr_b16 a[214:215], v10 offset:9216
  v_accvgpr_read_b32 v22, a100
  v_accvgpr_read_b32 v248, a88
  v_mfma_f32_32x32x16_bf16 v[168:183], a[220:223], v[32:35], v[168:183]
  buffer_load_dwordx4 v13, s[16:19], s44 offen offset:1024 lds
  ds_read_b64_tr_b16 a[216:217], v9 offset:10240
  ds_read_b64_tr_b16 a[218:219], v9 offset:11264
  v_accvgpr_read_b32 v249, a89
  v_accvgpr_read_b32 v250, a90
  s_waitcnt lgkmcnt(6)
  v_mfma_f32_32x32x16_bf16 v[152:167], a[224:227], v[36:39], v[152:167]
  buffer_load_dwordx4 v14, s[16:19], s44 offen offset:2048 lds
  ds_read_b64_tr_b16 a[220:221], v10 offset:10240
L_pg7:
  s_cbranch_execz L_walked
  ds_read_b64_tr_b16 a[222:223], v10 offset:11264
  v_accvgpr_read_b32 v251, a91
  v_accvgpr_read_b32 v252, a92
  v_mfma_f32_32x32x16_bf16 v[168:183], a[228:231], v[36:39], v[168:183]
  ds_read_b64_tr_b16 a[224:225], v9 offset:12288
  ds_read_b64_tr_b16 a[226:227], v9 offset:13312
  v_accvgpr_read_b32 v253, a93
  v_accvgpr_read_b32 v254, a94
  v_accvgpr_read_b32 v255, a95
  v_mfma_f32_32x32x16_bf16 v[152:167], a[232:235], v[40:43], v[152:167]
  buffer_load_dwordx4 v15, s[16:19], s44 offen offset:3072 lds
  ds_read_b64_tr_b16 a[228:229], v10 offset:12288
  ds_read_b64_tr_b16 a[230:231], v10 offset:13312
  v_rcp_f32 v22, v22
  v_mfma_f32_32x32x16_bf16 v[168:183], a[236:239], v[40:43], v[168:183]
  ds_read_b64_tr_b16 a[232:233], v9 offset:14336
  ds_read_b64_tr_b16 a[234:235], v9 offset:15360
  s_add_u32 m0, s48, 81920
  s_add_u32 s44, s44, 36864
  v_accvgpr_read_b32 v23, a98
  s_waitcnt lgkmcnt(6)
  v_mfma_f32_32x32x16_bf16 v[152:167], a[208:211], v[44:47], v[152:167]
  buffer_load_dwordx4 v12, s[16:19], s44 offen offset:0 lds
  ds_read_b64_tr_b16 a[236:237], v10 offset:14336
  ds_read_b64_tr_b16 a[238:239], v10 offset:15360
  v_mul_f32 v248, v22, v248
  v_mul_f32 v249, v22, v249
  v_mfma_f32_32x32x16_bf16 v[168:183], a[212:215], v[44:47], v[168:183]
  ds_read_b64_tr_b16 a[208:209], v9 offset:16384
  ds_read_b64_tr_b16 a[210:211], v9 offset:17408
  v_mul_f32 v250, v22, v250
  v_mul_f32 v251, v22, v251
  v_mul_f32 v252, v22, v252
  v_mfma_f32_32x32x16_bf16 v[152:167], a[216:219], v[48:51], v[152:167]
  ds_read_b64_tr_b16 a[212:213], v10 offset:16384
  ds_read_b64_tr_b16 a[214:215], v10 offset:17408
  v_mul_f32 v253, v22, v253
  v_mul_f32 v254, v22, v254
  v_mul_f32 v255, v22, v255
  v_mfma_f32_32x32x16_bf16 v[168:183], a[220:223], v[48:51], v[168:183]
  ds_read_b64_tr_b16 a[216:217], v9 offset:18432
  ds_read_b64_tr_b16 a[218:219], v9 offset:19456
  v_cvt_pk_bf16_f32 v64, v248, v249
  v_cvt_pk_bf16_f32 v65, v250, v251
  v_cvt_pk_bf16_f32 v66, v252, v253
  s_waitcnt lgkmcnt(6)
  v_mfma_f32_32x32x16_bf16 v[152:167], a[224:227], v[52:55], v[152:167]
  ds_read_b64_tr_b16 a[220:221], v10 offset:18432
  ds_read_b64_tr_b16 a[222:223], v10 offset:19456
  v_cvt_pk_bf16_f32 v67, v254, v255
  v_accvgpr_read_b32 v248, a99
  v_mul_f32 v23, v22, v23
  s_waitcnt vmcnt(18)
  s_barrier
  v_mfma_f32_32x32x16_bf16 v[168:183], a[228:231], v[52:55], v[168:183]
  ds_read_b64_tr_b16 a[224:225], v9 offset:20480
  ds_read_b64_tr_b16 a[226:227], v9 offset:21504
  s_add_u32 m0, s49, 102400
  s_add_u32 s44, s69, s63
  v_mul_f32 v248, v22, v248
  v_mfma_f32_32x32x16_bf16 v[152:167], a[232:235], v[56:59], v[152:167]
  buffer_load_dwordx4 v12, s[16:19], s44 offen offset:0 lds
  ds_read_b64_tr_b16 a[228:229], v10 offset:20480
  ds_read_b64_tr_b16 a[230:231], v10 offset:21504
  v_cvt_pk_bf16_f32 v248, v23, v248
  v_cndmask_b32_e64 v69, 0, v248, s[96:97]
  v_mfma_f32_32x32x16_bf16 v[168:183], a[236:239], v[56:59], v[168:183]
  buffer_load_dwordx4 v13, s[16:19], s44 offen offset:1024 lds
  ds_read_b64_tr_b16 a[232:233], v9 offset:22528
  ds_read_b64_tr_b16 a[234:235], v9 offset:23552
  s_waitcnt lgkmcnt(6)
  v_mfma_f32_32x32x16_bf16 v[152:167], a[208:211], v[112:115], v[152:167]
  buffer_load_dwordx4 v14, s[16:19], s44 offen offset:2048 lds
  ds_read_b64_tr_b16 a[236:237], v10 offset:22528
  ds_read_b64_tr_b16 a[238:239], v10 offset:23552
  v_mfma_f32_32x32x16_bf16 v[168:183], a[212:215], v[112:115], v[168:183]
  buffer_load_dwordx4 v15, s[16:19], s44 offen offset:3072 lds
  ds_read_b64_tr_b16 a[208:209], v9 offset:24576
  ds_read_b64_tr_b16 a[210:211], v9 offset:25600
  v_mfma_f32_32x32x16_bf16 v[152:167], a[216:219], v[116:119], v[152:167]
  ds_read_b64_tr_b16 a[212:213], v10 offset:24576
  ds_read_b64_tr_b16 a[214:215], v10 offset:25600
  s_add_u32 m0, s50, 118784
  s_add_u32 s44, s80, s63
  v_mfma_f32_32x32x16_bf16 v[168:183], a[220:223], v[116:119], v[168:183]
  buffer_load_dwordx4 v12, s[20:23], s44 offen offset:0 lds
  ds_read_b64_tr_b16 a[216:217], v9 offset:26624
  ds_read_b64_tr_b16 a[218:219], v9 offset:27648
  s_waitcnt lgkmcnt(6)
  v_mfma_f32_32x32x16_bf16 v[152:167], a[224:227], v[120:123], v[152:167]
  ds_read_b64_tr_b16 a[220:221], v10 offset:26624
  ds_read_b64_tr_b16 a[222:223], v10 offset:27648
  s_add_u32 m0, s48, 122880
  s_add_u32 s44, s68, s63
  v_mfma_f32_32x32x16_bf16 v[168:183], a[228:231], v[120:123], v[168:183]
  ds_read_b64_tr_b16 a[224:225], v9 offset:28672
  ds_read_b64_tr_b16 a[226:227], v9 offset:29696
  v_mfma_f32_32x32x16_bf16 v[152:167], a[232:235], v[124:127], v[152:167]
  buffer_load_dwordx4 v12, s[16:19], s44 offen offset:0 lds
  ds_read_b64_tr_b16 a[228:229], v10 offset:28672
  ds_read_b64_tr_b16 a[230:231], v10 offset:29696
  v_mfma_f32_32x32x16_bf16 v[168:183], a[236:239], v[124:127], v[168:183]
  ds_read_b64_tr_b16 a[232:233], v9 offset:30720
  ds_read_b64_tr_b16 a[234:235], v9 offset:31744
  s_waitcnt lgkmcnt(6)
  v_mfma_f32_32x32x16_bf16 v[152:167], a[208:211], v[128:131], v[152:167]
  ds_read_b64_tr_b16 a[236:237], v10 offset:30720
  ds_read_b64_tr_b16 a[238:239], v10 offset:31744
  v_mfma_f32_32x32x16_bf16 v[168:183], a[212:215], v[128:131], v[168:183]
  buffer_load_dwordx4 v13, s[16:19], s44 offen offset:1024 lds
  ds_read_b64_tr_b16 a[208:209], v9 offset:32768
  ds_read_b64_tr_b16 a[210:211], v9 offset:33792
  v_mfma_f32_32x32x16_bf16 v[152:167], a[216:219], v[132:135], v[152:167]
  ds_read_b64_tr_b16 a[212:213], v10 offset:32768
  ds_read_b64_tr_b16 a[214:215], v10 offset:33792
  s_add_u32 s75, s92, 3
  s_waitcnt vmcnt(12)
  v_subrev_u32 v26, s75, v26
  v_cmp_eq_u32 s[52:53], s93, v27
  v_cmp_ge_u32 vcc, 12, v26
  s_nop 0
  s_and_b32 vcc_lo, vcc_lo, s52
  s_cmp_eq_u32 vcc_lo, 0x1
  s_cbranch_scc0 L_slow_h2
L_back_h2:
  v_mfma_f32_32x32x16_bf16 v[168:183], a[220:223], v[132:135], v[168:183]
  ds_read_b64_tr_b16 a[216:217], v9 offset:34816
  ds_read_b64_tr_b16 a[218:219], v9 offset:35840
  s_add_u32 s55, s57, 8192
  buffer_load_dwordx4 a[136:139], v21, s[28:31], s55 offen offset:0 sc1
  s_waitcnt lgkmcnt(6)
  v_mfma_f32_32x32x16_bf16 v[152:167], a[224:227], v[136:139], v[152:167]
  buffer_load_dwordx4 v14, s[16:19], s44 offen offset:2048 lds
  ds_read_b64_tr_b16 a[220:221], v10 offset:34816
  ds_read_b64_tr_b16 a[222:223], v10 offset:35840
  v_mfma_f32_32x32x16_bf16 v[168:183], a[228:231], v[136:139], v[168:183]
  buffer_store_dwordx4 v[64:67], v21, s[28:31], s51 offen offset:3072 sc1
  ds_read_b64_tr_b16 a[224:225], v9 offset:36864
  ds_read_b64_tr_b16 a[226:227], v9 offset:37888
  s_add_u32 s51, s56, 20480
  buffer_store_dwordx4 v[68:71], v21, s[28:31], s51 offen offset:0 sc1
  v_mfma_f32_32x32x16_bf16 v[152:167], a[232:235], v[140:143], v[152:167]
  ds_read_b64_tr_b16 a[228:229], v10 offset:36864
  ds_read_b64_tr_b16 a[230:231], v10 offset:37888
  v_mfma_f32_32x32x16_bf16 v[168:183], a[236:239], v[140:143], v[168:183]
  ds_read_b64_tr_b16 a[232:233], v9 offset:38912
  ds_read_b64_tr_b16 a[234:235], v9 offset:39936
  s_waitcnt lgkmcnt(6)
  v_mfma_f32_32x32x16_bf16 v[152:167], a[208:211], v[144:147], v[152:167]
  ds_read_b64_tr_b16 a[236:237], v10 offset:38912
  ds_read_b64_tr_b16 a[238:239], v10 offset:39936
  s_waitcnt vmcnt(11)
  s_barrier
  v_mfma_f32_32x32x16_bf16 v[168:183], a[212:215], v[144:147], v[168:183]
  buffer_load_dwordx4 a[140:143], v21, s[28:31], s55 offen offset:1024 sc1
  v_add_u32 v9, 0x13000, v9
  ds_read_b64_tr_b16 a[208:209], v9 offset:0
  ds_read_b64_tr_b16 a[210:211], v9 offset:1024
  v_mfma_f32_32x32x16_bf16 v[152:167], a[216:219], v[148:151], v[152:167]
  v_add_u32 v10, 0x13000, v10
  ds_read_b64_tr_b16 a[212:213], v10 offset:0
  ds_read_b64_tr_b16 a[214:215], v10 offset:1024
  v_mfma_f32_32x32x16_bf16 v[168:183], a[220:223], v[148:151], v[168:183]
  buffer_load_dwordx4 a[144:147], v21, s[28:31], s55 offen offset:2048 sc1
  ds_read_b64_tr_b16 a[216:217], v9 offset:2048
  ds_read_b64_tr_b16 a[218:219], v9 offset:3072
  s_waitcnt lgkmcnt(6)
  v_mfma_f32_32x32x16_bf16 v[152:167], a[224:227], v[60:63], v[152:167]
  ds_read_b64_tr_b16 a[220:221], v10 offset:2048
  ds_read_b64_tr_b16 a[222:223], v10 offset:3072
  v_mfma_f32_32x32x16_bf16 v[168:183], a[228:231], v[60:63], v[168:183]
  ds_read_b64_tr_b16 a[224:225], v9 offset:4096
  ds_read_b64_tr_b16 a[226:227], v9 offset:5120
  v_mfma_f32_32x32x16_bf16 v[152:167], a[232:235], v[64:67], v[152:167]
  buffer_load_dwordx4 v15, s[16:19], s44 offen offset:3072 lds
  ds_read_b64_tr_b16 a[228:229], v10 offset:4096
  ds_read_b64_tr_b16 a[230:231], v10 offset:5120
  v_mfma_f32_32x32x16_bf16 v[168:183], a[236:239], v[64:67], v[168:183]
  ds_read_b64_tr_b16 a[232:233], v9 offset:6144
  ds_read_b64_tr_b16 a[234:235], v9 offset:7168
  s_add_u32 m0, s48, 126976
  s_add_u32 s44, s44, 36864
  s_waitcnt lgkmcnt(6)
  v_mfma_f32_32x32x16_bf16 v[184:199], a[208:211], v[28:31], 0
  buffer_load_dwordx4 a[148:151], v21, s[28:31], s55 offen offset:3072 sc1
  ds_read_b64_tr_b16 a[236:237], v10 offset:6144
  ds_read_b64_tr_b16 a[238:239], v10 offset:7168
  v_mfma_f32_32x32x16_bf16 v[200:215], a[212:215], v[28:31], 0
  ds_read_b64_tr_b16 a[208:209], v9 offset:8192
  ds_read_b64_tr_b16 a[210:211], v9 offset:9216
  v_mfma_f32_32x32x16_bf16 v[184:199], a[216:219], v[32:35], v[184:199]
  buffer_load_dwordx4 v12, s[16:19], s44 offen offset:0 lds
  ds_read_b64_tr_b16 a[212:213], v10 offset:8192
  ds_read_b64_tr_b16 a[214:215], v10 offset:9216
  v_mfma_f32_32x32x16_bf16 v[200:215], a[220:223], v[32:35], v[200:215]
  ds_read_b64_tr_b16 a[216:217], v9 offset:10240
  ds_read_b64_tr_b16 a[218:219], v9 offset:11264
  s_add_u32 m0, s49, 143360
  s_add_u32 s44, s70, s63
  s_waitcnt lgkmcnt(6)
  v_mfma_f32_32x32x16_bf16 v[184:199], a[224:227], v[36:39], v[184:199]
  ds_read_b64_tr_b16 a[220:221], v10 offset:10240
  ds_read_b64_tr_b16 a[222:223], v10 offset:11264
  s_add_u32 s55, s57, 12288
  buffer_load_dwordx4 a[152:155], v21, s[28:31], s55 offen offset:0 sc1
  v_mfma_f32_32x32x16_bf16 v[200:215], a[228:231], v[36:39], v[200:215]
  ds_read_b64_tr_b16 a[224:225], v9 offset:12288
  ds_read_b64_tr_b16 a[226:227], v9 offset:13312
  v_mfma_f32_32x32x16_bf16 v[184:199], a[232:235], v[40:43], v[184:199]
  buffer_load_dwordx4 v12, s[16:19], s44 offen offset:0 lds
  ds_read_b64_tr_b16 a[228:229], v10 offset:12288
  ds_read_b64_tr_b16 a[230:231], v10 offset:13312
  v_mfma_f32_32x32x16_bf16 v[200:215], a[236:239], v[40:43], v[200:215]
  ds_read_b64_tr_b16 a[232:233], v9 offset:14336
  ds_read_b64_tr_b16 a[234:235], v9 offset:15360
  s_waitcnt lgkmcnt(6)
  v_mfma_f32_32x32x16_bf16 v[184:199], a[208:211], v[44:47], v[184:199]
  buffer_load_dwordx4 a[156:159], v21, s[28:31], s55 offen offset:1024 sc1
  ds_read_b64_tr_b16 a[236:237], v10 offset:14336
  ds_read_b64_tr_b16 a[238:239], v10 offset:15360
  v_mfma_f32_32x32x16_bf16 v[200:215], a[212:215], v[44:47], v[200:215]
  ds_read_b64_tr_b16 a[208:209], v9 offset:16384
  ds_read_b64_tr_b16 a[210:211], v9 offset:17408
  v_mfma_f32_32x32x16_bf16 v[184:199], a[216:219], v[48:51], v[184:199]
  buffer_load_dwordx4 v13, s[16:19], s44 offen offset:1024 lds
  ds_read_b64_tr_b16 a[212:213], v10 offset:16384
  ds_read_b64_tr_b16 a[214:215], v10 offset:17408
  v_mfma_f32_32x32x16_bf16 v[200:215], a[220:223], v[48:51], v[200:215]
  ds_read_b64_tr_b16 a[216:217], v9 offset:18432
  ds_read_b64_tr_b16 a[218:219], v9 offset:19456
  s_waitcnt lgkmcnt(6)
  v_mfma_f32_32x32x16_bf16 v[184:199], a[224:227], v[52:55], v[184:199]
  ds_read_b64_tr_b16 a[220:221], v10 offset:18432
  ds_read_b64_tr_b16 a[222:223], v10 offset:19456
  s_waitcnt vmcnt(15)
  s_barrier
  v_mfma_f32_32x32x16_bf16 v[200:215], a[228:231], v[52:55], v[200:215]
  buffer_load_dwordx4 a[160:163], v21, s[28:31], s55 offen offset:2048 sc1
  ds_read_b64_tr_b16 a[224:225], v9 offset:24576
  ds_read_b64_tr_b16 a[226:227], v9 offset:25600
  v_mfma_f32_32x32x16_bf16 v[184:199], a[232:235], v[56:59], v[184:199]
  ds_read_b64_tr_b16 a[228:229], v10 offset:24576
  ds_read_b64_tr_b16 a[230:231], v10 offset:25600
  v_mfma_f32_32x32x16_bf16 v[200:215], a[236:239], v[56:59], v[200:215]
  buffer_load_dwordx4 a[164:167], v21, s[28:31], s55 offen offset:3072 sc1
  ds_read_b64_tr_b16 a[232:233], v9 offset:26624
  ds_read_b64_tr_b16 a[234:235], v9 offset:27648
  s_waitcnt lgkmcnt(6)
  v_mfma_f32_32x32x16_bf16 v[184:199], a[208:211], v[112:115], v[184:199]
  ds_read_b64_tr_b16 a[236:237], v10 offset:26624
  ds_read_b64_tr_b16 a[238:239], v10 offset:27648
  v_mfma_f32_32x32x16_bf16 v[200:215], a[212:215], v[112:115], v[200:215]
  buffer_load_dwordx4 v14, s[16:19], s44 offen offset:2048 lds
  ds_read_b64_tr_b16 a[208:209], v9 offset:28672
  ds_read_b64_tr_b16 a[210:211], v9 offset:29696
  v_mfma_f32_32x32x16_bf16 v[184:199], a[216:219], v[116:119], v[184:199]
  ds_read_b64_tr_b16 a[212:213], v10 offset:28672
  ds_read_b64_tr_b16 a[214:215], v10 offset:29696
  v_mfma_f32_32x32x16_bf16 v[200:215], a[220:223], v[116:119], v[200:215]
  ds_read_b64_tr_b16 a[216:217], v9 offset:30720
  ds_read_b64_tr_b16 a[218:219], v9 offset:31744
  s_add_u32 s55, s57, 16384
  buffer_load_dwordx4 a[168:171], v21, s[28:31], s55 offen offset:0 sc1
  s_waitcnt lgkmcnt(6)
  v_mfma_f32_32x32x16_bf16 v[184:199], a[224:227], v[120:123], v[184:199]
  ds_read_b64_tr_b16 a[220:221], v10 offset:30720
  ds_read_b64_tr_b16 a[222:223], v10 offset:31744
  v_mfma_f32_32x32x16_bf16 v[200:215], a[228:231], v[120:123], v[200:215]
  ds_read_b64_tr_b16 a[224:225], v9 offset:32768
  ds_read_b64_tr_b16 a[226:227], v9 offset:33792
  s_waitcnt vmcnt(13)
  s_add_u32 s76, s92, 4
  v_mov_b32 v24, s76
  buffer_store_dwordx2 v[24:25], v4, s[28:31], s90 offen sc1
  v_mfma_f32_32x32x16_bf16 v[184:199], a[232:235], v[124:127], v[184:199]
  buffer_load_dwordx4 v15, s[16:19], s44 offen offset:3072 lds
  ds_read_b64_tr_b16 a[228:229], v10 offset:32768
  ds_read_b64_tr_b16 a[230:231], v10 offset:33792
  v_mfma_f32_32x32x16_bf16 v[200:215], a[236:239], v[124:127], v[200:215]
  buffer_load_dwordx4 a[172:175], v21, s[28:31], s55 offen offset:1024 sc1
  ds_read_b64_tr_b16 a[232:233], v9 offset:34816
  ds_read_b64_tr_b16 a[234:235], v9 offset:35840
  s_add_u32 m0, s83, 4096
  s_add_u32 s44, s82, s62
  s_waitcnt lgkmcnt(6)
  v_mfma_f32_32x32x16_bf16 v[184:199], a[208:211], v[128:131], v[184:199]
  ds_read_b64_tr_b16 a[236:237], v10 offset:34816
  ds_read_b64_tr_b16 a[238:239], v10 offset:35840
  v_mfma_f32_32x32x16_bf16 v[200:215], a[212:215], v[128:131], v[200:215]
  buffer_load_dwordx4 v12, s[20:23], s44 offen offset:0 lds
  ds_read_b64_tr_b16 a[208:209], v9 offset:36864
  ds_read_b64_tr_b16 a[210:211], v9 offset:37888
  v_mfma_f32_32x32x16_bf16 v[184:199], a[216:219], v[132:135], v[184:199]
  ds_read_b64_tr_b16 a[212:213], v10 offset:36864
  ds_read_b64_tr_b16 a[214:215], v10 offset:37888
  s_add_u32 m0, s50, 0
  s_add_u32 s44, s81, s62
  v_mfma_f32_32x32x16_bf16 v[200:215], a[220:223], v[132:135], v[200:215]
  ds_read_b64_tr_b16 a[216:217], v9 offset:38912
  ds_read_b64_tr_b16 a[218:219], v9 offset:39936
  s_waitcnt lgkmcnt(6)
  v_mfma_f32_32x32x16_bf16 v[184:199], a[224:227], v[136:139], v[184:199]
  buffer_load_dwordx4 v12, s[20:23], s44 offen offset:0 lds
  ds_read_b64_tr_b16 a[220:221], v10 offset:38912
  ds_read_b64_tr_b16 a[222:223], v10 offset:39936
  v_mfma_f32_32x32x16_bf16 v[200:215], a[228:231], v[136:139], v[200:215]
  ds_read_b64_tr_b16 a[224:225], v9 offset:40960
  ds_read_b64_tr_b16 a[226:227], v9 offset:41984
  s_add_u32 m0, s83, 10240
  s_add_u32 s44, s82, s63
  v_mfma_f32_32x32x16_bf16 v[184:199], a[232:235], v[140:143], v[184:199]
  ds_read_b64_tr_b16 a[228:229], v10 offset:40960
  ds_read_b64_tr_b16 a[230:231], v10 offset:41984
  v_mfma_f32_32x32x16_bf16 v[200:215], a[236:239], v[140:143], v[200:215]
  buffer_load_dwordx4 v12, s[20:23], s44 offen offset:0 lds
  ds_read_b64_tr_b16 a[232:233], v9 offset:43008
  ds_read_b64_tr_b16 a[234:235], v9 offset:44032
  s_waitcnt lgkmcnt(6)
  v_mfma_f32_32x32x16_bf16 v[184:199], a[208:211], v[144:147], v[184:199]
  ds_read_b64_tr_b16 a[236:237], v10 offset:43008
  ds_read_b64_tr_b16 a[238:239], v10 offset:44032
  s_add_u32 m0, s50, 6144
  s_add_u32 s44, s81, s63
  s_barrier
  v_mfma_f32_32x32x16_bf16 v[200:215], a[212:215], v[144:147], v[200:215]
  v_add_u32 v9, 0xffff7000, v9
  ds_read_b64_tr_b16 a[208:209], v9 offset:0
  ds_read_b64_tr_b16 a[210:211], v9 offset:1024
  v_mfma_f32_32x32x16_bf16 v[184:199], a[216:219], v[148:151], v[184:199]
  buffer_load_dwordx4 v12, s[20:23], s44 offen offset:0 lds
  v_add_u32 v10, 0xffff7000, v10
  ds_read_b64_tr_b16 a[212:213], v10 offset:0
  ds_read_b64_tr_b16 a[214:215], v10 offset:1024
  v_mfma_f32_32x32x16_bf16 v[200:215], a[220:223], v[148:151], v[200:215]
  ds_read_b64_tr_b16 a[216:217], v9 offset:2048
  ds_read_b64_tr_b16 a[218:219], v9 offset:3072
  s_add_u32 m0, s48, 12288
  s_add_u32 s44, s67, s64
  s_waitcnt lgkmcnt(6)
  v_mfma_f32_32x32x16_bf16 v[184:199], a[224:227], v[60:63], v[184:199]
  ds_read_b64_tr_b16 a[220:221], v10 offset:2048
  ds_read_b64_tr_b16 a[222:223], v10 offset:3072
  v_mfma_f32_32x32x16_bf16 v[200:215], a[228:231], v[60:63], v[200:215]
  buffer_load_dwordx4 v12, s[16:19], s44 offen offset:0 lds
  ds_read_b64_tr_b16 a[224:225], v9 offset:4096
  ds_read_b64_tr_b16 a[226:227], v9 offset:5120
  v_mfma_f32_32x32x16_bf16 v[184:199], a[232:235], v[64:67], v[184:199]
  ds_read_b64_tr_b16 a[228:229], v10 offset:4096
  ds_read_b64_tr_b16 a[230:231], v10 offset:5120
  v_mfma_f32_32x32x16_bf16 v[200:215], a[236:239], v[64:67], v[200:215]
  ds_read_b64_tr_b16 a[232:233], v9 offset:6144
  ds_read_b64_tr_b16 a[234:235], v9 offset:7168
  s_waitcnt lgkmcnt(6)
  v_mfma_f32_32x32x16_bf16 v[152:167], a[208:211], a[104:107], v[152:167]
  buffer_load_dwordx4 v13, s[16:19], s44 offen offset:1024 lds
  ds_read_b64_tr_b16 a[236:237], v10 offset:6144
  ds_read_b64_tr_b16 a[238:239], v10 offset:7168
  v_mfma_f32_32x32x16_bf16 v[168:183], a[212:215], a[104:107], v[168:183]
  ds_read_b64_tr_b16 a[208:209], v9 offset:8192
  ds_read_b64_tr_b16 a[210:211], v9 offset:9216
  v_mfma_f32_32x32x16_bf16 v[152:167], a[216:219], a[108:111], v[152:167]
  ds_read_b64_tr_b16 a[212:213], v10 offset:8192
  ds_read_b64_tr_b16 a[214:215], v10 offset:9216
  v_mfma_f32_32x32x16_bf16 v[168:183], a[220:223], a[108:111], v[168:183]
  buffer_load_dwordx4 v14, s[16:19], s44 offen offset:2048 lds
  ds_read_b64_tr_b16 a[216:217], v9 offset:10240
  ds_read_b64_tr_b16 a[218:219], v9 offset:11264
  s_waitcnt lgkmcnt(6)
  v_mfma_f32_32x32x16_bf16 v[152:167], a[224:227], a[112:115], v[152:167]
  ds_read_b64_tr_b16 a[220:221], v10 offset:10240
  ds_read_b64_tr_b16 a[222:223], v10 offset:11264
  v_mfma_f32_32x32x16_bf16 v[168:183], a[228:231], a[112:115], v[168:183]
  ds_read_b64_tr_b16 a[224:225], v9 offset:12288
  ds_read_b64_tr_b16 a[226:227], v9 offset:13312
  v_mfma_f32_32x32x16_bf16 v[152:167], a[232:235], a[116:119], v[152:167]
  buffer_load_dwordx4 v15, s[16:19], s44 offen offset:3072 lds
  ds_read_b64_tr_b16 a[228:229], v10 offset:12288
  ds_read_b64_tr_b16 a[230:231], v10 offset:13312
  v_mfma_f32_32x32x16_bf16 v[168:183], a[236:239], a[116:119], v[168:183]
  ds_read_b64_tr_b16 a[232:233], v9 offset:14336
  ds_read_b64_tr_b16 a[234:235], v9 offset:15360
  s_add_u32 m0, s48, 16384
  s_add_u32 s44, s44, 36864
  s_waitcnt lgkmcnt(6)
  v_mfma_f32_32x32x16_bf16 v[152:167], a[208:211], a[120:123], v[152:167]
  ds_read_b64_tr_b16 a[236:237], v10 offset:14336
  ds_read_b64_tr_b16 a[238:239], v10 offset:15360
  v_mfma_f32_32x32x16_bf16 v[168:183], a[212:215], a[120:123], v[168:183]
  buffer_load_dwordx4 v12, s[16:19], s44 offen offset:0 lds
  ds_read_b64_tr_b16 a[208:209], v9 offset:16384
  ds_read_b64_tr_b16 a[210:211], v9 offset:17408
  v_mfma_f32_32x32x16_bf16 v[152:167], a[216:219], a[124:127], v[152:167]
  ds_read_b64_tr_b16 a[212:213], v10 offset:16384
  ds_read_b64_tr_b16 a[214:215], v10 offset:17408
  s_add_u32 m0, s49, 77824
  s_add_u32 s44, s69, s64
  v_mfma_f32_32x32x16_bf16 v[168:183], a[220:223], a[124:127], v[168:183]
  ds_read_b64_tr_b16 a[216:217], v9 offset:18432
  ds_read_b64_tr_b16 a[218:219], v9 offset:19456
  s_waitcnt lgkmcnt(6)
  v_mfma_f32_32x32x16_bf16 v[152:167], a[224:227], a[128:131], v[152:167]
  buffer_load_dwordx4 v12, s[16:19], s44 offen offset:0 lds
  ds_read_b64_tr_b16 a[220:221], v10 offset:18432
  ds_read_b64_tr_b16 a[222:223], v10 offset:19456
  s_waitcnt vmcnt(21)
  s_barrier
  v_mfma_f32_32x32x16_bf16 v[168:183], a[228:231], a[128:131], v[168:183]
  v_add_u32 v9, 0x14000, v9
  ds_read_b64_tr_b16 a[224:225], v9 offset:0
  ds_read_b64_tr_b16 a[226:227], v9 offset:1024
  v_mfma_f32_32x32x16_bf16 v[152:167], a[232:235], a[132:135], v[152:167]
  v_add_u32 v10, 0x14000, v10
  ds_read_b64_tr_b16 a[228:229], v10 offset:0
  ds_read_b64_tr_b16 a[230:231], v10 offset:1024
  v_mfma_f32_32x32x16_bf16 v[168:183], a[236:239], a[132:135], v[168:183]
  buffer_load_dwordx4 v13, s[16:19], s44 offen offset:1024 lds
  ds_read_b64_tr_b16 a[232:233], v9 offset:2048
  ds_read_b64_tr_b16 a[234:235], v9 offset:3072
  s_waitcnt lgkmcnt(6)
  v_mfma_f32_32x32x16_bf16 v[152:167], a[208:211], a[136:139], v[152:167]
  ds_read_b64_tr_b16 a[236:237], v10 offset:2048
  ds_read_b64_tr_b16 a[238:239], v10 offset:3072
  v_mfma_f32_32x32x16_bf16 v[168:183], a[212:215], a[136:139], v[168:183]
  ds_read_b64_tr_b16 a[208:209], v9 offset:4096
  ds_read_b64_tr_b16 a[210:211], v9 offset:5120
  v_mfma_f32_32x32x16_bf16 v[152:167], a[216:219], a[140:143], v[152:167]
  buffer_load_dwordx4 v14, s[16:19], s44 offen offset:2048 lds
  ds_read_b64_tr_b16 a[212:213], v10 offset:4096
  ds_read_b64_tr_b16 a[214:215], v10 offset:5120
  v_mfma_f32_32x32x16_bf16 v[168:183], a[220:223], a[140:143], v[168:183]
  ds_read_b64_tr_b16 a[216:217], v9 offset:6144
  ds_read_b64_tr_b16 a[218:219], v9 offset:7168
  s_waitcnt lgkmcnt(6)
  v_mfma_f32_32x32x16_bf16 v[184:199], a[224:227], a[104:107], v[184:199]
  ds_read_b64_tr_b16 a[220:221], v10 offset:6144
  ds_read_b64_tr_b16 a[222:223], v10 offset:7168
  v_mfma_f32_32x32x16_bf16 v[200:215], a[228:231], a[104:107], v[200:215]
  buffer_load_dwordx4 v15, s[16:19], s44 offen offset:3072 lds
  ds_read_b64_tr_b16 a[224:225], v9 offset:8192
  ds_read_b64_tr_b16 a[226:227], v9 offset:9216
  v_mfma_f32_32x32x16_bf16 v[184:199], a[232:235], a[108:111], v[184:199]
  buffer_load_dwordx2 v[26:27], v5, s[28:31], 0 offen sc1
  ds_read_b64_tr_b16 a[228:229], v10 offset:8192
  ds_read_b64_tr_b16 a[230:231], v10 offset:9216
  s_add_u32 m0, s50, 94208
  s_add_u32 s44, s80, s64
  v_mfma_f32_32x32x16_bf16 v[200:215], a[236:239], a[108:111], v[200:215]
  ds_read_b64_tr_b16 a[232:233], v9 offset:10240
  ds_read_b64_tr_b16 a[234:235], v9 offset:11264
  s_waitcnt lgkmcnt(6)
  v_mfma_f32_32x32x16_bf16 v[184:199], a[208:211], a[112:115], v[184:199]
  buffer_load_dwordx4 v12, s[20:23], s44 offen offset:0 lds
  ds_read_b64_tr_b16 a[236:237], v10 offset:10240
  ds_read_b64_tr_b16 a[238:239], v10 offset:11264
  v_mfma_f32_32x32x16_bf16 v[200:215], a[212:215], a[112:115], v[200:215]
  ds_read_b64_tr_b16 a[208:209], v9 offset:12288
  ds_read_b64_tr_b16 a[210:211], v9 offset:13312
  s_add_u32 m0, s48, 98304
  s_add_u32 s44, s68, s64
  v_mfma_f32_32x32x16_bf16 v[184:199], a[216:219], a[116:119], v[184:199]
  ds_read_b64_tr_b16 a[212:213], v10 offset:12288
  ds_read_b64_tr_b16 a[214:215], v10 offset:13312
  v_mfma_f32_32x32x16_bf16 v[200:215], a[220:223], a[116:119], v[200:215]
  buffer_load_dwordx4 v12, s[16:19], s44 offen offset:0 lds
  ds_read_b64_tr_b16 a[216:217], v9 offset:14336
  ds_read_b64_tr_b16 a[218:219], v9 offset:15360
  s_waitcnt lgkmcnt(6)
  v_mfma_f32_32x32x16_bf16 v[184:199], a[224:227], a[120:123], v[184:199]
  ds_read_b64_tr_b16 a[220:221], v10 offset:14336
  ds_read_b64_tr_b16 a[222:223], v10 offset:15360
  v_mfma_f32_32x32x16_bf16 v[200:215], a[228:231], a[120:123], v[200:215]
  ds_read_b64_tr_b16 a[224:225], v9 offset:16384
  ds_read_b64_tr_b16 a[226:227], v9 offset:17408
  v_mfma_f32_32x32x16_bf16 v[184:199], a[232:235], a[124:127], v[184:199]
  buffer_load_dwordx4 v13, s[16:19], s44 offen offset:1024 lds
  ds_read_b64_tr_b16 a[228:229], v10 offset:16384
  ds_read_b64_tr_b16 a[230:231], v10 offset:17408
  v_mfma_f32_32x32x16_bf16 v[200:215], a[236:239], a[124:127], v[200:215]
  ds_read_b64_tr_b16 a[232:233], v9 offset:18432
  ds_read_b64_tr_b16 a[234:235], v9 offset:19456
  s_waitcnt lgkmcnt(6)
  v_mfma_f32_32x32x16_bf16 v[184:199], a[208:211], a[128:131], v[184:199]
  ds_read_b64_tr_b16 a[236:237], v10 offset:18432
  ds_read_b64_tr_b16 a[238:239], v10 offset:19456
  s_barrier
  v_mfma_f32_32x32x16_bf16 v[200:215], a[212:215], a[128:131], v[200:215]
  buffer_load_dwordx4 v14, s[16:19], s44 offen offset:2048 lds
  v_add_u32 v9, 0xffff1000, v9
  ds_read_b64_tr_b16 a[208:209], v9 offset:0
  ds_read_b64_tr_b16 a[210:211], v9 offset:1024
  v_mfma_f32_32x32x16_bf16 v[184:199], a[216:219], a[132:135], v[184:199]
  v_add_u32 v10, 0xffff1000, v10
  ds_read_b64_tr_b16 a[212:213], v10 offset:0
  ds_read_b64_tr_b16 a[214:215], v10 offset:1024
  v_mfma_f32_32x32x16_bf16 v[200:215], a[220:223], a[132:135], v[200:215]
  ds_read_b64_tr_b16 a[216:217], v9 offset:2048
  ds_read_b64_tr_b16 a[218:219], v9 offset:3072
  s_waitcnt lgkmcnt(6)
  v_mfma_f32_32x32x16_bf16 v[184:199], a[224:227], a[136:139], v[184:199]
  buffer_load_dwordx4 v15, s[16:19], s44 offen offset:3072 lds
  ds_read_b64_tr_b16 a[220:221], v10 offset:2048
  ds_read_b64_tr_b16 a[222:223], v10 offset:3072
  v_mfma_f32_32x32x16_bf16 v[200:215], a[228:231], a[136:139], v[200:215]
  ds_read_b64_tr_b16 a[224:225], v9 offset:4096
  ds_read_b64_tr_b16 a[226:227], v9 offset:5120
  s_add_u32 m0, s48, 102400
  s_add_u32 s44, s44, 36864
  v_mfma_f32_32x32x16_bf16 v[184:199], a[232:235], a[140:143], v[184:199]
  ds_read_b64_tr_b16 a[228:229], v10 offset:4096
  ds_read_b64_tr_b16 a[230:231], v10 offset:5120
  v_mfma_f32_32x32x16_bf16 v[200:215], a[236:239], a[140:143], v[200:215]
  buffer_load_dwordx4 v12, s[16:19], s44 offen offset:0 lds
  ds_read_b64_tr_b16 a[232:233], v9 offset:6144
  ds_read_b64_tr_b16 a[234:235], v9 offset:7168
  s_waitcnt lgkmcnt(6)
  v_mfma_f32_32x32x16_bf16 v[152:167], a[208:211], a[144:147], v[152:167]
  ds_read_b64_tr_b16 a[236:237], v10 offset:6144
  ds_read_b64_tr_b16 a[238:239], v10 offset:7168
  v_mfma_f32_32x32x16_bf16 v[168:183], a[212:215], a[144:147], v[168:183]
  ds_read_b64_tr_b16 a[208:209], v9 offset:8192
  ds_read_b64_tr_b16 a[210:211], v9 offset:9216
  v_mfma_f32_32x32x16_bf16 v[152:167], a[216:219], a[148:151], v[152:167]
  ds_read_b64_tr_b16 a[212:213], v10 offset:8192
  ds_read_b64_tr_b16 a[214:215], v10 offset:9216
  v_mfma_f32_32x32x16_bf16 v[168:183], a[220:223], a[148:151], v[168:183]
  ds_read_b64_tr_b16 a[216:217], v9 offset:10240
  ds_read_b64_tr_b16 a[218:219], v9 offset:11264
  s_waitcnt lgkmcnt(6)
  s_waitcnt vmcnt(30)
  v_mfma_f32_32x32x16_bf16 v[152:167], a[224:227], a[152:155], v[152:167]
  ds_read_b64_tr_b16 a[220:221], v10 offset:10240
  ds_read_b64_tr_b16 a[222:223], v10 offset:11264
  v_mfma_f32_32x32x16_bf16 v[168:183], a[228:231], a[152:155], v[168:183]
  ds_read_b64_tr_b16 a[224:225], v9 offset:12288
  ds_read_b64_tr_b16 a[226:227], v9 offset:13312
  s_waitcnt vmcnt(28)
  v_mfma_f32_32x32x16_bf16 v[152:167], a[232:235], a[156:159], v[152:167]
  ds_read_b64_tr_b16 a[228:229], v10 offset:12288
  ds_read_b64_tr_b16 a[230:231], v10 offset:13312
  s_add_u32 s75, s92, 4
  s_waitcnt vmcnt(6)
  v_subrev_u32 v26, s75, v26
  v_cmp_eq_u32 s[52:53], s93, v27
  v_cmp_ge_u32 vcc, 11, v26
  s_nop 0
  s_and_b32 vcc_lo, vcc_lo, s52
  s_cmp_eq_u32 vcc_lo, 0x1
  s_cbranch_scc0 L_slow_o
L_back_o:
  v_mfma_f32_32x32x16_bf16 v[168:183], a[236:239], a[156:159], v[168:183]
  ds_read_b64_tr_b16 a[232:233], v9 offset:14336
  ds_read_b64_tr_b16 a[234:235], v9 offset:15360
  s_add_u32 s55, s57, 16384
  buffer_load_dwordx4 a[176:179], v21, s[28:31], s55 offen offset:2048 sc1
  s_waitcnt lgkmcnt(6)
  v_mfma_f32_32x32x16_bf16 v[152:167], a[208:211], a[160:163], v[152:167]
  ds_read_b64_tr_b16 a[236:237], v10 offset:14336
L_pg8:
  s_cbranch_execz L_walked
  ds_read_b64_tr_b16 a[238:239], v10 offset:15360
  s_barrier
  v_mfma_f32_32x32x16_bf16 v[168:183], a[212:215], a[160:163], v[168:183]
  v_add_u32 v9, 0x14000, v9
  ds_read_b64_tr_b16 a[208:209], v9 offset:0
  ds_read_b64_tr_b16 a[210:211], v9 offset:1024
  s_add_u32 m0, s83, 139264
  s_add_u32 s44, s82, s64
  v_mfma_f32_32x32x16_bf16 v[152:167], a[216:219], a[164:167], v[152:167]
  buffer_load_dwordx4 a[180:183], v21, s[28:31], s55 offen offset:3072 sc1
  v_add_u32 v10, 0x14000, v10
  ds_read_b64_tr_b16 a[212:213], v10 offset:0
  ds_read_b64_tr_b16 a[214:215], v10 offset:1024
  v_mfma_f32_32x32x16_bf16 v[168:183], a[220:223], a[164:167], v[168:183]
  buffer_load_dwordx4 v12, s[20:23], s44 offen offset:0 lds
  ds_read_b64_tr_b16 a[216:217], v9 offset:2048
  ds_read_b64_tr_b16 a[218:219], v9 offset:3072
  s_waitcnt lgkmcnt(6)
  v_mfma_f32_32x32x16_bf16 v[152:167], a[224:227], a[168:171], v[152:167]
  ds_read_b64_tr_b16 a[220:221], v10 offset:2048
  ds_read_b64_tr_b16 a[222:223], v10 offset:3072
  v_accvgpr_read_b32 v16, a240
  v_accvgpr_read_b32 v17, a241
  v_accvgpr_read_b32 v18, a242
  v_mfma_f32_32x32x16_bf16 v[168:183], a[228:231], a[168:171], v[168:183]
  ds_read_b64_tr_b16 a[224:225], v9 offset:4096
  ds_read_b64_tr_b16 a[226:227], v9 offset:5120
  v_accvgpr_read_b32 v7, a245
  v_lshlrev_b32 v19, 26, v1
  v_and_b32 v19, 0x80000000, v19
  v_mfma_f32_32x32x16_bf16 v[152:167], a[232:235], a[172:175], v[152:167]
  ds_read_b64_tr_b16 a[228:229], v10 offset:4096
  ds_read_b64_tr_b16 a[230:231], v10 offset:5120
  v_or_b32 v19, v19, v18
  s_add_u32 s55, s57, 20480
  buffer_load_dwordx2 v[70:71], v21, s[28:31], s55 offen sc1
  v_mfma_f32_32x32x16_bf16 v[168:183], a[236:239], a[172:175], v[168:183]
  ds_read_b64_tr_b16 a[232:233], v9 offset:6144
  ds_read_b64_tr_b16 a[234:235], v9 offset:7168
  s_add_u32 m0, s49, 118784
  s_add_u32 s44, s70, s64
  s_waitcnt lgkmcnt(6)
  v_mfma_f32_32x32x16_bf16 v[184:199], a[208:211], a[144:147], v[184:199]
  buffer_load_dwordx4 v12, s[16:19], s44 offen offset:0 lds
  ds_read_b64_tr_b16 a[236:237], v10 offset:6144
  ds_read_b64_tr_b16 a[238:239], v10 offset:7168
  v_mfma_f32_32x32x16_bf16 v[200:215], a[212:215], a[144:147], v[200:215]
  ds_read_b64_tr_b16 a[208:209], v9 offset:8192
  ds_read_b64_tr_b16 a[210:211], v9 offset:9216
  v_mfma_f32_32x32x16_bf16 v[184:199], a[216:219], a[148:151], v[184:199]
  ds_read_b64_tr_b16 a[212:213], v10 offset:8192
  ds_read_b64_tr_b16 a[214:215], v10 offset:9216
  v_mfma_f32_32x32x16_bf16 v[200:215], a[220:223], a[148:151], v[200:215]
  buffer_load_dwordx4 v13, s[16:19], s44 offen offset:1024 lds
  ds_read_b64_tr_b16 a[216:217], v9 offset:10240
  ds_read_b64_tr_b16 a[218:219], v9 offset:11264
  s_waitcnt lgkmcnt(6)
  v_mfma_f32_32x32x16_bf16 v[184:199], a[224:227], a[152:155], v[184:199]
  ds_read_b64_tr_b16 a[220:221], v10 offset:10240
  ds_read_b64_tr_b16 a[222:223], v10 offset:11264
  v_mfma_f32_32x32x16_bf16 v[200:215], a[228:231], a[152:155], v[200:215]
  ds_read_b64_tr_b16 a[224:225], v9 offset:12288
  ds_read_b64_tr_b16 a[226:227], v9 offset:13312
  v_mfma_f32_32x32x16_bf16 v[184:199], a[232:235], a[156:159], v[184:199]
  buffer_load_dwordx4 v14, s[16:19], s44 offen offset:2048 lds
  ds_read_b64_tr_b16 a[228:229], v10 offset:12288
  ds_read_b64_tr_b16 a[230:231], v10 offset:13312
  v_mfma_f32_32x32x16_bf16 v[200:215], a[236:239], a[156:159], v[200:215]
  ds_read_b64_tr_b16 a[232:233], v9 offset:14336
  ds_read_b64_tr_b16 a[234:235], v9 offset:15360
  s_waitcnt lgkmcnt(6)
  v_mfma_f32_32x32x16_bf16 v[184:199], a[208:211], a[160:163], v[184:199]
  ds_read_b64_tr_b16 a[236:237], v10 offset:14336
  ds_read_b64_tr_b16 a[238:239], v10 offset:15360
  s_lshr_b32 s3, s2, 3
  s_lshl_b32 s3, s3, 2
  s_add_u32 s3, s3, s60
  s_lshl_b32 s3, s3, 9
  s_barrier
  v_mfma_f32_32x32x16_bf16 v[200:215], a[212:215], a[160:163], v[200:215]
  v_add_u32 v9, 0xfffdd000, v9
  ds_read_b64_tr_b16 a[208:209], v9 offset:0
  ds_read_b64_tr_b16 a[210:211], v9 offset:1024
  v_accvgpr_read_b32 v26, a246
  buffer_load_dword v26, v26, s[36:39], s3 offen
  v_mfma_f32_32x32x16_bf16 v[184:199], a[216:219], a[164:167], v[184:199]
  buffer_load_dwordx4 v15, s[16:19], s44 offen offset:3072 lds
  v_add_u32 v10, 0xfffdd000, v10
  ds_read_b64_tr_b16 a[212:213], v10 offset:0
  ds_read_b64_tr_b16 a[214:215], v10 offset:1024
  v_mfma_f32_32x32x16_bf16 v[200:215], a[220:223], a[164:167], v[200:215]
  ds_read_b64_tr_b16 a[216:217], v9 offset:2048
  ds_read_b64_tr_b16 a[218:219], v9 offset:3072
  s_add_u32 m0, s50, 135168
  s_add_u32 s44, s81, s64
  s_waitcnt lgkmcnt(6)
  v_mfma_f32_32x32x16_bf16 v[184:199], a[224:227], a[168:171], v[184:199]
  ds_read_b64_tr_b16 a[220:221], v10 offset:2048
  ds_read_b64_tr_b16 a[222:223], v10 offset:3072
  v_mfma_f32_32x32x16_bf16 v[200:215], a[228:231], a[168:171], v[200:215]
  buffer_load_dwordx4 v12, s[20:23], s44 offen offset:0 lds
  ds_read_b64_tr_b16 a[224:225], v9 offset:4096
  ds_read_b64_tr_b16 a[226:227], v9 offset:5120
  v_mfma_f32_32x32x16_bf16 v[184:199], a[232:235], a[172:175], v[184:199]
  ds_read_b64_tr_b16 a[228:229], v10 offset:4096
  ds_read_b64_tr_b16 a[230:231], v10 offset:5120
  v_mfma_f32_32x32x16_bf16 v[200:215], a[236:239], a[172:175], v[200:215]
  ds_read_b64_tr_b16 a[232:233], v9 offset:6144
  ds_read_b64_tr_b16 a[234:235], v9 offset:7168
  s_waitcnt lgkmcnt(6)
  s_waitcnt vmcnt(9)
  v_mfma_f32_32x32x16_bf16 v[152:167], a[208:211], a[176:179], v[152:167]
  ds_read_b64_tr_b16 a[236:237], v10 offset:6144
  ds_read_b64_tr_b16 a[238:239], v10 offset:7168
  v_mfma_f32_32x32x16_bf16 v[168:183], a[212:215], a[176:179], v[168:183]
  ds_read_b64_tr_b16 a[208:209], v9 offset:8192
  ds_read_b64_tr_b16 a[210:211], v9 offset:9216
  s_waitcnt vmcnt(8)
  v_mfma_f32_32x32x16_bf16 v[152:167], a[216:219], a[180:183], v[152:167]
  ds_read_b64_tr_b16 a[212:213], v10 offset:8192
  ds_read_b64_tr_b16 a[214:215], v10 offset:9216
  v_mfma_f32_32x32x16_bf16 v[168:183], a[220:223], a[180:183], v[168:183]
  ds_read_b64_tr_b16 a[216:217], v9 offset:10240
  ds_read_b64_tr_b16 a[218:219], v9 offset:11264
  s_waitcnt lgkmcnt(6)
  s_waitcnt vmcnt(6)
  v_mfma_f32_32x32x16_bf16 v[152:167], a[224:227], v[68:71], v[152:167]
  ds_read_b64_tr_b16 a[220:221], v10 offset:10240
  ds_read_b64_tr_b16 a[222:223], v10 offset:11264
  s_barrier
  v_mfma_f32_32x32x16_bf16 v[168:183], a[228:231], v[68:71], v[168:183]
  ds_read_b64_tr_b16 a[224:225], v9 offset:12288
  ds_read_b64_tr_b16 a[226:227], v9 offset:13312
  s_add_u32 m0, s48, 141312
  s_add_u32 s44, s67, s65
  v_mfma_f32_32x32x16_bf16 v[184:199], a[232:235], a[176:179], v[184:199]
  buffer_load_dwordx4 v12, s[16:19], s44 offen offset:0 lds
  ds_read_b64_tr_b16 a[228:229], v10 offset:12288
  ds_read_b64_tr_b16 a[230:231], v10 offset:13312
  v_mfma_f32_32x32x16_bf16 v[200:215], a[236:239], a[176:179], v[200:215]
  ds_read_b64_tr_b16 a[232:233], v9 offset:14336
  ds_read_b64_tr_b16 a[234:235], v9 offset:15360
  s_waitcnt lgkmcnt(6)
  v_mfma_f32_32x32x16_bf16 v[184:199], a[208:211], a[180:183], v[184:199]
  ds_read_b64_tr_b16 a[236:237], v10 offset:14336
  ds_read_b64_tr_b16 a[238:239], v10 offset:15360
  v_mfma_f32_32x32x16_bf16 v[200:215], a[212:215], a[180:183], v[200:215]
  ds_read_b64_tr_b16 a[208:209], v9 offset:16384
  ds_read_b64_tr_b16 a[210:211], v9 offset:17408
  s_add_u32 s54, s91, 0
  v_cvt_pk_bf16_f32 v76, v152, v153
  v_cvt_pk_bf16_f32 v77, v154, v155
  v_mfma_f32_32x32x16_bf16 v[184:199], a[216:219], v[68:71], v[184:199]
  ds_read_b64_tr_b16 a[212:213], v10 offset:16384
  ds_read_b64_tr_b16 a[214:215], v10 offset:17408
  v_cvt_pk_bf16_f32 v78, v156, v157
  v_cvt_pk_bf16_f32 v79, v158, v159
  buffer_store_dwordx4 v[76:79], v16, s[28:31], s54 offen offset:0 sc1
  v_mfma_f32_32x32x16_bf16 v[200:215], a[220:223], v[68:71], v[200:215]
  ds_read_b64_tr_b16 a[216:217], v9 offset:18432
  ds_read_b64_tr_b16 a[218:219], v9 offset:19456
  v_cvt_pk_bf16_f32 v80, v160, v161
  v_cvt_pk_bf16_f32 v81, v162, v163
  v_cvt_pk_bf16_f32 v82, v164, v165
  s_waitcnt lgkmcnt(6)
  v_mfma_f32_32x32x16_bf16 v[216:231], a[224:227], v[28:31], 0
  ds_read_b64_tr_b16 a[220:221], v10 offset:18432
  ds_read_b64_tr_b16 a[222:223], v10 offset:19456
  v_cvt_pk_bf16_f32 v83, v166, v167
  buffer_store_dwordx4 v[80:83], v16, s[28:31], s54 offen offset:128 sc1
  v_cvt_pk_bf16_f32 v84, v168, v169
  v_mfma_f32_32x32x16_bf16 v[232:247], a[228:231], v[28:31], 0
  ds_read_b64_tr_b16 a[224:225], v9 offset:20480
  ds_read_b64_tr_b16 a[226:227], v9 offset:21504
  v_cvt_pk_bf16_f32 v85, v170, v171
  v_cvt_pk_bf16_f32 v86, v172, v173
  v_cvt_pk_bf16_f32 v87, v174, v175
  v_mfma_f32_32x32x16_bf16 v[216:231], a[232:235], v[32:35], v[216:231]
  buffer_store_dwordx4 v[84:87], v16, s[28:31], s54 offen offset:256 sc1
  ds_read_b64_tr_b16 a[228:229], v10 offset:20480
  ds_read_b64_tr_b16 a[230:231], v10 offset:21504
  v_cvt_pk_bf16_f32 v88, v176, v177
  v_cvt_pk_bf16_f32 v89, v178, v179
  v_mfma_f32_32x32x16_bf16 v[232:247], a[236:239], v[32:35], v[232:247]
  buffer_load_dwordx4 v13, s[16:19], s44 offen offset:1024 lds
  ds_read_b64_tr_b16 a[232:233], v9 offset:22528
  ds_read_b64_tr_b16 a[234:235], v9 offset:23552
  v_cvt_pk_bf16_f32 v90, v180, v181
  v_cvt_pk_bf16_f32 v91, v182, v183
  s_waitcnt lgkmcnt(6)
  v_mfma_f32_32x32x16_bf16 v[216:231], a[208:211], v[36:39], v[216:231]
  ds_read_b64_tr_b16 a[236:237], v10 offset:22528
  ds_read_b64_tr_b16 a[238:239], v10 offset:23552
  v_mfma_f32_32x32x16_bf16 v[232:247], a[212:215], v[36:39], v[232:247]
  ds_read_b64_tr_b16 a[208:209], v9 offset:24576
  ds_read_b64_tr_b16 a[210:211], v9 offset:25600
  v_mfma_f32_32x32x16_bf16 v[216:231], a[216:219], v[40:43], v[216:231]
  buffer_store_dwordx4 v[88:91], v16, s[28:31], s54 offen offset:384 sc1
  ds_read_b64_tr_b16 a[212:213], v10 offset:24576
  ds_read_b64_tr_b16 a[214:215], v10 offset:25600
  s_add_u32 s54, s91, 131072
  v_cvt_pk_bf16_f32 v76, v184, v185
  v_mfma_f32_32x32x16_bf16 v[232:247], a[220:223], v[40:43], v[232:247]
  ds_read_b64_tr_b16 a[216:217], v9 offset:26624
  ds_read_b64_tr_b16 a[218:219], v9 offset:27648
  v_cvt_pk_bf16_f32 v77, v186, v187
  v_cvt_pk_bf16_f32 v78, v188, v189
  v_cvt_pk_bf16_f32 v79, v190, v191
  s_waitcnt lgkmcnt(6)
  v_mfma_f32_32x32x16_bf16 v[216:231], a[224:227], v[44:47], v[216:231]
  buffer_store_dwordx4 v[76:79], v16, s[28:31], s54 offen offset:0 sc1
  ds_read_b64_tr_b16 a[220:221], v10 offset:26624
  ds_read_b64_tr_b16 a[222:223], v10 offset:27648
  v_cvt_pk_bf16_f32 v80, v192, v193
  v_cvt_pk_bf16_f32 v81, v194, v195
  v_mfma_f32_32x32x16_bf16 v[232:247], a[228:231], v[44:47], v[232:247]
  buffer_load_dwordx4 v14, s[16:19], s44 offen offset:2048 lds
  ds_read_b64_tr_b16 a[224:225], v9 offset:28672
  ds_read_b64_tr_b16 a[226:227], v9 offset:29696
  v_cvt_pk_bf16_f32 v82, v196, v197
  v_cvt_pk_bf16_f32 v83, v198, v199
  v_mfma_f32_32x32x16_bf16 v[216:231], a[232:235], v[48:51], v[216:231]
  ds_read_b64_tr_b16 a[228:229], v10 offset:28672
  ds_read_b64_tr_b16 a[230:231], v10 offset:29696
  v_mfma_f32_32x32x16_bf16 v[232:247], a[236:239], v[48:51], v[232:247]
  ds_read_b64_tr_b16 a[232:233], v9 offset:30720
  ds_read_b64_tr_b16 a[234:235], v9 offset:31744
  s_waitcnt lgkmcnt(6)
  v_mfma_f32_32x32x16_bf16 v[216:231], a[208:211], v[52:55], v[216:231]
  buffer_store_dwordx4 v[80:83], v16, s[28:31], s54 offen offset:128 sc1
  ds_read_b64_tr_b16 a[236:237], v10 offset:30720
  ds_read_b64_tr_b16 a[238:239], v10 offset:31744
  v_cvt_pk_bf16_f32 v84, v200, v201
  v_cvt_pk_bf16_f32 v85, v202, v203
  s_barrier
  v_mfma_f32_32x32x16_bf16 v[232:247], a[212:215], v[52:55], v[232:247]
  v_add_u32 v9, 0x13000, v9
  ds_read_b64_tr_b16 a[208:209], v9 offset:0
  ds_read_b64_tr_b16 a[210:211], v9 offset:1024
  v_cvt_pk_bf16_f32 v86, v204, v205
  v_cvt_pk_bf16_f32 v87, v206, v207
  v_mfma_f32_32x32x16_bf16 v[216:231], a[216:219], v[56:59], v[216:231]
  buffer_load_dwordx4 v15, s[16:19], s44 offen offset:3072 lds
  v_add_u32 v10, 0x13000, v10
  ds_read_b64_tr_b16 a[212:213], v10 offset:0
  ds_read_b64_tr_b16 a[214:215], v10 offset:1024
  v_mfma_f32_32x32x16_bf16 v[232:247], a[220:223], v[56:59], v[232:247]
  ds_read_b64_tr_b16 a[216:217], v9 offset:2048
  ds_read_b64_tr_b16 a[218:219], v9 offset:3072
  s_add_u32 m0, s48, 145408
  s_add_u32 s44, s44, 36864
  s_waitcnt lgkmcnt(6)
  v_mfma_f32_32x32x16_bf16 v[216:231], a[224:227], v[112:115], v[216:231]
  ds_read_b64_tr_b16 a[220:221], v10 offset:2048
  ds_read_b64_tr_b16 a[222:223], v10 offset:3072
  v_mfma_f32_32x32x16_bf16 v[232:247], a[228:231], v[112:115], v[232:247]
  buffer_store_dwordx4 v[84:87], v16, s[28:31], s54 offen offset:256 sc1
  ds_read_b64_tr_b16 a[224:225], v9 offset:4096
  ds_read_b64_tr_b16 a[226:227], v9 offset:5120
  v_cvt_pk_bf16_f32 v88, v208, v209
  v_cvt_pk_bf16_f32 v89, v210, v211
  v_mfma_f32_32x32x16_bf16 v[216:231], a[232:235], v[116:119], v[216:231]
  buffer_load_dwordx4 v12, s[16:19], s44 offen offset:0 lds
  ds_read_b64_tr_b16 a[228:229], v10 offset:4096
  ds_read_b64_tr_b16 a[230:231], v10 offset:5120
  v_cvt_pk_bf16_f32 v90, v212, v213
  v_cvt_pk_bf16_f32 v91, v214, v215
  v_mfma_f32_32x32x16_bf16 v[232:247], a[236:239], v[116:119], v[232:247]
  ds_read_b64_tr_b16 a[232:233], v9 offset:6144
  ds_read_b64_tr_b16 a[234:235], v9 offset:7168
  s_waitcnt lgkmcnt(6)
  v_mfma_f32_32x32x16_bf16 v[216:231], a[208:211], v[120:123], v[216:231]
  ds_read_b64_tr_b16 a[236:237], v10 offset:6144
  ds_read_b64_tr_b16 a[238:239], v10 offset:7168
  v_mfma_f32_32x32x16_bf16 v[232:247], a[212:215], v[120:123], v[232:247]
  buffer_store_dwordx4 v[88:91], v16, s[28:31], s54 offen offset:384 sc1
  ds_read_b64_tr_b16 a[208:209], v9 offset:8192
  ds_read_b64_tr_b16 a[210:211], v9 offset:9216
  v_mfma_f32_32x32x16_bf16 v[216:231], a[216:219], v[124:127], v[216:231]
  ds_read_b64_tr_b16 a[212:213], v10 offset:8192
  ds_read_b64_tr_b16 a[214:215], v10 offset:9216
  v_mfma_f32_32x32x16_bf16 v[232:247], a[220:223], v[124:127], v[232:247]
  ds_read_b64_tr_b16 a[216:217], v9 offset:10240
  ds_read_b64_tr_b16 a[218:219], v9 offset:11264
  s_waitcnt lgkmcnt(6)
  v_mfma_f32_32x32x16_bf16 v[216:231], a[224:227], v[128:131], v[216:231]
  ds_read_b64_tr_b16 a[220:221], v10 offset:10240
  ds_read_b64_tr_b16 a[222:223], v10 offset:11264
  v_mfma_f32_32x32x16_bf16 v[232:247], a[228:231], v[128:131], v[232:247]
  ds_read_b64_tr_b16 a[224:225], v9 offset:12288
  ds_read_b64_tr_b16 a[226:227], v9 offset:13312
  v_mfma_f32_32x32x16_bf16 v[216:231], a[232:235], v[132:135], v[216:231]
  ds_read_b64_tr_b16 a[228:229], v10 offset:12288
  ds_read_b64_tr_b16 a[230:231], v10 offset:13312
  v_mfma_f32_32x32x16_bf16 v[232:247], a[236:239], v[132:135], v[232:247]
  ds_read_b64_tr_b16 a[232:233], v9 offset:14336
  ds_read_b64_tr_b16 a[234:235], v9 offset:15360
  s_waitcnt lgkmcnt(6)
  v_mfma_f32_32x32x16_bf16 v[216:231], a[208:211], v[136:139], v[216:231]
  ds_read_b64_tr_b16 a[236:237], v10 offset:14336
  ds_read_b64_tr_b16 a[238:239], v10 offset:15360
  v_mfma_f32_32x32x16_bf16 v[232:247], a[212:215], v[136:139], v[232:247]
  ds_read_b64_tr_b16 a[208:209], v9 offset:16384
  ds_read_b64_tr_b16 a[210:211], v9 offset:17408
  v_mfma_f32_32x32x16_bf16 v[216:231], a[216:219], v[140:143], v[216:231]
  ds_read_b64_tr_b16 a[212:213], v10 offset:16384
  ds_read_b64_tr_b16 a[214:215], v10 offset:17408
  v_mfma_f32_32x32x16_bf16 v[232:247], a[220:223], v[140:143], v[232:247]
  ds_read_b64_tr_b16 a[216:217], v9 offset:18432
  ds_read_b64_tr_b16 a[218:219], v9 offset:19456
  s_waitcnt lgkmcnt(6)
  v_mfma_f32_32x32x16_bf16 v[216:231], a[224:227], v[144:147], v[216:231]
  ds_read_b64_tr_b16 a[220:221], v10 offset:18432
  ds_read_b64_tr_b16 a[222:223], v10 offset:19456
  s_barrier
  v_mfma_f32_32x32x16_bf16 v[232:247], a[228:231], v[144:147], v[232:247]
  ds_read_b64_tr_b16 a[224:225], v9 offset:20480
  ds_read_b64_tr_b16 a[226:227], v9 offset:21504
  s_add_u32 m0, s49, 0
  s_add_u32 s44, s69, s65
  v_mfma_f32_32x32x16_bf16 v[216:231], a[232:235], v[148:151], v[216:231]
  buffer_load_dwordx4 v12, s[16:19], s44 offen offset:0 lds
  ds_read_b64_tr_b16 a[228:229], v10 offset:20480
  ds_read_b64_tr_b16 a[230:231], v10 offset:21504
  v_mfma_f32_32x32x16_bf16 v[232:247], a[236:239], v[148:151], v[232:247]
  ds_read_b64_tr_b16 a[232:233], v9 offset:22528
  ds_read_b64_tr_b16 a[234:235], v9 offset:23552
  s_waitcnt lgkmcnt(6)
  v_mfma_f32_32x32x16_bf16 v[216:231], a[208:211], v[60:63], v[216:231]
  ds_read_b64_tr_b16 a[236:237], v10 offset:22528
  ds_read_b64_tr_b16 a[238:239], v10 offset:23552
  v_mfma_f32_32x32x16_bf16 v[232:247], a[212:215], v[60:63], v[232:247]
  buffer_load_dwordx4 v13, s[16:19], s44 offen offset:1024 lds
  ds_read_b64_tr_b16 a[208:209], v9 offset:24576
  ds_read_b64_tr_b16 a[210:211], v9 offset:25600
  v_mfma_f32_32x32x16_bf16 v[216:231], a[216:219], v[64:67], v[216:231]
  ds_read_b64_tr_b16 a[212:213], v10 offset:24576
  ds_read_b64_tr_b16 a[214:215], v10 offset:25600
  v_mfma_f32_32x32x16_bf16 v[232:247], a[220:223], v[64:67], v[232:247]
  ds_read_b64_tr_b16 a[216:217], v9 offset:26624
  ds_read_b64_tr_b16 a[218:219], v9 offset:27648
  s_waitcnt lgkmcnt(6)
  v_mfma_f32_32x32x16_bf16 v[216:231], a[224:227], a[104:107], v[216:231]
  buffer_load_dwordx4 v14, s[16:19], s44 offen offset:2048 lds
  ds_read_b64_tr_b16 a[220:221], v10 offset:26624
  ds_read_b64_tr_b16 a[222:223], v10 offset:27648
  v_mfma_f32_32x32x16_bf16 v[232:247], a[228:231], a[104:107], v[232:247]
  ds_read_b64_tr_b16 a[224:225], v9 offset:28672
  ds_read_b64_tr_b16 a[226:227], v9 offset:29696
  v_mfma_f32_32x32x16_bf16 v[216:231], a[232:235], a[108:111], v[216:231]
  ds_read_b64_tr_b16 a[228:229], v10 offset:28672
  ds_read_b64_tr_b16 a[230:231], v10 offset:29696
  v_mfma_f32_32x32x16_bf16 v[232:247], a[236:239], a[108:111], v[232:247]
  buffer_load_dwordx4 v15, s[16:19], s44 offen offset:3072 lds
  ds_read_b64_tr_b16 a[232:233], v9 offset:30720
  ds_read_b64_tr_b16 a[234:235], v9 offset:31744
  s_waitcnt lgkmcnt(6)
  v_mfma_f32_32x32x16_bf16 v[216:231], a[208:211], a[112:115], v[216:231]
  ds_read_b64_tr_b16 a[236:237], v10 offset:30720
  ds_read_b64_tr_b16 a[238:239], v10 offset:31744
  s_add_u32 m0, s50, 16384
  s_add_u32 s44, s80, s65
  v_mfma_f32_32x32x16_bf16 v[232:247], a[212:215], a[112:115], v[232:247]
  ds_read_b64_tr_b16 a[208:209], v9 offset:32768
  ds_read_b64_tr_b16 a[210:211], v9 offset:33792
  v_mfma_f32_32x32x16_bf16 v[216:231], a[216:219], a[116:119], v[216:231]
  buffer_load_dwordx4 v12, s[20:23], s44 offen offset:0 lds
  ds_read_b64_tr_b16 a[212:213], v10 offset:32768
  ds_read_b64_tr_b16 a[214:215], v10 offset:33792
  v_mfma_f32_32x32x16_bf16 v[232:247], a[220:223], a[116:119], v[232:247]
  ds_read_b64_tr_b16 a[216:217], v9 offset:34816
  ds_read_b64_tr_b16 a[218:219], v9 offset:35840
  s_add_u32 m0, s48, 20480
  s_add_u32 s44, s68, s65
  s_waitcnt lgkmcnt(6)
  v_mfma_f32_32x32x16_bf16 v[216:231], a[224:227], a[120:123], v[216:231]
  ds_read_b64_tr_b16 a[220:221], v10 offset:34816
  ds_read_b64_tr_b16 a[222:223], v10 offset:35840
  v_mfma_f32_32x32x16_bf16 v[232:247], a[228:231], a[120:123], v[232:247]
  buffer_load_dwordx4 v12, s[16:19], s44 offen offset:0 lds
  ds_read_b64_tr_b16 a[224:225], v9 offset:36864
  ds_read_b64_tr_b16 a[226:227], v9 offset:37888
  v_mfma_f32_32x32x16_bf16 v[216:231], a[232:235], a[124:127], v[216:231]
  ds_read_b64_tr_b16 a[228:229], v10 offset:36864
  ds_read_b64_tr_b16 a[230:231], v10 offset:37888
  v_mfma_f32_32x32x16_bf16 v[232:247], a[236:239], a[124:127], v[232:247]
  ds_read_b64_tr_b16 a[232:233], v9 offset:38912
  ds_read_b64_tr_b16 a[234:235], v9 offset:39936
  s_waitcnt lgkmcnt(6)
  v_mfma_f32_32x32x16_bf16 v[216:231], a[208:211], a[128:131], v[216:231]
  buffer_load_dwordx4 v13, s[16:19], s44 offen offset:1024 lds
  ds_read_b64_tr_b16 a[236:237], v10 offset:38912
  ds_read_b64_tr_b16 a[238:239], v10 offset:39936
  s_waitcnt vmcnt(20)
  s_barrier
  v_mfma_f32_32x32x16_bf16 v[232:247], a[212:215], a[128:131], v[232:247]
  ds_read_b64_tr_b16 a[208:209], v9 offset:40960
  ds_read_b64_tr_b16 a[210:211], v9 offset:41984
  v_mfma_f32_32x32x16_bf16 v[216:231], a[216:219], a[132:135], v[216:231]
  ds_read_b64_tr_b16 a[212:213], v10 offset:40960
  ds_read_b64_tr_b16 a[214:215], v10 offset:41984
  v_mfma_f32_32x32x16_bf16 v[232:247], a[220:223], a[132:135], v[232:247]
  buffer_load_dwordx4 v14, s[16:19], s44 offen offset:2048 lds
  ds_read_b64_tr_b16 a[216:217], v9 offset:43008
  ds_read_b64_tr_b16 a[218:219], v9 offset:44032
  s_waitcnt lgkmcnt(6)
  v_mfma_f32_32x32x16_bf16 v[216:231], a[224:227], a[136:139], v[216:231]
  ds_read_b64_tr_b16 a[220:221], v10 offset:43008
  ds_read_b64_tr_b16 a[222:223], v10 offset:44032
  v_mfma_f32_32x32x16_bf16 v[232:247], a[228:231], a[136:139], v[232:247]
  ds_read_b64_tr_b16 a[224:225], v9 offset:45056
  ds_read_b64_tr_b16 a[226:227], v9 offset:46080
  v_mfma_f32_32x32x16_bf16 v[216:231], a[232:235], a[140:143], v[216:231]
  buffer_load_dwordx4 v15, s[16:19], s44 offen offset:3072 lds
  ds_read_b64_tr_b16 a[228:229], v10 offset:45056
  ds_read_b64_tr_b16 a[230:231], v10 offset:46080
  v_mfma_f32_32x32x16_bf16 v[232:247], a[236:239], a[140:143], v[232:247]
  ds_read_b64_tr_b16 a[232:233], v9 offset:47104
  ds_read_b64_tr_b16 a[234:235], v9 offset:48128
  s_add_u32 m0, s48, 24576
  s_add_u32 s44, s44, 36864
  s_waitcnt lgkmcnt(6)
  v_mfma_f32_32x32x16_bf16 v[216:231], a[208:211], a[144:147], v[216:231]
  ds_read_b64_tr_b16 a[236:237], v10 offset:47104
  ds_read_b64_tr_b16 a[238:239], v10 offset:48128
  v_mfma_f32_32x32x16_bf16 v[232:247], a[212:215], a[144:147], v[232:247]
  buffer_load_dwordx4 v12, s[16:19], s44 offen offset:0 lds
  ds_read_b64_tr_b16 a[208:209], v9 offset:49152
  ds_read_b64_tr_b16 a[210:211], v9 offset:50176
  v_mfma_f32_32x32x16_bf16 v[216:231], a[216:219], a[148:151], v[216:231]
  ds_read_b64_tr_b16 a[212:213], v10 offset:49152
  ds_read_b64_tr_b16 a[214:215], v10 offset:50176
  s_add_u32 m0, s83, 61440
  s_add_u32 s44, s82, s65
  v_mfma_f32_32x32x16_bf16 v[232:247], a[220:223], a[148:151], v[232:247]
  ds_read_b64_tr_b16 a[216:217], v9 offset:51200
  ds_read_b64_tr_b16 a[218:219], v9 offset:52224
  s_waitcnt lgkmcnt(6)
  v_mfma_f32_32x32x16_bf16 v[216:231], a[224:227], a[152:155], v[216:231]
  buffer_load_dwordx2 v[96:97], v18, s[4:7], s62 offen
  ds_read_b64_tr_b16 a[220:221], v10 offset:51200
  ds_read_b64_tr_b16 a[222:223], v10 offset:52224
  v_mfma_f32_32x32x16_bf16 v[232:247], a[228:231], a[152:155], v[232:247]
  buffer_load_dwordx4 v12, s[20:23], s44 offen offset:0 lds
  ds_read_b64_tr_b16 a[224:225], v9 offset:53248
  ds_read_b64_tr_b16 a[226:227], v9 offset:54272
  v_mfma_f32_32x32x16_bf16 v[216:231], a[232:235], a[156:159], v[216:231]
  ds_read_b64_tr_b16 a[228:229], v10 offset:53248
  ds_read_b64_tr_b16 a[230:231], v10 offset:54272
  s_add_u32 m0, s49, 40960
  s_add_u32 s44, s70, s65
  v_mfma_f32_32x32x16_bf16 v[232:247], a[236:239], a[156:159], v[232:247]
  ds_read_b64_tr_b16 a[232:233], v9 offset:55296
  ds_read_b64_tr_b16 a[234:235], v9 offset:56320
  s_waitcnt lgkmcnt(6)
  v_mfma_f32_32x32x16_bf16 v[216:231], a[208:211], a[160:163], v[216:231]
  buffer_load_dwordx2 v[104:105], v18, s[4:7], s63 offen
  ds_read_b64_tr_b16 a[236:237], v10 offset:55296
  ds_read_b64_tr_b16 a[238:239], v10 offset:56320
  v_mfma_f32_32x32x16_bf16 v[232:247], a[212:215], a[160:163], v[232:247]
  buffer_load_dwordx4 v12, s[16:19], s44 offen offset:0 lds
  ds_read_b64_tr_b16 a[208:209], v9 offset:57344
  ds_read_b64_tr_b16 a[210:211], v9 offset:58368
  v_mfma_f32_32x32x16_bf16 v[216:231], a[216:219], a[164:167], v[216:231]
  ds_read_b64_tr_b16 a[212:213], v10 offset:57344
  ds_read_b64_tr_b16 a[214:215], v10 offset:58368
  v_mfma_f32_32x32x16_bf16 v[232:247], a[220:223], a[164:167], v[232:247]
  ds_read_b64_tr_b16 a[216:217], v9 offset:59392
  ds_read_b64_tr_b16 a[218:219], v9 offset:60416
  s_waitcnt lgkmcnt(6)
  v_mfma_f32_32x32x16_bf16 v[216:231], a[224:227], a[168:171], v[216:231]
  buffer_load_dwordx2 v[248:249], v18, s[4:7], s64 offen
  ds_read_b64_tr_b16 a[220:221], v10 offset:59392
  ds_read_b64_tr_b16 a[222:223], v10 offset:60416
  v_mfma_f32_32x32x16_bf16 v[232:247], a[228:231], a[168:171], v[232:247]
  buffer_load_dwordx4 v13, s[16:19], s44 offen offset:1024 lds
  ds_read_b64_tr_b16 a[224:225], v9 offset:61440
  ds_read_b64_tr_b16 a[226:227], v9 offset:62464
  v_mfma_f32_32x32x16_bf16 v[216:231], a[232:235], a[172:175], v[216:231]
  ds_read_b64_tr_b16 a[228:229], v10 offset:61440
  ds_read_b64_tr_b16 a[230:231], v10 offset:62464
  s_waitcnt vmcnt(17)
  s_barrier
  v_mfma_f32_32x32x16_bf16 v[232:247], a[236:239], a[172:175], v[232:247]
  ds_read_b64_tr_b16 a[232:233], v9 offset:63488
  ds_read_b64_tr_b16 a[234:235], v9 offset:64512
  s_waitcnt lgkmcnt(6)
  v_mfma_f32_32x32x16_bf16 v[216:231], a[208:211], a[176:179], v[216:231]
  buffer_load_dwordx2 v[200:201], v18, s[4:7], s65 offen
  ds_read_b64_tr_b16 a[236:237], v10 offset:63488
  ds_read_b64_tr_b16 a[238:239], v10 offset:64512
  v_mfma_f32_32x32x16_bf16 v[232:247], a[212:215], a[176:179], v[232:247]
  buffer_load_dwordx4 v14, s[16:19], s44 offen offset:2048 lds
  v_add_u32 v9, 0x10000, v9
  ds_read_b64_tr_b16 a[208:209], v9 offset:0
  ds_read_b64_tr_b16 a[210:211], v9 offset:1024
  v_mfma_f32_32x32x16_bf16 v[216:231], a[216:219], a[180:183], v[216:231]
  v_add_u32 v10, 0x10000, v10
  ds_read_b64_tr_b16 a[212:213], v10 offset:0
  ds_read_b64_tr_b16 a[214:215], v10 offset:1024
  v_mfma_f32_32x32x16_bf16 v[232:247], a[220:223], a[180:183], v[232:247]
  ds_read_b64_tr_b16 a[216:217], v9 offset:2048
  ds_read_b64_tr_b16 a[218:219], v9 offset:3072
  s_waitcnt lgkmcnt(6)
  v_mfma_f32_32x32x16_bf16 v[216:231], a[224:227], v[68:71], v[216:231]
  buffer_load_dwordx2 v[208:209], v19, s[4:7], s66 offen
  ds_read_b64_tr_b16 a[220:221], v10 offset:2048
  ds_read_b64_tr_b16 a[222:223], v10 offset:3072
  v_mfma_f32_32x32x16_bf16 v[232:247], a[228:231], v[68:71], v[232:247]
  buffer_load_dwordx4 v15, s[16:19], s44 offen offset:3072 lds
  ds_read_b64_tr_b16 a[224:225], v9 offset:4096
  ds_read_b64_tr_b16 a[226:227], v9 offset:5120
  v_mfma_f32_32x32x16_bf16 v[152:167], a[232:235], v[28:31], 0
  ds_read_b64_tr_b16 a[228:229], v10 offset:4096
  ds_read_b64_tr_b16 a[230:231], v10 offset:5120
  s_add_u32 m0, s50, 57344
  s_add_u32 s44, s81, s65
  v_mfma_f32_32x32x16_bf16 v[168:183], a[236:239], v[28:31], 0
  ds_read_b64_tr_b16 a[232:233], v9 offset:6144
  ds_read_b64_tr_b16 a[234:235], v9 offset:7168
  s_waitcnt lgkmcnt(6)
  v_mfma_f32_32x32x16_bf16 v[152:167], a[208:211], v[32:35], v[152:167]
  buffer_load_dwordx4 v12, s[20:23], s44 offen offset:0 lds
  ds_read_b64_tr_b16 a[236:237], v10 offset:6144
  ds_read_b64_tr_b16 a[238:239], v10 offset:7168
  v_mfma_f32_32x32x16_bf16 v[168:183], a[212:215], v[32:35], v[168:183]
  ds_read_b64_tr_b16 a[208:209], v9 offset:8192
  ds_read_b64_tr_b16 a[210:211], v9 offset:9216
  s_waitcnt vmcnt(21)
  s_add_u32 s76, s92, 6
  v_mov_b32 v24, s76
  buffer_store_dwordx2 v[24:25], v4, s[28:31], s90 offen sc1
  v_mfma_f32_32x32x16_bf16 v[152:167], a[216:219], v[36:39], v[152:167]
  ds_read_b64_tr_b16 a[212:213], v10 offset:8192
  ds_read_b64_tr_b16 a[214:215], v10 offset:9216
  s_add_u32 s54, s91, 262144
  v_cvt_pk_bf16_f32 v76, v216, v217
  v_cvt_pk_bf16_f32 v77, v218, v219
  v_mfma_f32_32x32x16_bf16 v[168:183], a[220:223], v[36:39], v[168:183]
  ds_read_b64_tr_b16 a[216:217], v9 offset:10240
  ds_read_b64_tr_b16 a[218:219], v9 offset:11264
  v_cvt_pk_bf16_f32 v78, v220, v221
  v_cvt_pk_bf16_f32 v79, v222, v223
  buffer_store_dwordx4 v[76:79], v16, s[28:31], s54 offen offset:0 sc1
  s_waitcnt lgkmcnt(6)
L_pg9:
  s_cbranch_execz L_walked
  v_mfma_f32_32x32x16_bf16 v[152:167], a[224:227], v[40:43], v[152:167]
  ds_read_b64_tr_b16 a[220:221], v10 offset:10240
  ds_read_b64_tr_b16 a[222:223], v10 offset:11264
  v_cvt_pk_bf16_f32 v80, v224, v225
  v_cvt_pk_bf16_f32 v81, v226, v227
  v_cvt_pk_bf16_f32 v82, v228, v229
  v_mfma_f32_32x32x16_bf16 v[168:183], a[228:231], v[40:43], v[168:183]
  ds_read_b64_tr_b16 a[224:225], v9 offset:12288
  ds_read_b64_tr_b16 a[226:227], v9 offset:13312
  v_cvt_pk_bf16_f32 v83, v230, v231
  buffer_store_dwordx4 v[80:83], v16, s[28:31], s54 offen offset:128 sc1
  v_cvt_pk_bf16_f32 v84, v232, v233
  v_mfma_f32_32x32x16_bf16 v[152:167], a[232:235], v[44:47], v[152:167]
  ds_read_b64_tr_b16 a[228:229], v10 offset:12288
  ds_read_b64_tr_b16 a[230:231], v10 offset:13312
  v_cvt_pk_bf16_f32 v85, v234, v235
  v_cvt_pk_bf16_f32 v86, v236, v237
  v_cvt_pk_bf16_f32 v87, v238, v239
  v_mfma_f32_32x32x16_bf16 v[168:183], a[236:239], v[44:47], v[168:183]
  buffer_store_dwordx4 v[84:87], v16, s[28:31], s54 offen offset:256 sc1
  ds_read_b64_tr_b16 a[232:233], v9 offset:14336
  ds_read_b64_tr_b16 a[234:235], v9 offset:15360
  v_cvt_pk_bf16_f32 v88, v240, v241
  v_cvt_pk_bf16_f32 v89, v242, v243
  s_waitcnt lgkmcnt(6)
  v_mfma_f32_32x32x16_bf16 v[152:167], a[208:211], v[48:51], v[152:167]
  ds_read_b64_tr_b16 a[236:237], v10 offset:14336
  ds_read_b64_tr_b16 a[238:239], v10 offset:15360
  v_cvt_pk_bf16_f32 v90, v244, v245
  v_cvt_pk_bf16_f32 v91, v246, v247
  v_accvgpr_read_b32 v12, a244
  v_add_u32 v13, 17408, v12
  v_add_u32 v14, 34816, v12
  v_add_u32 v15, 52224, v12
  v_mfma_f32_32x32x16_bf16 v[168:183], a[212:215], v[48:51], v[168:183]
  buffer_store_dwordx4 v[88:91], v16, s[28:31], s54 offen offset:384 sc1
  ds_read_b64_tr_b16 a[208:209], v9 offset:16384
  ds_read_b64_tr_b16 a[210:211], v9 offset:17408
  s_add_u32 m0, s49, 63488
  s_add_u32 s44, s84, s66
  v_mfma_f32_32x32x16_bf16 v[152:167], a[216:219], v[52:55], v[152:167]
  buffer_load_dwordx4 v12, s[16:19], s44 offen offset:0 lds
  ds_read_b64_tr_b16 a[212:213], v10 offset:16384
  ds_read_b64_tr_b16 a[214:215], v10 offset:17408
  s_waitcnt vmcnt(22)
  s_barrier
  v_mfma_f32_32x32x16_bf16 v[168:183], a[220:223], v[52:55], v[168:183]
  v_add_u32 v9, 0xfffdd000, v9
  ds_read_b64_tr_b16 a[216:217], v9 offset:0
  ds_read_b64_tr_b16 a[218:219], v9 offset:1024
  s_waitcnt lgkmcnt(6)
  v_mfma_f32_32x32x16_bf16 v[152:167], a[224:227], v[56:59], v[152:167]
  v_add_u32 v10, 0xfffdd000, v10
  ds_read_b64_tr_b16 a[220:221], v10 offset:0
  ds_read_b64_tr_b16 a[222:223], v10 offset:1024
  v_mfma_f32_32x32x16_bf16 v[168:183], a[228:231], v[56:59], v[168:183]
  buffer_load_dwordx4 v13, s[16:19], s44 offen offset:1024 lds
  ds_read_b64_tr_b16 a[224:225], v9 offset:2048
  ds_read_b64_tr_b16 a[226:227], v9 offset:3072
  v_mfma_f32_32x32x16_bf16 v[152:167], a[232:235], v[112:115], v[152:167]
  ds_read_b64_tr_b16 a[228:229], v10 offset:2048
  ds_read_b64_tr_b16 a[230:231], v10 offset:3072
  v_mfma_f32_32x32x16_bf16 v[168:183], a[236:239], v[112:115], v[168:183]
  ds_read_b64_tr_b16 a[232:233], v9 offset:4096
  ds_read_b64_tr_b16 a[234:235], v9 offset:5120
  s_waitcnt lgkmcnt(6)
  v_mfma_f32_32x32x16_bf16 v[152:167], a[208:211], v[116:119], v[152:167]
  buffer_load_dwordx4 v14, s[16:19], s44 offen offset:2048 lds
  ds_read_b64_tr_b16 a[236:237], v10 offset:4096
  ds_read_b64_tr_b16 a[238:239], v10 offset:5120
  v_mfma_f32_32x32x16_bf16 v[168:183], a[212:215], v[116:119], v[168:183]
  ds_read_b64_tr_b16 a[208:209], v9 offset:6144
  ds_read_b64_tr_b16 a[210:211], v9 offset:7168
  v_mfma_f32_32x32x16_bf16 v[152:167], a[216:219], v[120:123], v[152:167]
  ds_read_b64_tr_b16 a[212:213], v10 offset:6144
  ds_read_b64_tr_b16 a[214:215], v10 offset:7168
  v_mfma_f32_32x32x16_bf16 v[168:183], a[220:223], v[120:123], v[168:183]
  buffer_load_dwordx4 v15, s[16:19], s44 offen offset:3072 lds
  ds_read_b64_tr_b16 a[216:217], v9 offset:8192
  ds_read_b64_tr_b16 a[218:219], v9 offset:9216
  s_waitcnt lgkmcnt(6)
  v_mfma_f32_32x32x16_bf16 v[152:167], a[224:227], v[124:127], v[152:167]
  ds_read_b64_tr_b16 a[220:221], v10 offset:8192
  ds_read_b64_tr_b16 a[222:223], v10 offset:9216
  s_add_u32 m0, s83, 79872
  s_add_u32 s44, s86, s66
  v_mfma_f32_32x32x16_bf16 v[168:183], a[228:231], v[124:127], v[168:183]
  ds_read_b64_tr_b16 a[224:225], v9 offset:10240
  ds_read_b64_tr_b16 a[226:227], v9 offset:11264
  v_mfma_f32_32x32x16_bf16 v[152:167], a[232:235], v[128:131], v[152:167]
  ds_read_b64_tr_b16 a[228:229], v10 offset:10240
  ds_read_b64_tr_b16 a[230:231], v10 offset:11264
  v_mfma_f32_32x32x16_bf16 v[168:183], a[236:239], v[128:131], v[168:183]
  buffer_load_dwordx4 v12, s[16:19], s44 offen offset:0 lds
  ds_read_b64_tr_b16 a[232:233], v9 offset:12288
  ds_read_b64_tr_b16 a[234:235], v9 offset:13312
  s_waitcnt lgkmcnt(6)
  v_mfma_f32_32x32x16_bf16 v[152:167], a[208:211], v[132:135], v[152:167]
  ds_read_b64_tr_b16 a[236:237], v10 offset:12288
  ds_read_b64_tr_b16 a[238:239], v10 offset:13312
  s_add_u32 m0, s83, 81920
  s_add_u32 s44, s88, s66
  v_mfma_f32_32x32x16_bf16 v[168:183], a[212:215], v[132:135], v[168:183]
  ds_read_b64_tr_b16 a[208:209], v9 offset:14336
  ds_read_b64_tr_b16 a[210:211], v9 offset:15360
  v_mfma_f32_32x32x16_bf16 v[152:167], a[216:219], v[136:139], v[152:167]
  ds_read_b64_tr_b16 a[212:213], v10 offset:14336
  ds_read_b64_tr_b16 a[214:215], v10 offset:15360
  v_mfma_f32_32x32x16_bf16 v[168:183], a[220:223], v[136:139], v[168:183]
  ds_read_b64_tr_b16 a[216:217], v9 offset:16384
  ds_read_b64_tr_b16 a[218:219], v9 offset:17408
  s_waitcnt lgkmcnt(6)
  v_mfma_f32_32x32x16_bf16 v[152:167], a[224:227], v[140:143], v[152:167]
  buffer_load_dwordx4 v12, s[20:23], s44 offen offset:0 lds
  ds_read_b64_tr_b16 a[220:221], v10 offset:16384
  ds_read_b64_tr_b16 a[222:223], v10 offset:17408
  v_mfma_f32_32x32x16_bf16 v[168:183], a[228:231], v[140:143], v[168:183]
  ds_read_b64_tr_b16 a[224:225], v9 offset:18432
  ds_read_b64_tr_b16 a[226:227], v9 offset:19456
  s_add_u32 m0, s49, 83968
  s_add_u32 s44, s85, s66
  v_mfma_f32_32x32x16_bf16 v[152:167], a[232:235], v[144:147], v[152:167]
  ds_read_b64_tr_b16 a[228:229], v10 offset:18432
  ds_read_b64_tr_b16 a[230:231], v10 offset:19456
  s_waitcnt vmcnt(22)
  s_barrier
  v_mfma_f32_32x32x16_bf16 v[168:183], a[236:239], v[144:147], v[168:183]
  ds_read_b64_tr_b16 a[232:233], v9 offset:20480
  ds_read_b64_tr_b16 a[234:235], v9 offset:21504
  s_waitcnt lgkmcnt(6)
  v_mfma_f32_32x32x16_bf16 v[152:167], a[208:211], v[148:151], v[152:167]
  buffer_load_dwordx4 v12, s[16:19], s44 offen offset:0 lds
  ds_read_b64_tr_b16 a[236:237], v10 offset:20480
  ds_read_b64_tr_b16 a[238:239], v10 offset:21504
  v_mfma_f32_32x32x16_bf16 v[168:183], a[212:215], v[148:151], v[168:183]
  ds_read_b64_tr_b16 a[208:209], v9 offset:22528
  ds_read_b64_tr_b16 a[210:211], v9 offset:23552
  v_mfma_f32_32x32x16_bf16 v[152:167], a[216:219], v[60:63], v[152:167]
  ds_read_b64_tr_b16 a[212:213], v10 offset:22528
  ds_read_b64_tr_b16 a[214:215], v10 offset:23552
  v_mfma_f32_32x32x16_bf16 v[168:183], a[220:223], v[60:63], v[168:183]
  ds_read_b64_tr_b16 a[216:217], v9 offset:24576
  ds_read_b64_tr_b16 a[218:219], v9 offset:25600
  s_waitcnt lgkmcnt(6)
  v_mfma_f32_32x32x16_bf16 v[152:167], a[224:227], v[64:67], v[152:167]
  ds_read_b64_tr_b16 a[220:221], v10 offset:24576
  ds_read_b64_tr_b16 a[222:223], v10 offset:25600
  s_lshr_b32 s3, s2, 3
  s_lshl_b32 s3, s3, 2
  s_add_u32 s3, s3, s60
  s_lshl_b32 s3, s3, 9
  v_mfma_f32_32x32x16_bf16 v[168:183], a[228:231], v[64:67], v[168:183]
  ds_read_b64_tr_b16 a[224:225], v9 offset:26624
  ds_read_b64_tr_b16 a[226:227], v9 offset:27648
  v_accvgpr_read_b32 v26, a246
  buffer_load_dword v26, v26, s[36:39], s3 offen
  v_mfma_f32_32x32x16_bf16 v[152:167], a[232:235], a[104:107], v[152:167]
  ds_read_b64_tr_b16 a[228:229], v10 offset:26624
  ds_read_b64_tr_b16 a[230:231], v10 offset:27648
  s_waitcnt vmcnt(8)
  s_add_u32 s76, s92, 7
  v_mov_b32 v24, s76
  buffer_store_dwordx2 v[24:25], v4, s[28:31], s90 offen sc1
  v_mfma_f32_32x32x16_bf16 v[168:183], a[236:239], a[104:107], v[168:183]
  buffer_load_dwordx4 v13, s[16:19], s44 offen offset:1024 lds
  ds_read_b64_tr_b16 a[232:233], v9 offset:28672
  ds_read_b64_tr_b16 a[234:235], v9 offset:29696
  s_waitcnt lgkmcnt(6)
  v_mfma_f32_32x32x16_bf16 v[152:167], a[208:211], a[108:111], v[152:167]
  ds_read_b64_tr_b16 a[236:237], v10 offset:28672
  ds_read_b64_tr_b16 a[238:239], v10 offset:29696
  v_mfma_f32_32x32x16_bf16 v[168:183], a[212:215], a[108:111], v[168:183]
  ds_read_b64_tr_b16 a[208:209], v9 offset:30720
  ds_read_b64_tr_b16 a[210:211], v9 offset:31744
  v_mfma_f32_32x32x16_bf16 v[152:167], a[216:219], a[112:115], v[152:167]
  buffer_load_dwordx4 v14, s[16:19], s44 offen offset:2048 lds
  ds_read_b64_tr_b16 a[212:213], v10 offset:30720
  ds_read_b64_tr_b16 a[214:215], v10 offset:31744
  v_mfma_f32_32x32x16_bf16 v[168:183], a[220:223], a[112:115], v[168:183]
  ds_read_b64_tr_b16 a[216:217], v9 offset:32768
  ds_read_b64_tr_b16 a[218:219], v9 offset:33792
  s_waitcnt lgkmcnt(6)
  v_mfma_f32_32x32x16_bf16 v[152:167], a[224:227], a[116:119], v[152:167]
  ds_read_b64_tr_b16 a[220:221], v10 offset:32768
  ds_read_b64_tr_b16 a[222:223], v10 offset:33792
  v_mfma_f32_32x32x16_bf16 v[168:183], a[228:231], a[116:119], v[168:183]
  buffer_load_dwordx4 v15, s[16:19], s44 offen offset:3072 lds
  ds_read_b64_tr_b16 a[224:225], v9 offset:34816
  ds_read_b64_tr_b16 a[226:227], v9 offset:35840
  v_mfma_f32_32x32x16_bf16 v[152:167], a[232:235], a[120:123], v[152:167]
  ds_read_b64_tr_b16 a[228:229], v10 offset:34816
  ds_read_b64_tr_b16 a[230:231], v10 offset:35840
  s_add_u32 m0, s83, 100352
  s_add_u32 s44, s87, s66
  v_mfma_f32_32x32x16_bf16 v[168:183], a[236:239], a[120:123], v[168:183]
  ds_read_b64_tr_b16 a[232:233], v9 offset:36864
  ds_read_b64_tr_b16 a[234:235], v9 offset:37888
  s_waitcnt lgkmcnt(6)
  v_mfma_f32_32x32x16_bf16 v[152:167], a[208:211], a[124:127], v[152:167]
  ds_read_b64_tr_b16 a[236:237], v10 offset:36864
  ds_read_b64_tr_b16 a[238:239], v10 offset:37888
  v_mfma_f32_32x32x16_bf16 v[168:183], a[212:215], a[124:127], v[168:183]
  buffer_load_dwordx4 v12, s[16:19], s44 offen offset:0 lds
  ds_read_b64_tr_b16 a[208:209], v9 offset:38912
  ds_read_b64_tr_b16 a[210:211], v9 offset:39936
  v_mfma_f32_32x32x16_bf16 v[152:167], a[216:219], a[128:131], v[152:167]
  ds_read_b64_tr_b16 a[212:213], v10 offset:38912
  ds_read_b64_tr_b16 a[214:215], v10 offset:39936
  s_add_u32 m0, s50, 102400
  s_add_u32 s44, s94, s66
  s_barrier
  v_mfma_f32_32x32x16_bf16 v[168:183], a[220:223], a[128:131], v[168:183]
  ds_read_b64_tr_b16 a[216:217], v9 offset:40960
  ds_read_b64_tr_b16 a[218:219], v9 offset:41984
  s_waitcnt lgkmcnt(6)
  v_mfma_f32_32x32x16_bf16 v[152:167], a[224:227], a[132:135], v[152:167]
  ds_read_b64_tr_b16 a[220:221], v10 offset:40960
  ds_read_b64_tr_b16 a[222:223], v10 offset:41984
  v_mfma_f32_32x32x16_bf16 v[168:183], a[228:231], a[132:135], v[168:183]
  buffer_load_dwordx4 v12, s[20:23], s44 offen offset:0 lds
  ds_read_b64_tr_b16 a[224:225], v9 offset:43008
  ds_read_b64_tr_b16 a[226:227], v9 offset:44032
  v_mfma_f32_32x32x16_bf16 v[152:167], a[232:235], a[136:139], v[152:167]
  ds_read_b64_tr_b16 a[228:229], v10 offset:43008
  ds_read_b64_tr_b16 a[230:231], v10 offset:44032
  v_mfma_f32_32x32x16_bf16 v[168:183], a[236:239], a[136:139], v[168:183]
  ds_read_b64_tr_b16 a[232:233], v9 offset:45056
  ds_read_b64_tr_b16 a[234:235], v9 offset:46080
  s_waitcnt lgkmcnt(6)
  v_mfma_f32_32x32x16_bf16 v[152:167], a[208:211], a[140:143], v[152:167]
  ds_read_b64_tr_b16 a[236:237], v10 offset:45056
  ds_read_b64_tr_b16 a[238:239], v10 offset:46080
  v_mfma_f32_32x32x16_bf16 v[168:183], a[212:215], a[140:143], v[168:183]
  ds_read_b64_tr_b16 a[208:209], v9 offset:47104
  ds_read_b64_tr_b16 a[210:211], v9 offset:48128
  v_mfma_f32_32x32x16_bf16 v[152:167], a[216:219], a[144:147], v[152:167]
  ds_read_b64_tr_b16 a[212:213], v10 offset:47104
  ds_read_b64_tr_b16 a[214:215], v10 offset:48128
  v_mfma_f32_32x32x16_bf16 v[168:183], a[220:223], a[144:147], v[168:183]
  ds_read_b64_tr_b16 a[216:217], v9 offset:49152
  ds_read_b64_tr_b16 a[218:219], v9 offset:50176
  s_waitcnt lgkmcnt(6)
  v_mfma_f32_32x32x16_bf16 v[152:167], a[224:227], a[148:151], v[152:167]
  ds_read_b64_tr_b16 a[220:221], v10 offset:49152
  ds_read_b64_tr_b16 a[222:223], v10 offset:50176
  v_mfma_f32_32x32x16_bf16 v[168:183], a[228:231], a[148:151], v[168:183]
  ds_read_b64_tr_b16 a[224:225], v9 offset:51200
  ds_read_b64_tr_b16 a[226:227], v9 offset:52224
  v_mfma_f32_32x32x16_bf16 v[152:167], a[232:235], a[152:155], v[152:167]
  ds_read_b64_tr_b16 a[228:229], v10 offset:51200
  ds_read_b64_tr_b16 a[230:231], v10 offset:52224
  v_mfma_f32_32x32x16_bf16 v[168:183], a[236:239], a[152:155], v[168:183]
  ds_read_b64_tr_b16 a[232:233], v9 offset:53248
  ds_read_b64_tr_b16 a[234:235], v9 offset:54272
  s_waitcnt lgkmcnt(6)
  v_mfma_f32_32x32x16_bf16 v[152:167], a[208:211], a[156:159], v[152:167]
  ds_read_b64_tr_b16 a[236:237], v10 offset:53248
  ds_read_b64_tr_b16 a[238:239], v10 offset:54272
  v_mfma_f32_32x32x16_bf16 v[168:183], a[212:215], a[156:159], v[168:183]
  ds_read_b64_tr_b16 a[208:209], v9 offset:55296
  ds_read_b64_tr_b16 a[210:211], v9 offset:56320
  v_mfma_f32_32x32x16_bf16 v[152:167], a[216:219], a[160:163], v[152:167]
  ds_read_b64_tr_b16 a[212:213], v10 offset:55296
  ds_read_b64_tr_b16 a[214:215], v10 offset:56320
  v_mfma_f32_32x32x16_bf16 v[168:183], a[220:223], a[160:163], v[168:183]
  ds_read_b64_tr_b16 a[216:217], v9 offset:57344
  ds_read_b64_tr_b16 a[218:219], v9 offset:58368
  s_waitcnt lgkmcnt(6)
  v_mfma_f32_32x32x16_bf16 v[152:167], a[224:227], a[164:167], v[152:167]
  ds_read_b64_tr_b16 a[220:221], v10 offset:57344
  ds_read_b64_tr_b16 a[222:223], v10 offset:58368
  v_mfma_f32_32x32x16_bf16 v[168:183], a[228:231], a[164:167], v[168:183]
  ds_read_b64_tr_b16 a[224:225], v9 offset:59392
  ds_read_b64_tr_b16 a[226:227], v9 offset:60416
  v_mfma_f32_32x32x16_bf16 v[152:167], a[232:235], a[168:171], v[152:167]
  ds_read_b64_tr_b16 a[228:229], v10 offset:59392
  ds_read_b64_tr_b16 a[230:231], v10 offset:60416
  v_mfma_f32_32x32x16_bf16 v[168:183], a[236:239], a[168:171], v[168:183]
  ds_read_b64_tr_b16 a[232:233], v9 offset:61440
  ds_read_b64_tr_b16 a[234:235], v9 offset:62464
  s_waitcnt lgkmcnt(6)
  v_mfma_f32_32x32x16_bf16 v[152:167], a[208:211], a[172:175], v[152:167]
  ds_read_b64_tr_b16 a[236:237], v10 offset:61440
  ds_read_b64_tr_b16 a[238:239], v10 offset:62464
  s_waitcnt vmcnt(8)
  s_barrier
  v_mfma_f32_32x32x16_bf16 v[168:183], a[212:215], a[172:175], v[168:183]
  ds_read_b64_tr_b16 a[208:209], v7 offset:63488
  ds_read_b64_tr_b16 a[210:211], v7 offset:64000
  v_mfma_f32_32x32x16_bf16 v[152:167], a[216:219], a[176:179], v[152:167]
  ds_read_b64_tr_b16 a[212:213], v7 offset:64512
  ds_read_b64_tr_b16 a[214:215], v7 offset:65024
  v_mfma_f32_32x32x16_bf16 v[168:183], a[220:223], a[176:179], v[168:183]
  v_add_u32 v7, 0x10000, v7
  ds_read_b64_tr_b16 a[216:217], v7 offset:0
  ds_read_b64_tr_b16 a[218:219], v7 offset:512
  s_waitcnt lgkmcnt(6)
  v_mfma_f32_32x32x16_bf16 v[152:167], a[224:227], a[180:183], v[152:167]
  ds_read_b64_tr_b16 a[220:221], v7 offset:1024
  ds_read_b64_tr_b16 a[222:223], v7 offset:1536
  v_mfma_f32_32x32x16_bf16 v[168:183], a[228:231], a[180:183], v[168:183]
  ds_read_b64_tr_b16 a[224:225], v7 offset:2048
  ds_read_b64_tr_b16 a[226:227], v7 offset:2560
  v_mfma_f32_32x32x16_bf16 v[152:167], a[232:235], v[68:71], v[152:167]
  ds_read_b64_tr_b16 a[228:229], v7 offset:3072
  ds_read_b64_tr_b16 a[230:231], v7 offset:3584
  v_mfma_f32_32x32x16_bf16 v[168:183], a[236:239], v[68:71], v[168:183]
  ds_read_b64_tr_b16 a[232:233], v7 offset:4096
  ds_read_b64_tr_b16 a[234:235], v7 offset:4608
  s_waitcnt lgkmcnt(6)
  v_mfma_f32_32x32x16_bf16 v[184:199], a[208:211], v[28:31], 0
  ds_read_b64_tr_b16 a[236:237], v7 offset:5120
  ds_read_b64_tr_b16 a[238:239], v7 offset:5632
  v_mfma_f32_32x32x16_bf16 v[184:199], a[212:215], v[32:35], v[184:199]
  ds_read_b64_tr_b16 a[208:209], v7 offset:6144
  ds_read_b64_tr_b16 a[210:211], v7 offset:6656
  v_mfma_f32_32x32x16_bf16 v[184:199], a[216:219], v[36:39], v[184:199]
  ds_read_b64_tr_b16 a[212:213], v7 offset:7168
  ds_read_b64_tr_b16 a[214:215], v7 offset:7680
  v_mfma_f32_32x32x16_bf16 v[184:199], a[220:223], v[40:43], v[184:199]
  ds_read_b64_tr_b16 a[216:217], v7 offset:8192
  ds_read_b64_tr_b16 a[218:219], v7 offset:8704
  s_add_u32 s54, s91, 393216
  v_cvt_pk_bf16_f32 v76, v152, v153
  v_cvt_pk_bf16_f32 v77, v154, v155
  s_waitcnt lgkmcnt(6)
  v_mfma_f32_32x32x16_bf16 v[184:199], a[224:227], v[44:47], v[184:199]
  ds_read_b64_tr_b16 a[220:221], v7 offset:9216
  ds_read_b64_tr_b16 a[222:223], v7 offset:9728
  v_cvt_pk_bf16_f32 v78, v156, v157
  v_cvt_pk_bf16_f32 v79, v158, v159
  buffer_store_dwordx4 v[76:79], v16, s[28:31], s54 offen offset:0 sc1
  v_mfma_f32_32x32x16_bf16 v[184:199], a[228:231], v[48:51], v[184:199]
  ds_read_b64_tr_b16 a[224:225], v7 offset:10240
  ds_read_b64_tr_b16 a[226:227], v7 offset:10752
  v_cvt_pk_bf16_f32 v80, v160, v161
  v_cvt_pk_bf16_f32 v81, v162, v163
  v_cvt_pk_bf16_f32 v82, v164, v165
  v_mfma_f32_32x32x16_bf16 v[184:199], a[232:235], v[52:55], v[184:199]
  ds_read_b64_tr_b16 a[228:229], v7 offset:11264
  ds_read_b64_tr_b16 a[230:231], v7 offset:11776
  v_cvt_pk_bf16_f32 v83, v166, v167
  buffer_store_dwordx4 v[80:83], v16, s[28:31], s54 offen offset:128 sc1
  v_cvt_pk_bf16_f32 v84, v168, v169
  v_mfma_f32_32x32x16_bf16 v[184:199], a[236:239], v[56:59], v[184:199]
  ds_read_b64_tr_b16 a[232:233], v7 offset:12288
  ds_read_b64_tr_b16 a[234:235], v7 offset:12800
  v_cvt_pk_bf16_f32 v85, v170, v171
  v_cvt_pk_bf16_f32 v86, v172, v173
  v_cvt_pk_bf16_f32 v87, v174, v175
  s_waitcnt lgkmcnt(6)
  v_mfma_f32_32x32x16_bf16 v[184:199], a[208:211], v[112:115], v[184:199]
  buffer_store_dwordx4 v[84:87], v16, s[28:31], s54 offen offset:256 sc1
  ds_read_b64_tr_b16 a[236:237], v7 offset:13312
  ds_read_b64_tr_b16 a[238:239], v7 offset:13824
  v_cvt_pk_bf16_f32 v88, v176, v177
  v_cvt_pk_bf16_f32 v89, v178, v179
  v_mfma_f32_32x32x16_bf16 v[184:199], a[212:215], v[116:119], v[184:199]
  ds_read_b64_tr_b16 a[208:209], v7 offset:14336
  ds_read_b64_tr_b16 a[210:211], v7 offset:14848
  v_cvt_pk_bf16_f32 v90, v180, v181
  v_cvt_pk_bf16_f32 v91, v182, v183
  v_mfma_f32_32x32x16_bf16 v[184:199], a[216:219], v[120:123], v[184:199]
  buffer_store_dwordx4 v[88:91], v16, s[28:31], s54 offen offset:384 sc1
  ds_read_b64_tr_b16 a[212:213], v7 offset:15360
  ds_read_b64_tr_b16 a[214:215], v7 offset:15872
  v_mfma_f32_32x32x16_bf16 v[184:199], a[220:223], v[124:127], v[184:199]
  ds_read_b64_tr_b16 a[216:217], v7 offset:16384
  ds_read_b64_tr_b16 a[218:219], v7 offset:16896
  s_waitcnt lgkmcnt(6)
  v_mfma_f32_32x32x16_bf16 v[184:199], a[224:227], v[128:131], v[184:199]
  ds_read_b64_tr_b16 a[220:221], v7 offset:17408
  ds_read_b64_tr_b16 a[222:223], v7 offset:17920
  s_waitcnt vmcnt(4)
  s_barrier
  v_mfma_f32_32x32x16_bf16 v[184:199], a[228:231], v[132:135], v[184:199]
  ds_read_b64_tr_b16 a[224:225], v7 offset:18432
  ds_read_b64_tr_b16 a[226:227], v7 offset:18944
  v_mfma_f32_32x32x16_bf16 v[184:199], a[232:235], v[136:139], v[184:199]
  ds_read_b64_tr_b16 a[228:229], v7 offset:19456
  ds_read_b64_tr_b16 a[230:231], v7 offset:19968
  v_mfma_f32_32x32x16_bf16 v[184:199], a[236:239], v[140:143], v[184:199]
  ds_read_b64_tr_b16 a[232:233], v7 offset:20480
  ds_read_b64_tr_b16 a[234:235], v7 offset:20992
  s_waitcnt lgkmcnt(6)
  v_mfma_f32_32x32x16_bf16 v[184:199], a[208:211], v[144:147], v[184:199]
  ds_read_b64_tr_b16 a[236:237], v7 offset:21504
  ds_read_b64_tr_b16 a[238:239], v7 offset:22016
  v_mfma_f32_32x32x16_bf16 v[184:199], a[212:215], v[148:151], v[184:199]
  buffer_load_dwordx2 v[26:27], v0, s[28:31], 0 offen sc1
  ds_read_b64_tr_b16 a[208:209], v7 offset:22528
  ds_read_b64_tr_b16 a[210:211], v7 offset:23040
  v_mfma_f32_32x32x16_bf16 v[184:199], a[216:219], v[60:63], v[184:199]
  ds_read_b64_tr_b16 a[212:213], v7 offset:23552
  ds_read_b64_tr_b16 a[214:215], v7 offset:24064
  v_mfma_f32_32x32x16_bf16 v[184:199], a[220:223], v[64:67], v[184:199]
  ds_read_b64_tr_b16 a[216:217], v7 offset:24576
  ds_read_b64_tr_b16 a[218:219], v7 offset:25088
  s_waitcnt lgkmcnt(6)
  v_mfma_f32_32x32x16_bf16 v[184:199], a[224:227], a[104:107], v[184:199]
  ds_read_b64_tr_b16 a[220:221], v7 offset:25600
  ds_read_b64_tr_b16 a[222:223], v7 offset:26112
  v_mfma_f32_32x32x16_bf16 v[184:199], a[228:231], a[108:111], v[184:199]
  ds_read_b64_tr_b16 a[224:225], v7 offset:26624
  ds_read_b64_tr_b16 a[226:227], v7 offset:27136
  v_mfma_f32_32x32x16_bf16 v[184:199], a[232:235], a[112:115], v[184:199]
  ds_read_b64_tr_b16 a[228:229], v7 offset:27648
  ds_read_b64_tr_b16 a[230:231], v7 offset:28160
  v_mfma_f32_32x32x16_bf16 v[184:199], a[236:239], a[116:119], v[184:199]
  ds_read_b64_tr_b16 a[232:233], v7 offset:28672
  ds_read_b64_tr_b16 a[234:235], v7 offset:29184
  s_waitcnt lgkmcnt(6)
  v_mfma_f32_32x32x16_bf16 v[184:199], a[208:211], a[120:123], v[184:199]
  ds_read_b64_tr_b16 a[236:237], v7 offset:29696
  ds_read_b64_tr_b16 a[238:239], v7 offset:30208
  v_mfma_f32_32x32x16_bf16 v[184:199], a[212:215], a[124:127], v[184:199]
  ds_read_b64_tr_b16 a[208:209], v7 offset:30720
  ds_read_b64_tr_b16 a[210:211], v7 offset:31232
  v_mfma_f32_32x32x16_bf16 v[184:199], a[216:219], a[128:131], v[184:199]
  ds_read_b64_tr_b16 a[212:213], v7 offset:31744
  ds_read_b64_tr_b16 a[214:215], v7 offset:32256
  v_mfma_f32_32x32x16_bf16 v[184:199], a[220:223], a[132:135], v[184:199]
  ds_read_b64_tr_b16 a[216:217], v7 offset:32768
  ds_read_b64_tr_b16 a[218:219], v7 offset:33280
  s_waitcnt lgkmcnt(6)
  v_mfma_f32_32x32x16_bf16 v[184:199], a[224:227], a[136:139], v[184:199]
  ds_read_b64_tr_b16 a[220:221], v7 offset:33792
  ds_read_b64_tr_b16 a[222:223], v7 offset:34304
  v_mfma_f32_32x32x16_bf16 v[184:199], a[228:231], a[140:143], v[184:199]
  ds_read_b64_tr_b16 a[224:225], v7 offset:34816
  ds_read_b64_tr_b16 a[226:227], v7 offset:35328
  v_mfma_f32_32x32x16_bf16 v[184:199], a[232:235], a[144:147], v[184:199]
  ds_read_b64_tr_b16 a[228:229], v7 offset:35840
  ds_read_b64_tr_b16 a[230:231], v7 offset:36352
  v_mfma_f32_32x32x16_bf16 v[184:199], a[236:239], a[148:151], v[184:199]
  ds_read_b64_tr_b16 a[232:233], v7 offset:36864
  ds_read_b64_tr_b16 a[234:235], v7 offset:37376
  s_waitcnt lgkmcnt(6)
  v_mfma_f32_32x32x16_bf16 v[184:199], a[208:211], a[152:155], v[184:199]
  ds_read_b64_tr_b16 a[236:237], v7 offset:37888
  ds_read_b64_tr_b16 a[238:239], v7 offset:38400
  v_mfma_f32_32x32x16_bf16 v[184:199], a[212:215], a[156:159], v[184:199]
  ds_read_b64_tr_b16 a[208:209], v7 offset:38912
  ds_read_b64_tr_b16 a[210:211], v7 offset:39936
  v_mfma_f32_32x32x16_bf16 v[184:199], a[216:219], a[160:163], v[184:199]
  v_mfma_f32_32x32x16_bf16 v[184:199], a[220:223], a[164:167], v[184:199]
  s_waitcnt lgkmcnt(2)
  v_mfma_f32_32x32x16_bf16 v[184:199], a[224:227], a[168:171], v[184:199]
  v_mfma_f32_32x32x16_bf16 v[184:199], a[228:231], a[172:175], v[184:199]
  v_mfma_f32_32x32x16_bf16 v[184:199], a[232:235], a[176:179], v[184:199]
  v_mfma_f32_32x32x16_bf16 v[184:199], a[236:239], a[180:183], v[184:199]
  s_waitcnt lgkmcnt(0)
  v_mfma_f32_32x32x16_bf16 v[184:199], a[208:211], v[68:71], v[184:199]
  s_add_u32 s54, s91, 524288
  s_nop 10
  v_cvt_pk_bf16_f32 v76, v184, v185
  v_cvt_pk_bf16_f32 v77, v186, v187
  v_cvt_pk_bf16_f32 v78, v188, v189
  v_cvt_pk_bf16_f32 v79, v190, v191
  buffer_store_dwordx4 v[76:79], v16, s[28:31], s54 offen offset:0 sc1
  v_cvt_pk_bf16_f32 v80, v192, v193
  v_cvt_pk_bf16_f32 v81, v194, v195
  v_cvt_pk_bf16_f32 v82, v196, v197
  v_cvt_pk_bf16_f32 v83, v198, v199
  buffer_store_dwordx4 v[80:83], v16, s[28:31], s54 offen offset:128 sc1
  s_add_u32 s75, s92, 7
  s_waitcnt vmcnt(2)
  v_subrev_u32 v26, s75, v26
  v_cmp_eq_u32 s[52:53], s93, v27
  v_cmp_ge_u32 vcc, 8, v26
  s_nop 0
  s_and_b32 vcc_lo, vcc_lo, s52
  s_cmp_eq_u32 vcc_lo, 0xff
  s_cbranch_scc0 L_slow_rb
L_back_rb:
  s_add_u32 s55, s91, 0
  buffer_load_dwordx4 a[0:3], v17, s[28:31], s55 offen offset:0 sc1
  buffer_load_dwordx4 a[4:7], v17, s[28:31], s55 offen offset:2048 sc1
  buffer_load_dwordx4 a[8:11], v17, s[28:31], s55 offen offset:256 sc1
  buffer_load_dwordx4 a[12:15], v17, s[28:31], s55 offen offset:2304 sc1
  s_waitcnt vmcnt(4)
  s_add_u32 s76, s92, 9
  v_mov_b32 v24, s76
  buffer_store_dwordx2 v[24:25], v4, s[28:31], s90 offen sc1
  s_add_u32 s55, s91, 131072
  buffer_load_dwordx4 a[16:19], v17, s[28:31], s55 offen offset:0 sc1
  buffer_load_dwordx4 a[20:23], v17, s[28:31], s55 offen offset:2048 sc1
  buffer_load_dwordx4 a[24:27], v17, s[28:31], s55 offen offset:256 sc1
  buffer_load_dwordx4 a[28:31], v17, s[28:31], s55 offen offset:2304 sc1
  s_add_u32 s55, s91, 262144
  buffer_load_dwordx4 a[32:35], v17, s[28:31], s55 offen offset:0 sc1
  buffer_load_dwordx4 a[36:39], v17, s[28:31], s55 offen offset:2048 sc1
  buffer_load_dwordx4 a[40:43], v17, s[28:31], s55 offen offset:256 sc1
  buffer_load_dwordx4 a[44:47], v17, s[28:31], s55 offen offset:2304 sc1
  v_lshlrev_b32 v100, 16, v96
  v_and_b32 v101, 0xffff0000, v96
  v_lshlrev_b32 v102, 16, v97
  v_and_b32 v103, 0xffff0000, v97
  s_waitcnt vmcnt(12)
  s_nop 0
  v_mfma_f32_16x16x32_bf16 v[100:103], a[252:255], a[0:3], v[100:103]
  s_waitcnt vmcnt(11)
  v_mfma_f32_16x16x32_bf16 v[100:103], a[252:255], a[4:7], v[100:103]
  s_waitcnt vmcnt(10)
  v_mfma_f32_16x16x32_bf16 v[100:103], a[248:251], a[8:11], v[100:103]
  s_waitcnt vmcnt(9)
  v_mfma_f32_16x16x32_bf16 v[100:103], a[248:251], a[12:15], v[100:103]
  s_nop 7
  v_cvt_pk_bf16_f32 v98, v100, v101
  v_cvt_pk_bf16_f32 v99, v102, v103
  buffer_store_dwordx2 v[98:99], v18, s[24:27], s62 offen sc1
  buffer_load_dwordx2 v[26:27], v0, s[28:31], 0 offen sc1
  v_lshlrev_b32 v108, 16, v104
  v_and_b32 v109, 0xffff0000, v104
  v_lshlrev_b32 v110, 16, v105
  v_and_b32 v111, 0xffff0000, v105
  s_waitcnt vmcnt(9)
  s_nop 0
  v_mfma_f32_16x16x32_bf16 v[108:111], a[252:255], a[16:19], v[108:111]
  s_waitcnt vmcnt(8)
  v_mfma_f32_16x16x32_bf16 v[108:111], a[252:255], a[20:23], v[108:111]
  s_waitcnt vmcnt(7)
  v_mfma_f32_16x16x32_bf16 v[108:111], a[248:251], a[24:27], v[108:111]
  s_waitcnt vmcnt(6)
  v_mfma_f32_16x16x32_bf16 v[108:111], a[248:251], a[28:31], v[108:111]
  s_nop 7
  v_cvt_pk_bf16_f32 v106, v108, v109
  v_cvt_pk_bf16_f32 v107, v110, v111
  buffer_store_dwordx2 v[106:107], v18, s[24:27], s63 offen sc1
  s_add_u32 s75, s92, 9
  s_waitcnt vmcnt(1)
  v_subrev_u32 v26, s75, v26
  v_cmp_eq_u32 s[52:53], s93, v27
  v_cmp_ge_u32 vcc, 6, v26
  s_nop 0
  s_and_b32 vcc_lo, vcc_lo, s52
  s_cmp_eq_u32 vcc_lo, 0xff
  s_cbranch_scc0 L_slow_r9
L_back_r9:
  s_add_u32 s55, s91, 393216
  buffer_load_dwordx4 a[48:51], v17, s[28:31], s55 offen offset:0 sc1
  buffer_load_dwordx4 a[52:55], v17, s[28:31], s55 offen offset:2048 sc1
  buffer_load_dwordx4 a[56:59], v17, s[28:31], s55 offen offset:256 sc1
  buffer_load_dwordx4 a[60:63], v17, s[28:31], s55 offen offset:2304 sc1
  s_add_u32 s55, s91, 524288
  buffer_load_dwordx4 a[64:67], v17, s[28:31], s55 offen offset:0 sc1
  buffer_load_dwordx4 a[68:71], v17, s[28:31], s55 offen offset:2048 sc1
  v_lshlrev_b32 v252, 16, v248
  v_and_b32 v253, 0xffff0000, v248
  v_lshlrev_b32 v254, 16, v249
  v_and_b32 v255, 0xffff0000, v249
  s_nop 1
  v_mfma_f32_16x16x32_bf16 v[252:255], a[252:255], a[32:35], v[252:255]
  v_mfma_f32_16x16x32_bf16 v[252:255], a[252:255], a[36:39], v[252:255]
  v_mfma_f32_16x16x32_bf16 v[252:255], a[248:251], a[40:43], v[252:255]
  v_mfma_f32_16x16x32_bf16 v[252:255], a[248:251], a[44:47], v[252:255]
  s_nop 7
L_pg10:
  s_cbranch_execz L_walked
  v_cvt_pk_bf16_f32 v250, v252, v253
  v_cvt_pk_bf16_f32 v251, v254, v255
  buffer_store_dwordx2 v[250:251], v18, s[24:27], s64 offen sc1
  v_lshlrev_b32 v204, 16, v200
  v_and_b32 v205, 0xffff0000, v200
  v_lshlrev_b32 v206, 16, v201
  v_and_b32 v207, 0xffff0000, v201
  s_waitcnt vmcnt(6)
  s_nop 0
  v_mfma_f32_16x16x32_bf16 v[204:207], a[252:255], a[48:51], v[204:207]
  s_waitcnt vmcnt(5)
  v_mfma_f32_16x16x32_bf16 v[204:207], a[252:255], a[52:55], v[204:207]
  s_waitcnt vmcnt(4)
  v_mfma_f32_16x16x32_bf16 v[204:207], a[248:251], a[56:59], v[204:207]
  s_waitcnt vmcnt(3)
  v_mfma_f32_16x16x32_bf16 v[204:207], a[248:251], a[60:63], v[204:207]
  s_nop 7
  v_cvt_pk_bf16_f32 v202, v204, v205
  v_cvt_pk_bf16_f32 v203, v206, v207
  buffer_store_dwordx2 v[202:203], v18, s[24:27], s65 offen sc1
  v_lshlrev_b32 v212, 16, v208
  v_and_b32 v213, 0xffff0000, v208
  v_lshlrev_b32 v214, 16, v209
  v_and_b32 v215, 0xffff0000, v209
  s_waitcnt vmcnt(3)
  s_nop 0
  v_mfma_f32_16x16x32_bf16 v[212:215], a[252:255], a[64:67], v[212:215]
  s_waitcnt vmcnt(2)
  v_mfma_f32_16x16x32_bf16 v[212:215], a[252:255], a[68:71], v[212:215]
  s_nop 7
  v_cvt_pk_bf16_f32 v210, v212, v213
  v_cvt_pk_bf16_f32 v211, v214, v215
  buffer_store_dwordx2 v[210:211], v19, s[24:27], s66 offen sc1
L_end:
  s_endpgm
L_slow_tag:
  s_mov_b32 s78, 0
L_spin_tag:
  s_sleep 2
  buffer_load_dword v26, v4, s[32:35], 0 offen sc1
  s_waitcnt vmcnt(0)
  v_readfirstlane_b32 s92, v26
  s_nop 1
  s_cmp_lg_u32 s92, 0
  s_cbranch_scc1 L_back_tag
  s_add_u32 s78, s78, 1
  s_cmp_lt_u32 s78, 0x40000
  s_cbranch_scc1 L_spin_tag
  s_branch L_back_tag
L_slow_kv:
  s_mov_b32 s78, 0
L_spin_kv:
  buffer_load_dwordx2 v[26:27], v5, s[28:31], 0 offen sc1
  s_waitcnt vmcnt(0)
  s_add_u32 s75, s92, 1
  s_nop 1
  v_subrev_u32 v26, s75, v26
  s_nop 1
  v_cmp_eq_u32 s[52:53], s93, v27
  s_nop 1
  v_cmp_ge_u32 vcc, 14, v26
  s_nop 1
  s_and_b32 vcc_lo, vcc_lo, s52
  s_nop 1
  s_cmp_eq_u32 vcc_lo, 0xfff
  s_cbranch_scc1 L_out_kv
  s_add_u32 s78, s78, 1
  s_cmp_lt_u32 s78, 0x40000
  s_cbranch_scc1 L_spin_kv
L_out_kv:
  s_branch L_back_kv
L_slow_h1:
  s_mov_b32 s78, 0
L_spin_h1:
  buffer_load_dwordx2 v[26:27], v5, s[28:31], 0 offen sc1
  s_waitcnt vmcnt(0)
  s_add_u32 s75, s92, 2
  s_nop 1
  v_subrev_u32 v26, s75, v26
  s_nop 1
  v_cmp_eq_u32 s[52:53], s93, v27
  s_nop 1
  v_cmp_ge_u32 vcc, 13, v26
  s_nop 1
  s_and_b32 vcc_lo, vcc_lo, s52
  s_nop 1
  s_cmp_eq_u32 vcc_lo, 0x1
  s_cbranch_scc1 L_out_h1
  s_add_u32 s78, s78, 1
  s_cmp_lt_u32 s78, 0x40000
  s_cbranch_scc1 L_spin_h1
L_out_h1:
  s_branch L_back_h1
L_slow_h2:
  s_mov_b32 s78, 0
L_spin_h2:
  buffer_load_dwordx2 v[26:27], v5, s[28:31], 0 offen sc1
  s_waitcnt vmcnt(0)
  s_add_u32 s75, s92, 3
  s_nop 1
  v_subrev_u32 v26, s75, v26
  s_nop 1
  v_cmp_eq_u32 s[52:53], s93, v27
  s_nop 1
  v_cmp_ge_u32 vcc, 12, v26
  s_nop 1
  s_and_b32 vcc_lo, vcc_lo, s52
  s_nop 1
  s_cmp_eq_u32 vcc_lo, 0x1
  s_cbranch_scc1 L_out_h2
  s_add_u32 s78, s78, 1
  s_cmp_lt_u32 s78, 0x40000
  s_cbranch_scc1 L_spin_h2
L_out_h2:
  s_branch L_back_h2
L_slow_o:
  s_mov_b32 s78, 0
L_spin_o:
  buffer_load_dwordx2 v[26:27], v5, s[28:31], 0 offen sc1
  s_waitcnt vmcnt(0)
  s_add_u32 s75, s92, 4
  s_nop 1
  v_subrev_u32 v26, s75, v26
  s_nop 1
  v_cmp_eq_u32 s[52:53], s93, v27
  s_nop 1
  v_cmp_ge_u32 vcc, 11, v26
  s_nop 1
  s_and_b32 vcc_lo, vcc_lo, s52
  s_nop 1
  s_cmp_eq_u32 vcc_lo, 0x1
  s_cbranch_scc1 L_out_o
  s_add_u32 s78, s78, 1
  s_cmp_lt_u32 s78, 0x40000
  s_cbranch_scc1 L_spin_o
L_out_o:
  s_branch L_back_o
L_slow_rb:
  s_mov_b32 s78, 0
L_spin_rb:
  buffer_load_dwordx2 v[26:27], v0, s[28:31], 0 offen sc1
  s_waitcnt vmcnt(0)
  s_add_u32 s75, s92, 7
  s_nop 1
  v_subrev_u32 v26, s75, v26
  s_nop 1
  v_cmp_eq_u32 s[52:53], s93, v27
  s_nop 1
  v_cmp_ge_u32 vcc, 8, v26
  s_nop 1
  s_and_b32 vcc_lo, vcc_lo, s52
  s_nop 1
  s_cmp_eq_u32 vcc_lo, 0xff
  s_cbranch_scc1 L_out_rb
  s_add_u32 s78, s78, 1
  s_cmp_lt_u32 s78, 0x40000
  s_cbranch_scc1 L_spin_rb
L_out_rb:
  s_branch L_back_rb
L_slow_r9:
  s_mov_b32 s78, 0
L_spin_r9:
  buffer_load_dwordx2 v[26:27], v0, s[28:31], 0 offen sc1
  s_waitcnt vmcnt(0)
  s_add_u32 s75, s92, 9
  s_nop 1
  v_subrev_u32 v26, s75, v26
  s_nop 1
  v_cmp_eq_u32 s[52:53], s93, v27
  s_nop 1
  v_cmp_ge_u32 vcc, 6, v26
  s_nop 1
  s_and_b32 vcc_lo, vcc_lo, s52
  s_nop 1
  s_cmp_eq_u32 vcc_lo, 0xff
  s_cbranch_scc1 L_out_r9
  s_add_u32 s78, s78, 1
  s_cmp_lt_u32 s78, 0x40000
  s_cbranch_scc1 L_spin_r9
L_out_r9:
  s_branch L_back_r9
L_code_end:
  s_endpgm
.fill 64, 4, 0xbf800000
.section .rodata,"a"
.p2align 6
.amdhsa_kernel parallel_sum__sliding_block__dense_activation_relu__prompt_kernel
  .amdhsa_next_free_vgpr 512
  .amdhsa_next_free_sgpr 102
  .amdhsa_accum_offset 256
  .amdhsa_group_segment_fixed_size 0
  .amdhsa_kernarg_size 72
  .amdhsa_user_sgpr_count 2
  .amdhsa_user_sgpr_kernarg_segment_ptr 1
  .amdhsa_system_sgpr_workgroup_id_x 1
.end_amdhsa_kernel
```
